```python
import torch

def _softmax(x, axis=-1):
    return torch.softmax(x, dim=axis)

def _gelu(x):
    return torch.nn.functional.gelu(x, approximate='tanh')

def _silu(x):
    return torch.nn.functional.silu(x)

def _sigmoid(x):
    return torch.sigmoid(x)

def _layernorm(x, axis=-1, eps=1e-05):
    m = x.mean(dim=axis, keepdim=True)
    v = x.var(dim=axis, keepdim=True, unbiased=False)
    return (x - m) / torch.sqrt(v + eps)

def _scatter_add(tgt, idx, src, axis=0):
    return tgt.clone().index_add_(axis, idx, src)

def _segment_sum(src, seg, n):
    out = torch.zeros((n,) + src.shape[1:], dtype=src.dtype)
    return out.index_add_(0, seg, src)

def _pad(x, pw):
    flat = tuple((v for pair in reversed(pw) for v in pair))
    return torch.nn.functional.pad(x, flat)
kernel_name = 'gated_mix__sliding_local_dilated__mixer_gmlp__prompt'

def setup_inputs():

    _w = lambda a: (lambda t: t.to(torch.bfloat16) if t.is_floating_point() else t)(torch.as_tensor(a))

    def _A_setup():
        B, S, D = (1, 2048, 1024)
        return {'x': _w((lambda *s: torch.randn(*s, dtype=torch.bfloat16) * 0.05)(B, S, D)), 'wqkv': _w((lambda *s: torch.randn(*s, dtype=torch.bfloat16) * 0.8)(D, 3 * D)), 'wo': _w((lambda *s: torch.randn(*s, dtype=torch.bfloat16) * 0.05)(D, D))}
    _A_in = _A_setup()

    def _B_setup():
        B, S, D, F = (1, 2048, 1024, 3584)
        Fh = F // 2
        return {'x': _w((lambda *s: torch.randn(*s, dtype=torch.bfloat16) * 0.05)(B, S, D)), 'w_in': _w((lambda *s: torch.randn(*s, dtype=torch.bfloat16) * 0.4)(D, 2 * Fh)), 'w_sp': _w(0.01 * (lambda *s: torch.randn(*s, dtype=torch.bfloat16) * 0.4)(S, S)), 'b_sp': _w(1.0 + 0.01 * (lambda *s: torch.randn(*s, dtype=torch.bfloat16) * 0.1)(S)), 'w_out': _w((lambda *s: torch.randn(*s, dtype=torch.bfloat16) * 0.1)(Fh, D))}
    _B_in = _B_setup()
    return {'A_x': _A_in['x'], 'A_wqkv': _A_in['wqkv'], 'A_wo': _A_in['wo'], 'B_x': _B_in['x'], 'B_w_in': _B_in['w_in'], 'B_w_sp': _B_in['w_sp'], 'B_b_sp': _B_in['b_sp'], 'B_w_out': _B_in['w_out'], 'gate_w': _w((lambda *s: torch.randn(*s, dtype=torch.bfloat16) * 0.05)(1024) * 16.0)}

def reference(A_x, A_wqkv, A_wo, B_x, B_w_in, B_w_sp, B_b_sp, B_w_out, gate_w):

    def _A_ref(x, wqkv, wo):
        B, S, D = x.shape
        H = 32
        Dh = D // H
        W, dil = (8, 2)
        qkv = (lambda x, *d: x.permute(*d))((x @ wqkv).reshape(B, S, 3, H, Dh), 2, 0, 3, 1, 4)
        q, k, v = (qkv[0], qkv[1], qkv[2])
        scale = Dh ** (-0.5)
        pos = torch.arange(S)
        off = torch.arange(W) * dil
        idx = pos[:, None] - off[None, :]
        mask = idx >= 0
        idx_c = torch.where(mask, idx, 0).reshape(-1)
        kg = k[:, :, idx_c, :].reshape(B, H, S, W, Dh)
        vg = v[:, :, idx_c, :].reshape(B, H, S, W, Dh)
        logits = torch.einsum('bhsd,bhswd->bhsw', q, kg) * scale
        logits = torch.where(mask[None, None, :, :], logits, -1000000000.0)
        attn = _softmax(logits, axis=-1)
        o = torch.einsum('bhsw,bhswd->bhsd', attn, vg)
        return (lambda x, *d: x.permute(*d))(o, 0, 2, 1, 3).reshape(B, S, D) @ wo

    def _B_ref(x, w_in, w_sp, b_sp, w_out):
        B, S, D = x.shape
        F = w_in.shape[-1]
        Fh = F // 2
        z = _gelu(torch.einsum('bsd,df->bsf', x, w_in))
        z1 = z[..., :Fh].clone()
        z2 = _layernorm(z[..., Fh:], axis=-1)
        g = torch.einsum('ts,bsf->btf', w_sp, z2) + b_sp[None, :, None]
        return torch.einsum('bsf,fd->bsd', z1 * g, w_out)
    x = A_x
    g = _sigmoid((x * gate_w).sum(-1, keepdims=True))
    a = _A_ref(x, A_wqkv, A_wo)
    b = _B_ref(x, B_w_in, B_w_sp, B_b_sp, B_w_out)
    return g * a + (1 - g) * b
```

```asm
; @launch grid=(256,1,1) block=(256,1,1) lds=163840
.amdgcn_target "amdgcn-amd-amdhsa--gfx950"
.text
.globl gated_mix__sliding_local_dilated__mixer_gmlp__prompt_kernel
.p2align 8
.type gated_mix__sliding_local_dilated__mixer_gmlp__prompt_kernel,@function
gated_mix__sliding_local_dilated__mixer_gmlp__prompt_kernel:
    s_cmp_ge_u32 s2, 256
    s_cbranch_scc0 L_start
    s_endpgm
L_start:
    s_load_dwordx16 s[56:71], s[0:1], 0
    s_load_dwordx4 s[72:75], s[0:1], 64
    s_load_dwordx4 s[76:79], s[0:1], 80
    v_lshrrev_b32 v1, 6, v0
    v_and_b32 v0, 63, v0
    v_readfirstlane_b32 s24, v1
    s_and_b32 s41, s2, 7
    s_lshr_b32 s42, s2, 3
    s_and_b32 s25, s41, 1
    s_lshl_b32 s25, s25, 2
    s_and_b32 s43, s42, 3
    s_add_u32 s25, s25, s43
    s_lshl_b32 s27, s25, 8
    s_lshl_b32 s31, s25, 7
    s_lshr_b32 s41, s41, 1
    s_lshr_b32 s42, s42, 2
    s_and_b32 s51, s24, 1
    s_lshr_b32 s50, s24, 1
    s_lshl_b32 s43, s41, 2
    s_add_u32 s43, s43, s42
    s_add_u32 s52, s42, s25
    v_lshrrev_b32 v200, 3, v0
    v_and_b32 v201, 7, v0
    v_lshrrev_b32 v202, 1, v200
    v_xor_b32 v203, v201, v202
    v_xor_b32 v204, 4, v203
    v_lshlrev_b32 v200, 12, v200
    v_lshl_add_u32 v203, v203, 4, v200
    v_lshl_add_u32 v204, v204, 4, v200
    s_lshl_b32 s44, s24, 6
    s_add_u32 s44, s44, s27
    s_lshl_b32 s44, s44, 11
    s_add_u32 s45, s44, 0
    v_add_u32 v224, s45, v203
    s_add_u32 s45, s44, 31744
    v_add_u32 v225, s45, v204
    s_add_u32 s45, s44, 0
    v_add_u32 v226, s45, v203
    s_add_u32 s45, s44, 31744
    v_add_u32 v227, s45, v204
    s_add_u32 s45, s44, 65536
    v_add_u32 v228, s45, v203
    s_add_u32 s45, s44, 97280
    v_add_u32 v229, s45, v204
    s_add_u32 s45, s44, 65536
    v_add_u32 v230, s45, v203
    s_add_u32 s45, s44, 97280
    v_add_u32 v231, s45, v204
    s_lshl_b32 s32, s24, 13
    s_mov_b32 s53, 0
    s_and_b32 s54, s52, 3
    s_lshl_b32 s28, s54, 7
    s_waitcnt lgkmcnt(0)
    s_mov_b32 s4, s56
    s_mov_b32 s5, s57
    s_mov_b32 s6, 0x400000
    s_mov_b32 s7, 0x20000
    s_mov_b32 m0, s32
    s_nop 0
    buffer_load_dwordx4 v224, s[4:7], s28 offen lds
    buffer_load_dwordx4 v225, s[4:7], s28 offen offset:1024 lds
    buffer_load_dwordx4 v226, s[4:7], s28 offen offset:2048 lds
    buffer_load_dwordx4 v227, s[4:7], s28 offen offset:3072 lds
    s_add_u32 m0, s32, 4096
    s_nop 0
    buffer_load_dwordx4 v228, s[4:7], s28 offen lds
    buffer_load_dwordx4 v229, s[4:7], s28 offen offset:1024 lds
    buffer_load_dwordx4 v230, s[4:7], s28 offen offset:2048 lds
    buffer_load_dwordx4 v231, s[4:7], s28 offen offset:3072 lds
    s_mov_b32 s85, 0x1c62000
    s_mov_b32 s87, 0
    s_cmp_lt_u32 s42, 4
    s_cbranch_scc1 L_p1_sel
    s_mov_b32 s87, 4
    s_cmp_lt_u32 s41, 2
    s_cbranch_scc1 L_p1_sel
    s_cmp_eq_u32 s42, 7
    s_cbranch_scc0 L_p1_sel
    s_mov_b32 s87, 8
L_p1_sel:
    s_cmp_eq_u32 s87, 4
    s_cbranch_scc1 L_p1_Z
    s_cmp_eq_u32 s87, 8
    s_cbranch_scc1 L_p1_Y
    s_mov_b32 s26, s43
    s_lshl_b32 s41, s26, 2
    s_add_u32 s31, s31, s41
    v_and_b32 v201, 7, v0
    v_lshrrev_b32 v200, 3, v0
    v_and_b32 v200, 3, v200
    s_lshl_b32 s41, s24, 2
    v_add_u32 v200, s41, v200
    v_and_b32 v202, 7, v200
    v_lshlrev_b32 v202, 1, v202
    v_lshrrev_b32 v203, 3, v200
    v_add_u32 v202, v202, v203
    s_sub_u32 s41, s27, 16
    v_add_u32 v202, s41, v202
    v_max_i32 v202, 0, v202
    v_lshrrev_b32 v200, 1, v200
    v_xor_b32 v200, v201, v200
    v_lshlrev_b32 v200, 4, v200
    v_lshl_add_u32 v232, v202, 11, v200
    s_mul_i32 s41, s24, 7680
    s_sub_u32 s35, 32768, s41
    s_mul_i32 s29, s54, 393216
    s_mul_i32 s30, s54, 458752
    s_add_u32 m0, s32, s35
    s_mov_b32 exec_hi, 0
    buffer_load_dwordx4 v232, s[4:7], s28 offen lds
    s_mov_b32 exec_hi, -1
    s_mov_b32 s16, s78
    s_mov_b32 s17, s79
    s_mov_b32 s18, 0x10000000
    s_mov_b32 s19, 0x20000
    s_mov_b32 s20, s76
    s_mov_b32 s21, s77
    s_mov_b32 s22, 0x100
    s_mov_b32 s23, 0x20000
    s_lshl_b32 s41, s26, 7
    s_movk_i32 s42, 2048
    s_add_u32 s43, s41, 4096
    s_mov_b32 s8, s58
    s_mov_b32 s9, s59
    s_mov_b32 s10, 0x600000
    s_mov_b32 s11, 0x20000
    v_lshrrev_b32 v200, 3, v0
    v_and_b32 v201, 7, v0
    v_and_b32 v202, 2, v200
    v_xor_b32 v201, v201, v202
    v_mul_u32_u24 v200, 6144, v200
    v_lshl_add_u32 v203, v201, 4, v200
    v_xor_b32 v204, 64, v203
    s_mul_i32 s44, s24, 6
    s_add_u32 s45, s44, 0
    s_lshr_b32 s46, s45, 3
    s_and_b32 s45, s45, 7
    s_mul_i32 s47, s46, s42
    s_add_u32 s47, s47, s41
    s_cmp_eq_u32 s46, 2
    s_cselect_b32 s47, s43, s47
    s_mul_i32 s45, s45, 49152
    s_add_u32 s47, s47, s45
    v_add_u32 v233, s47, v203
    s_add_u32 s45, s44, 1
    s_lshr_b32 s46, s45, 3
    s_and_b32 s45, s45, 7
    s_mul_i32 s47, s46, s42
    s_add_u32 s47, s47, s41
    s_cmp_eq_u32 s46, 2
    s_cselect_b32 s47, s43, s47
    s_mul_i32 s45, s45, 49152
    s_add_u32 s47, s47, s45
    s_sub_u32 s47, s47, 1024
    v_add_u32 v234, s47, v204
    s_add_u32 s45, s44, 2
    s_lshr_b32 s46, s45, 3
    s_and_b32 s45, s45, 7
    s_mul_i32 s47, s46, s42
    s_add_u32 s47, s47, s41
    s_cmp_eq_u32 s46, 2
    s_cselect_b32 s47, s43, s47
    s_mul_i32 s45, s45, 49152
    s_add_u32 s47, s47, s45
    s_sub_u32 s47, s47, 2048
    v_add_u32 v235, s47, v203
    s_add_u32 s45, s44, 3
    s_lshr_b32 s46, s45, 3
    s_and_b32 s45, s45, 7
    s_mul_i32 s47, s46, s42
    s_add_u32 s47, s47, s41
    s_cmp_eq_u32 s46, 2
    s_cselect_b32 s47, s43, s47
    s_mul_i32 s45, s45, 49152
    s_add_u32 s47, s47, s45
    s_sub_u32 s47, s47, 3072
    v_add_u32 v236, s47, v204
    s_add_u32 s45, s44, 4
    s_lshr_b32 s46, s45, 3
    s_and_b32 s45, s45, 7
    s_mul_i32 s47, s46, s42
    s_add_u32 s47, s47, s41
    s_cmp_eq_u32 s46, 2
    s_cselect_b32 s47, s43, s47
    s_mul_i32 s45, s45, 49152
    s_add_u32 s47, s47, s45
    v_add_u32 v237, s47, v203
    s_add_u32 s45, s44, 5
    s_lshr_b32 s46, s45, 3
    s_and_b32 s45, s45, 7
    s_mul_i32 s47, s46, s42
    s_add_u32 s47, s47, s41
    s_cmp_eq_u32 s46, 2
    s_cselect_b32 s47, s43, s47
    s_mul_i32 s45, s45, 49152
    s_add_u32 s47, s47, s45
    s_sub_u32 s47, s47, 1024
    v_add_u32 v238, s47, v204
    s_mov_b32 s12, s64
    s_mov_b32 s13, s65
    s_mov_b32 s14, 0x700000
    s_mov_b32 s15, 0x20000
    v_lshrrev_b32 v200, 2, v0
    s_lshl_b32 s41, s24, 4
    v_add_u32 v200, s41, v200
    v_and_b32 v201, 3, v0
    v_lshrrev_b32 v202, 2, v200
    v_and_b32 v202, 2, v202
    v_xor_b32 v201, v201, v202
    s_lshl_b32 s41, s26, 6
    v_lshl_add_u32 v201, v201, 4, s41
    s_movk_i32 s41, 7168
    v_mad_u32_u24 v239, v200, s41, v201
    s_mul_i32 s41, s24, 5120
    s_sub_u32 s34, 24576, s41
    s_mul_i32 s33, s24, 6144
    s_add_u32 s33, s33, 104448
    s_mov_b32 m0, s33
    s_nop 0
    buffer_load_dwordx4 v233, s[8:11], s29 offen lds
    buffer_load_dwordx4 v234, s[8:11], s29 offen offset:1024 lds
    buffer_load_dwordx4 v235, s[8:11], s29 offen offset:2048 lds
    buffer_load_dwordx4 v236, s[8:11], s29 offen offset:3072 lds
    s_add_u32 m0, s33, 4096
    s_nop 0
    buffer_load_dwordx4 v237, s[8:11], s29 offen lds
    buffer_load_dwordx4 v238, s[8:11], s29 offen offset:1024 lds
    s_add_u32 m0, s33, s34
    s_nop 0
    buffer_load_dwordx4 v239, s[12:15], s30 offen lds
    v_mul_u32_u24 v252, 44, v0
    v_and_b32 v206, 15, v0
    v_lshrrev_b32 v207, 4, v0
    v_bfe_u32 v208, v0, 2, 2
    v_and_b32 v209, 3, v0
    v_lshrrev_b32 v200, 1, v206
    v_xor_b32 v200, v207, v200
    v_lshlrev_b32 v200, 4, v200
    v_lshl_add_u32 v200, v206, 7, v200
    s_lshl_b32 s41, s50, 14
    v_add_u32 v240, s41, v200
    v_xor_b32 v241, 64, v240
    v_and_b32 v200, 7, v206
    v_lshrrev_b32 v201, 3, v206
    v_lshl_add_u32 v200, v201, 4, v200
    v_add_u32 v200, 104, v200
    v_add_u32 v201, 256, v206
    s_cmp_eq_u32 s50, 0
    s_cselect_b64 vcc, -1, 0
    v_cndmask_b32 v200, v200, v201, vcc
    v_bfe_u32 v201, v200, 1, 3
    v_xor_b32 v201, v207, v201
    v_lshlrev_b32 v201, 4, v201
    v_lshl_add_u32 v242, v200, 7, v201
    v_xor_b32 v243, 64, v242
    v_lshl_add_u32 v200, v207, 3, v208
    v_lshrrev_b32 v201, 1, v208
    v_and_b32 v202, 1, v207
    v_lshl_or_b32 v201, v202, 1, v201
    v_lshlrev_b32 v203, 3, v209
    v_lshl_add_u32 v203, v200, 7, v203
    s_lshl_b32 s41, s51, 1
    s_add_u32 s41, s41, 0
    s_lshr_b32 s42, s41, 2
    s_lshl_b32 s42, s42, 13
    s_add_u32 s42, s42, 104448
    s_and_b32 s41, s41, 3
    v_xor_b32 v204, s41, v201
    v_lshl_add_u32 v204, v204, 5, v203
    v_add_u32 v244, s42, v204
    s_lshl_b32 s41, s51, 1
    s_add_u32 s41, s41, 1
    s_lshr_b32 s42, s41, 2
    s_lshl_b32 s42, s42, 13
    s_add_u32 s42, s42, 104448
    s_and_b32 s41, s41, 3
    v_xor_b32 v204, s41, v201
    v_lshl_add_u32 v204, v204, 5, v203
    v_add_u32 v245, s42, v204
    s_lshl_b32 s41, s51, 1
    s_add_u32 s41, s41, 4
    s_lshr_b32 s42, s41, 2
    s_lshl_b32 s42, s42, 13
    s_add_u32 s42, s42, 104448
    s_and_b32 s41, s41, 3
    v_xor_b32 v204, s41, v201
    v_lshl_add_u32 v204, v204, 5, v203
    v_add_u32 v246, s42, v204
    s_lshl_b32 s41, s51, 1
    s_add_u32 s41, s41, 5
    s_lshr_b32 s42, s41, 2
    s_lshl_b32 s42, s42, 13
    s_add_u32 s42, s42, 104448
    s_and_b32 s41, s41, 3
    v_xor_b32 v204, s41, v201
    v_lshl_add_u32 v204, v204, 5, v203
    v_add_u32 v247, s42, v204
    s_lshl_b32 s41, s51, 1
    s_add_u32 s41, s41, 8
    s_lshr_b32 s42, s41, 2
    s_lshl_b32 s42, s42, 13
    s_add_u32 s42, s42, 104448
    s_and_b32 s41, s41, 3
    v_xor_b32 v204, s41, v201
    v_lshl_add_u32 v204, v204, 5, v203
    v_add_u32 v248, s42, v204
    s_lshl_b32 s41, s51, 1
    s_add_u32 s41, s41, 9
    s_lshr_b32 s42, s41, 2
    s_lshl_b32 s42, s42, 13
    s_add_u32 s42, s42, 104448
    s_and_b32 s41, s41, 3
    v_xor_b32 v204, s41, v201
    v_lshl_add_u32 v204, v204, 5, v203
    v_add_u32 v249, s42, v204
    v_xor_b32 v204, s51, v202
    v_lshlrev_b32 v204, 5, v204
    v_lshl_add_u32 v204, v200, 6, v204
    v_lshl_add_u32 v204, v209, 3, v204
    v_add_u32 v250, 129024, v204
    v_lshlrev_b32 v200, 2, v207
    v_sub_u32 v200, v206, v200
    v_lshlrev_b32 v205, 2, v207
    s_mov_b32 s41, 0xcfa8965f
    v_mov_b32 v204, s41
    s_lshl_b32 s42, s50, 7
    s_add_u32 s42, s42, s27
    s_cmp_eq_u32 s42, 0
    s_cselect_b32 s42, 0, -1
    s_mov_b32 s43, s42
    s_mov_b32 s44, s42
    s_mov_b32 s45, s42
    v_subrev_u32 v201, 0, v200
    v_cmp_gt_u32 vcc, 8, v201
    s_nop 1
    v_cndmask_b32 v0, v204, 0, vcc
    v_cmp_ge_i32 vcc, -9, v201
    s_nop 1
    v_cndmask_b32 v4, v204, 0, vcc
    s_and_b64 vcc, vcc, s[44:45]
    v_cndmask_b32 v12, v204, 0, vcc
    v_cmp_ge_i32 vcc, -1, v201
    v_add_u32 v202, 0, v205
    v_cmp_gt_u32 s[46:47], 8, v202
    s_nop 0
    s_and_b64 vcc, vcc, s[46:47]
    s_and_b64 vcc, vcc, s[44:45]
    v_cndmask_b32 v8, v204, 0, vcc
    v_subrev_u32 v201, 1, v200
    v_cmp_gt_u32 vcc, 8, v201
    s_nop 1
    v_cndmask_b32 v1, v204, 0, vcc
    v_cmp_ge_i32 vcc, -9, v201
    s_nop 1
    v_cndmask_b32 v5, v204, 0, vcc
    s_and_b64 vcc, vcc, s[44:45]
    v_cndmask_b32 v13, v204, 0, vcc
    v_cmp_ge_i32 vcc, -1, v201
    v_add_u32 v202, 1, v205
    v_cmp_gt_u32 s[46:47], 8, v202
    s_nop 0
    s_and_b64 vcc, vcc, s[46:47]
    s_and_b64 vcc, vcc, s[44:45]
    v_cndmask_b32 v9, v204, 0, vcc
    v_subrev_u32 v201, 2, v200
    v_cmp_gt_u32 vcc, 8, v201
    s_nop 1
    v_cndmask_b32 v2, v204, 0, vcc
    v_cmp_ge_i32 vcc, -9, v201
    s_nop 1
    v_cndmask_b32 v6, v204, 0, vcc
    s_and_b64 vcc, vcc, s[44:45]
    v_cndmask_b32 v14, v204, 0, vcc
    v_cmp_ge_i32 vcc, -1, v201
    v_add_u32 v202, 2, v205
    v_cmp_gt_u32 s[46:47], 8, v202
    s_nop 0
    s_and_b64 vcc, vcc, s[46:47]
    s_and_b64 vcc, vcc, s[44:45]
    v_cndmask_b32 v10, v204, 0, vcc
    v_subrev_u32 v201, 3, v200
    v_cmp_gt_u32 vcc, 8, v201
    s_nop 1
    v_cndmask_b32 v3, v204, 0, vcc
    v_cmp_ge_i32 vcc, -9, v201
    s_nop 1
    v_cndmask_b32 v7, v204, 0, vcc
    s_and_b64 vcc, vcc, s[44:45]
    v_cndmask_b32 v15, v204, 0, vcc
    v_cmp_ge_i32 vcc, -1, v201
    v_add_u32 v202, 3, v205
    v_cmp_gt_u32 s[46:47], 8, v202
    s_nop 0
    s_and_b64 vcc, vcc, s[46:47]
    s_and_b64 vcc, vcc, s[44:45]
    v_cndmask_b32 v11, v204, 0, vcc
    s_cmp_lt_u32 s2, 54
    s_cbranch_scc1 L_p1a_pf0
    s_cmp_lt_u32 s2, 68
    s_cbranch_scc1 L_p1a_pf1
    s_mov_b32 s80, s70
    s_mov_b32 s81, s71
    s_mov_b32 s82, 0x380000
    s_mov_b32 s83, 0x20000
    s_sub_u32 s41, s2, 68
    s_branch L_p1a_pf2
L_p1a_pf1:
    s_mov_b32 s80, s60
    s_mov_b32 s81, s61
    s_mov_b32 s82, 0x200000
    s_mov_b32 s83, 0x20000
    s_sub_u32 s41, s2, 54
    s_branch L_p1a_pf2
L_p1a_pf0:
    s_mov_b32 s80, s66
    s_mov_b32 s81, s67
    s_mov_b32 s82, 0x800000
    s_mov_b32 s83, 0x20000
    s_mov_b32 s41, s2
L_p1a_pf2:
    s_lshl_b32 s41, s41, 2
    s_add_u32 s41, s41, s24
    s_mul_i32 s84, s41, 39424
    s_mov_b32 s36, 0
    s_mov_b32 s37, 34816
    s_mov_b32 s38, 34816
    s_mov_b32 s39, -69632
    s_mov_b32 s40, 28672
    s_mov_b64 exec, 0
    s_cmp_eq_u32 s24, 0
    s_cbranch_scc1 L_pad_p1a_0
    s_cmp_eq_u32 s24, 1
    s_cbranch_scc1 L_pad_p1a_1
    s_cmp_eq_u32 s24, 2
    s_cbranch_scc1 L_pad_p1a_2
    s_branch L_pad_p1a_3
L_pad_p1a_ret:
    s_mov_b64 exec, -1
    s_add_u32 s32, s32, 34816
    s_add_u32 s53, s53, 1
    s_add_u32 s42, s53, s52
    s_and_b32 s42, s42, 3
    s_and_b32 s54, s53, -4
    s_or_b32 s54, s54, s42
    s_lshl_b32 s28, s54, 7
    s_mul_i32 s29, s54, 393216
    s_mul_i32 s30, s54, 458752
    s_mov_b32 m0, s32
    s_nop 0
    buffer_load_dwordx4 v224, s[4:7], s28 offen lds
    buffer_load_dwordx4 v225, s[4:7], s28 offen offset:1024 lds
    buffer_load_dwordx4 v226, s[4:7], s28 offen offset:2048 lds
    buffer_load_dwordx4 v227, s[4:7], s28 offen offset:3072 lds
    s_add_u32 m0, s32, 4096
    s_nop 0
    buffer_load_dwordx4 v228, s[4:7], s28 offen lds
    buffer_load_dwordx4 v229, s[4:7], s28 offen offset:1024 lds
    buffer_load_dwordx4 v230, s[4:7], s28 offen offset:2048 lds
    buffer_load_dwordx4 v231, s[4:7], s28 offen offset:3072 lds
    s_add_u32 m0, s32, s35
    s_mov_b32 exec_hi, 0
    buffer_load_dwordx4 v232, s[4:7], s28 offen lds
    s_mov_b32 exec_hi, -1
    s_add_u32 s33, s33, 28672
    s_mov_b32 m0, s33
    s_nop 0
    buffer_load_dwordx4 v233, s[8:11], s29 offen lds
    buffer_load_dwordx4 v234, s[8:11], s29 offen offset:1024 lds
    buffer_load_dwordx4 v235, s[8:11], s29 offen offset:2048 lds
    buffer_load_dwordx4 v236, s[8:11], s29 offen offset:3072 lds
    s_add_u32 m0, s33, 4096
    s_nop 0
    buffer_load_dwordx4 v237, s[8:11], s29 offen lds
    buffer_load_dwordx4 v238, s[8:11], s29 offen offset:1024 lds
    s_add_u32 m0, s33, s34
    s_nop 0
    buffer_load_dwordx4 v239, s[12:15], s30 offen lds
    s_add_u32 s32, s32, 34816
    s_sub_u32 s33, s33, 28672
    s_add_u32 s53, s53, 1
    s_add_u32 s42, s53, s52
    s_and_b32 s42, s42, 3
    s_and_b32 s54, s53, -4
    s_or_b32 s54, s54, s42
    s_lshl_b32 s28, s54, 7
    s_mul_i32 s29, s54, 393216
    s_mul_i32 s30, s54, 458752
    s_waitcnt vmcnt(16)
    s_barrier
    ds_read_b128 a[0:3], v240 offset:0
    ds_read_b64_tr_b16 a[36:37], v244 offset:0
    ds_read_b64_tr_b16 a[38:39], v244 offset:512
    ds_read_b64_tr_b16 a[40:41], v245 offset:0
    ds_read_b64_tr_b16 a[42:43], v245 offset:512
    ds_read_b64_tr_b16 a[44:45], v246 offset:0
    ds_read_b64_tr_b16 a[46:47], v246 offset:512
    ds_read_b64_tr_b16 a[48:49], v247 offset:0
    ds_read_b64_tr_b16 a[50:51], v247 offset:512
    ds_read_b64_tr_b16 a[52:53], v248 offset:0
    ds_read_b64_tr_b16 a[54:55], v248 offset:512
    ds_read_b64_tr_b16 a[56:57], v249 offset:0
    ds_read_b64_tr_b16 a[58:59], v249 offset:512
    ds_read_b64_tr_b16 a[60:61], v250 offset:0
    ds_read_b64_tr_b16 a[62:63], v250 offset:256
    ds_read_b128 a[4:7], v240 offset:2048
    ds_read_b128 a[8:11], v240 offset:4096
    ds_read_b128 a[12:15], v240 offset:6144
    ds_read_b128 a[16:19], v240 offset:8192
    ds_read_b128 a[20:23], v240 offset:10240
    ds_read_b128 a[24:27], v240 offset:12288
    ds_read_b128 a[28:31], v240 offset:14336
    ds_read_b128 a[32:35], v242
    s_waitcnt lgkmcnt(0)
    v_mfma_f32_16x16x32_bf16 v[16:19], a[36:39], a[0:3], 0
    ds_read_b128 a[64:67], v241 offset:0
    v_mfma_f32_16x16x32_bf16 v[20:23], a[40:43], a[0:3], 0
    s_mov_b32 m0, s32
    v_mfma_f32_16x16x32_bf16 v[80:83], a[44:47], a[0:3], 0
    ds_read_b64_tr_b16 a[100:101], v244 offset:4096
    v_mfma_f32_16x16x32_bf16 v[84:87], a[48:51], a[0:3], 0
    ds_read_b64_tr_b16 a[102:103], v244 offset:4608
    v_mfma_f32_16x16x32_bf16 v[152:155], a[0:3], a[52:55], 0
    ds_read_b64_tr_b16 a[104:105], v245 offset:4096
    v_mfma_f32_16x16x32_bf16 v[156:159], a[0:3], a[56:59], 0
    buffer_load_dwordx4 v224, s[4:7], s28 offen lds
    v_mfma_f32_16x16x32_bf16 a[128:131], a[60:63], a[0:3], 0
    ds_read_b64_tr_b16 a[106:107], v245 offset:4608
    v_mfma_f32_16x16x32_bf16 v[24:27], a[36:39], a[4:7], 0
    ds_read_b64_tr_b16 a[108:109], v246 offset:4096
    v_mfma_f32_16x16x32_bf16 v[28:31], a[40:43], a[4:7], 0
    ds_read_b64_tr_b16 a[110:111], v246 offset:4608
    v_mfma_f32_16x16x32_bf16 v[88:91], a[44:47], a[4:7], 0
    buffer_load_dwordx4 v225, s[4:7], s28 offen offset:1024 lds
    v_mfma_f32_16x16x32_bf16 v[92:95], a[48:51], a[4:7], 0
    ds_read_b64_tr_b16 a[112:113], v247 offset:4096
    v_mfma_f32_16x16x32_bf16 v[160:163], a[4:7], a[52:55], 0
    ds_read_b64_tr_b16 a[114:115], v247 offset:4608
    v_mfma_f32_16x16x32_bf16 v[164:167], a[4:7], a[56:59], 0
    ds_read_b64_tr_b16 a[116:117], v248 offset:4096
    v_mfma_f32_16x16x32_bf16 a[132:135], a[60:63], a[4:7], 0
    buffer_load_dwordx4 v226, s[4:7], s28 offen offset:2048 lds
    v_mfma_f32_16x16x32_bf16 v[32:35], a[36:39], a[8:11], 0
    ds_read_b64_tr_b16 a[118:119], v248 offset:4608
    v_mfma_f32_16x16x32_bf16 v[36:39], a[40:43], a[8:11], 0
    ds_read_b64_tr_b16 a[120:121], v249 offset:4096
    v_mfma_f32_16x16x32_bf16 v[96:99], a[44:47], a[8:11], 0
    ds_read_b64_tr_b16 a[122:123], v249 offset:4608
    v_mfma_f32_16x16x32_bf16 v[100:103], a[48:51], a[8:11], 0
    buffer_load_dwordx4 v227, s[4:7], s28 offen offset:3072 lds
    v_mfma_f32_16x16x32_bf16 v[168:171], a[8:11], a[52:55], 0
    ds_read_b64_tr_b16 a[124:125], v250 offset:2048
    v_mfma_f32_16x16x32_bf16 v[172:175], a[8:11], a[56:59], 0
    ds_read_b64_tr_b16 a[126:127], v250 offset:2304
    v_mfma_f32_16x16x32_bf16 a[136:139], a[60:63], a[8:11], 0
    ds_read_b128 a[68:71], v241 offset:2048
    v_mfma_f32_16x16x32_bf16 v[40:43], a[36:39], a[12:15], 0
    s_add_u32 m0, s32, 4096
    v_mfma_f32_16x16x32_bf16 v[44:47], a[40:43], a[12:15], 0
    ds_read_b128 a[72:75], v241 offset:4096
    v_mfma_f32_16x16x32_bf16 v[104:107], a[44:47], a[12:15], 0
    ds_read_b128 a[76:79], v241 offset:6144
    v_mfma_f32_16x16x32_bf16 v[108:111], a[48:51], a[12:15], 0
    ds_read_b128 a[80:83], v241 offset:8192
    v_mfma_f32_16x16x32_bf16 v[176:179], a[12:15], a[52:55], 0
    buffer_load_dwordx4 v228, s[4:7], s28 offen lds
    v_mfma_f32_16x16x32_bf16 v[180:183], a[12:15], a[56:59], 0
    ds_read_b128 a[84:87], v241 offset:10240
    v_mfma_f32_16x16x32_bf16 a[140:143], a[60:63], a[12:15], 0
    ds_read_b128 a[88:91], v241 offset:12288
    v_mfma_f32_16x16x32_bf16 v[48:51], a[36:39], a[16:19], 0
    ds_read_b128 a[92:95], v241 offset:14336
    v_mfma_f32_16x16x32_bf16 v[52:55], a[40:43], a[16:19], 0
    buffer_load_dwordx4 v229, s[4:7], s28 offen offset:1024 lds
    v_mfma_f32_16x16x32_bf16 v[112:115], a[44:47], a[16:19], 0
    ds_read_b128 a[96:99], v243
    v_mfma_f32_16x16x32_bf16 v[116:119], a[48:51], a[16:19], 0
    v_add_u32 v241, s37, v241
    v_mfma_f32_16x16x32_bf16 v[184:187], a[16:19], a[52:55], 0
    v_add_u32 v240, s37, v240
    v_mfma_f32_16x16x32_bf16 v[188:191], a[16:19], a[56:59], 0
    buffer_load_dwordx4 v230, s[4:7], s28 offen offset:2048 lds
    v_mfma_f32_16x16x32_bf16 a[144:147], a[60:63], a[16:19], 0
    v_add_u32 v243, s37, v243
    v_mfma_f32_16x16x32_bf16 v[56:59], a[36:39], a[20:23], 0
    v_add_u32 v242, s37, v242
    v_mfma_f32_16x16x32_bf16 v[60:63], a[40:43], a[20:23], 0
    v_add_u32 v250, s40, v250
    v_mfma_f32_16x16x32_bf16 v[120:123], a[44:47], a[20:23], 0
    buffer_load_dwordx4 v231, s[4:7], s28 offen offset:3072 lds
    v_mfma_f32_16x16x32_bf16 v[124:127], a[48:51], a[20:23], 0
    v_add_u32 v244, s40, v244
    v_mfma_f32_16x16x32_bf16 v[192:195], a[20:23], a[52:55], 0
    v_add_u32 v245, s40, v245
    v_mfma_f32_16x16x32_bf16 v[196:199], a[20:23], a[56:59], 0
    v_add_u32 v246, s40, v246
    v_mfma_f32_16x16x32_bf16 a[148:151], a[60:63], a[20:23], 0
    s_add_u32 m0, s32, s35
    v_mfma_f32_16x16x32_bf16 v[64:67], a[36:39], a[24:27], 0
    v_add_u32 v247, s40, v247
    v_mfma_f32_16x16x32_bf16 v[68:71], a[40:43], a[24:27], 0
    v_add_u32 v248, s40, v248
    v_mfma_f32_16x16x32_bf16 v[128:131], a[44:47], a[24:27], 0
    v_add_u32 v249, s40, v249
    v_mfma_f32_16x16x32_bf16 v[132:135], a[48:51], a[24:27], 0
    s_mov_b32 exec_hi, 0
    buffer_load_dwordx4 v232, s[4:7], s28 offen lds
    s_mov_b32 exec_hi, -1
    v_mfma_f32_16x16x32_bf16 v[200:203], a[24:27], a[52:55], 0
    v_mfma_f32_16x16x32_bf16 v[204:207], a[24:27], a[56:59], 0
    v_mfma_f32_16x16x32_bf16 a[152:155], a[60:63], a[24:27], 0
    v_mfma_f32_16x16x32_bf16 v[72:75], a[36:39], a[28:31], 0
    v_mfma_f32_16x16x32_bf16 v[76:79], a[40:43], a[28:31], 0
    v_mfma_f32_16x16x32_bf16 v[136:139], a[44:47], a[28:31], 0
    v_mfma_f32_16x16x32_bf16 v[140:143], a[48:51], a[28:31], 0
    v_mfma_f32_16x16x32_bf16 v[208:211], a[28:31], a[52:55], 0
    v_mfma_f32_16x16x32_bf16 v[212:215], a[28:31], a[56:59], 0
    v_mfma_f32_16x16x32_bf16 a[156:159], a[60:63], a[28:31], 0
    v_mfma_f32_16x16x32_bf16 v[144:147], a[44:47], a[32:35], 0
    v_mfma_f32_16x16x32_bf16 v[148:151], a[48:51], a[32:35], 0
    v_mfma_f32_16x16x32_bf16 v[216:219], a[32:35], a[52:55], 0
    v_mfma_f32_16x16x32_bf16 v[220:223], a[32:35], a[56:59], 0
    s_waitcnt vmcnt(9) lgkmcnt(0)
    s_barrier
    v_mfma_f32_16x16x32_bf16 v[16:19], a[100:103], a[64:67], v[16:19]
    s_mov_b32 m0, s33
    v_mfma_f32_16x16x32_bf16 v[20:23], a[104:107], a[64:67], v[20:23]
    ds_read_b128 a[0:3], v240 offset:0
    v_mfma_f32_16x16x32_bf16 v[80:83], a[108:111], a[64:67], v[80:83]
    ds_read_b64_tr_b16 a[36:37], v244 offset:0
    v_mfma_f32_16x16x32_bf16 v[84:87], a[112:115], a[64:67], v[84:87]
    buffer_load_dwordx4 v233, s[8:11], s29 offen lds
    v_mfma_f32_16x16x32_bf16 v[152:155], a[64:67], a[116:119], v[152:155]
    ds_read_b64_tr_b16 a[38:39], v244 offset:512
    v_mfma_f32_16x16x32_bf16 v[156:159], a[64:67], a[120:123], v[156:159]
    ds_read_b64_tr_b16 a[40:41], v245 offset:0
    v_mfma_f32_16x16x32_bf16 a[128:131], a[124:127], a[64:67], a[128:131]
    buffer_load_dwordx4 v234, s[8:11], s29 offen offset:1024 lds
    v_mfma_f32_16x16x32_bf16 v[24:27], a[100:103], a[68:71], v[24:27]
    ds_read_b64_tr_b16 a[42:43], v245 offset:512
    v_mfma_f32_16x16x32_bf16 v[28:31], a[104:107], a[68:71], v[28:31]
    ds_read_b64_tr_b16 a[44:45], v246 offset:0
    v_mfma_f32_16x16x32_bf16 v[88:91], a[108:111], a[68:71], v[88:91]
    buffer_load_dwordx4 v235, s[8:11], s29 offen offset:2048 lds
    v_mfma_f32_16x16x32_bf16 v[92:95], a[112:115], a[68:71], v[92:95]
    ds_read_b64_tr_b16 a[46:47], v246 offset:512
    v_mfma_f32_16x16x32_bf16 v[160:163], a[68:71], a[116:119], v[160:163]
    ds_read_b64_tr_b16 a[48:49], v247 offset:0
    v_mfma_f32_16x16x32_bf16 v[164:167], a[68:71], a[120:123], v[164:167]
    buffer_load_dwordx4 v236, s[8:11], s29 offen offset:3072 lds
    v_mfma_f32_16x16x32_bf16 a[132:135], a[124:127], a[68:71], a[132:135]
    ds_read_b64_tr_b16 a[50:51], v247 offset:512
    v_mfma_f32_16x16x32_bf16 v[32:35], a[100:103], a[72:75], v[32:35]
    ds_read_b64_tr_b16 a[52:53], v248 offset:0
    v_mfma_f32_16x16x32_bf16 v[36:39], a[104:107], a[72:75], v[36:39]
    s_add_u32 m0, s33, 4096
    v_mfma_f32_16x16x32_bf16 v[96:99], a[108:111], a[72:75], v[96:99]
    ds_read_b64_tr_b16 a[54:55], v248 offset:512
    v_mfma_f32_16x16x32_bf16 v[100:103], a[112:115], a[72:75], v[100:103]
    ds_read_b64_tr_b16 a[56:57], v249 offset:0
    v_mfma_f32_16x16x32_bf16 v[168:171], a[72:75], a[116:119], v[168:171]
    buffer_load_dwordx4 v237, s[8:11], s29 offen lds
    v_mfma_f32_16x16x32_bf16 v[172:175], a[72:75], a[120:123], v[172:175]
    ds_read_b64_tr_b16 a[58:59], v249 offset:512
    v_mfma_f32_16x16x32_bf16 a[136:139], a[124:127], a[72:75], a[136:139]
    ds_read_b64_tr_b16 a[60:61], v250 offset:0
    v_mfma_f32_16x16x32_bf16 v[40:43], a[100:103], a[76:79], v[40:43]
    buffer_load_dwordx4 v238, s[8:11], s29 offen offset:1024 lds
    v_mfma_f32_16x16x32_bf16 v[44:47], a[104:107], a[76:79], v[44:47]
    ds_read_b64_tr_b16 a[62:63], v250 offset:256
    v_mfma_f32_16x16x32_bf16 v[104:107], a[108:111], a[76:79], v[104:107]
    ds_read_b128 a[4:7], v240 offset:2048
    v_mfma_f32_16x16x32_bf16 v[108:111], a[112:115], a[76:79], v[108:111]
    s_add_u32 m0, s33, s34
    v_mfma_f32_16x16x32_bf16 v[176:179], a[76:79], a[116:119], v[176:179]
    ds_read_b128 a[8:11], v240 offset:4096
    v_mfma_f32_16x16x32_bf16 v[180:183], a[76:79], a[120:123], v[180:183]
    ds_read_b128 a[12:15], v240 offset:6144
    v_mfma_f32_16x16x32_bf16 a[140:143], a[124:127], a[76:79], a[140:143]
    buffer_load_dwordx4 v239, s[12:15], s30 offen lds
    v_mfma_f32_16x16x32_bf16 v[48:51], a[100:103], a[80:83], v[48:51]
    ds_read_b128 a[16:19], v240 offset:8192
    v_mfma_f32_16x16x32_bf16 v[52:55], a[104:107], a[80:83], v[52:55]
    ds_read_b128 a[20:23], v240 offset:10240
    v_mfma_f32_16x16x32_bf16 v[112:115], a[108:111], a[80:83], v[112:115]
    buffer_load_dword a160, v252, s[80:83], s84 offen
    v_mfma_f32_16x16x32_bf16 v[116:119], a[112:115], a[80:83], v[116:119]
    ds_read_b128 a[24:27], v240 offset:12288
    v_mfma_f32_16x16x32_bf16 v[184:187], a[80:83], a[116:119], v[184:187]
    ds_read_b128 a[28:31], v240 offset:14336
    v_mfma_f32_16x16x32_bf16 v[188:191], a[80:83], a[120:123], v[188:191]
    s_add_u32 s84, s84, 2816
    v_mfma_f32_16x16x32_bf16 a[144:147], a[124:127], a[80:83], a[144:147]
    ds_read_b128 a[32:35], v242
    v_mfma_f32_16x16x32_bf16 v[56:59], a[100:103], a[84:87], v[56:59]
    s_add_u32 s32, s32, s39
    v_mfma_f32_16x16x32_bf16 v[60:63], a[104:107], a[84:87], v[60:63]
    s_add_u32 s33, s33, s40
    v_mfma_f32_16x16x32_bf16 v[120:123], a[108:111], a[84:87], v[120:123]
    s_add_u32 s53, s53, 1
    v_mfma_f32_16x16x32_bf16 v[124:127], a[112:115], a[84:87], v[124:127]
    s_add_u32 s42, s53, s52
    v_mfma_f32_16x16x32_bf16 v[192:195], a[84:87], a[116:119], v[192:195]
    s_and_b32 s42, s42, 3
    v_mfma_f32_16x16x32_bf16 v[196:199], a[84:87], a[120:123], v[196:199]
    s_and_b32 s54, s53, -4
    v_mfma_f32_16x16x32_bf16 a[148:151], a[124:127], a[84:87], a[148:151]
    s_or_b32 s54, s54, s42
    v_mfma_f32_16x16x32_bf16 v[64:67], a[100:103], a[88:91], v[64:67]
    s_lshl_b32 s28, s54, 7
    v_mfma_f32_16x16x32_bf16 v[68:71], a[104:107], a[88:91], v[68:71]
    s_mul_i32 s29, s54, 393216
    v_mfma_f32_16x16x32_bf16 v[128:131], a[108:111], a[88:91], v[128:131]
    s_mul_i32 s30, s54, 458752
    v_mfma_f32_16x16x32_bf16 v[132:135], a[112:115], a[88:91], v[132:135]
    s_sub_u32 s40, 0, s40
    v_mfma_f32_16x16x32_bf16 v[200:203], a[88:91], a[116:119], v[200:203]
    s_mov_b32 s41, s37
    v_mfma_f32_16x16x32_bf16 v[204:207], a[88:91], a[120:123], v[204:207]
    s_mov_b32 s37, s38
    v_mfma_f32_16x16x32_bf16 a[152:155], a[124:127], a[88:91], a[152:155]
    s_mov_b32 s38, s39
    v_mfma_f32_16x16x32_bf16 v[72:75], a[100:103], a[92:95], v[72:75]
    s_mov_b32 s39, s41
    v_mfma_f32_16x16x32_bf16 v[76:79], a[104:107], a[92:95], v[76:79]
    v_mfma_f32_16x16x32_bf16 v[136:139], a[108:111], a[92:95], v[136:139]
    v_mfma_f32_16x16x32_bf16 v[140:143], a[112:115], a[92:95], v[140:143]
    v_mfma_f32_16x16x32_bf16 v[208:211], a[92:95], a[116:119], v[208:211]
    v_mfma_f32_16x16x32_bf16 v[212:215], a[92:95], a[120:123], v[212:215]
    v_mfma_f32_16x16x32_bf16 a[156:159], a[124:127], a[92:95], a[156:159]
    v_mfma_f32_16x16x32_bf16 v[144:147], a[108:111], a[96:99], v[144:147]
    v_mfma_f32_16x16x32_bf16 v[148:151], a[112:115], a[96:99], v[148:151]
    v_mfma_f32_16x16x32_bf16 v[216:219], a[96:99], a[116:119], v[216:219]
    v_mfma_f32_16x16x32_bf16 v[220:223], a[96:99], a[120:123], v[220:223]
    s_waitcnt lgkmcnt(0)
L_p1a_loop:
    v_mfma_f32_16x16x32_bf16 v[16:19], a[36:39], a[0:3], v[16:19]
    ds_read_b128 a[64:67], v241 offset:0
    v_mfma_f32_16x16x32_bf16 v[20:23], a[40:43], a[0:3], v[20:23]
    s_mov_b32 m0, s32
    v_mfma_f32_16x16x32_bf16 v[80:83], a[44:47], a[0:3], v[80:83]
    ds_read_b64_tr_b16 a[100:101], v244 offset:4096
    v_mfma_f32_16x16x32_bf16 v[84:87], a[48:51], a[0:3], v[84:87]
    ds_read_b64_tr_b16 a[102:103], v244 offset:4608
    v_mfma_f32_16x16x32_bf16 v[152:155], a[0:3], a[52:55], v[152:155]
    ds_read_b64_tr_b16 a[104:105], v245 offset:4096
    v_mfma_f32_16x16x32_bf16 v[156:159], a[0:3], a[56:59], v[156:159]
    buffer_load_dwordx4 v224, s[4:7], s28 offen lds
    v_mfma_f32_16x16x32_bf16 a[128:131], a[60:63], a[0:3], a[128:131]
    ds_read_b64_tr_b16 a[106:107], v245 offset:4608
    v_mfma_f32_16x16x32_bf16 v[24:27], a[36:39], a[4:7], v[24:27]
    ds_read_b64_tr_b16 a[108:109], v246 offset:4096
    v_mfma_f32_16x16x32_bf16 v[28:31], a[40:43], a[4:7], v[28:31]
    ds_read_b64_tr_b16 a[110:111], v246 offset:4608
    v_mfma_f32_16x16x32_bf16 v[88:91], a[44:47], a[4:7], v[88:91]
    buffer_load_dwordx4 v225, s[4:7], s28 offen offset:1024 lds
    v_mfma_f32_16x16x32_bf16 v[92:95], a[48:51], a[4:7], v[92:95]
    ds_read_b64_tr_b16 a[112:113], v247 offset:4096
    v_mfma_f32_16x16x32_bf16 v[160:163], a[4:7], a[52:55], v[160:163]
    ds_read_b64_tr_b16 a[114:115], v247 offset:4608
    v_mfma_f32_16x16x32_bf16 v[164:167], a[4:7], a[56:59], v[164:167]
    ds_read_b64_tr_b16 a[116:117], v248 offset:4096
    v_mfma_f32_16x16x32_bf16 a[132:135], a[60:63], a[4:7], a[132:135]
    buffer_load_dwordx4 v226, s[4:7], s28 offen offset:2048 lds
    v_mfma_f32_16x16x32_bf16 v[32:35], a[36:39], a[8:11], v[32:35]
    ds_read_b64_tr_b16 a[118:119], v248 offset:4608
    v_mfma_f32_16x16x32_bf16 v[36:39], a[40:43], a[8:11], v[36:39]
    ds_read_b64_tr_b16 a[120:121], v249 offset:4096
    v_mfma_f32_16x16x32_bf16 v[96:99], a[44:47], a[8:11], v[96:99]
    ds_read_b64_tr_b16 a[122:123], v249 offset:4608
    v_mfma_f32_16x16x32_bf16 v[100:103], a[48:51], a[8:11], v[100:103]
    buffer_load_dwordx4 v227, s[4:7], s28 offen offset:3072 lds
    v_mfma_f32_16x16x32_bf16 v[168:171], a[8:11], a[52:55], v[168:171]
    ds_read_b64_tr_b16 a[124:125], v250 offset:2048
    v_mfma_f32_16x16x32_bf16 v[172:175], a[8:11], a[56:59], v[172:175]
    ds_read_b64_tr_b16 a[126:127], v250 offset:2304
    v_mfma_f32_16x16x32_bf16 a[136:139], a[60:63], a[8:11], a[136:139]
    ds_read_b128 a[68:71], v241 offset:2048
    v_mfma_f32_16x16x32_bf16 v[40:43], a[36:39], a[12:15], v[40:43]
    s_add_u32 m0, s32, 4096
    v_mfma_f32_16x16x32_bf16 v[44:47], a[40:43], a[12:15], v[44:47]
    ds_read_b128 a[72:75], v241 offset:4096
    v_mfma_f32_16x16x32_bf16 v[104:107], a[44:47], a[12:15], v[104:107]
    ds_read_b128 a[76:79], v241 offset:6144
    v_mfma_f32_16x16x32_bf16 v[108:111], a[48:51], a[12:15], v[108:111]
    ds_read_b128 a[80:83], v241 offset:8192
    v_mfma_f32_16x16x32_bf16 v[176:179], a[12:15], a[52:55], v[176:179]
    buffer_load_dwordx4 v228, s[4:7], s28 offen lds
    v_mfma_f32_16x16x32_bf16 v[180:183], a[12:15], a[56:59], v[180:183]
    ds_read_b128 a[84:87], v241 offset:10240
    v_mfma_f32_16x16x32_bf16 a[140:143], a[60:63], a[12:15], a[140:143]
    ds_read_b128 a[88:91], v241 offset:12288
    v_mfma_f32_16x16x32_bf16 v[48:51], a[36:39], a[16:19], v[48:51]
    ds_read_b128 a[92:95], v241 offset:14336
    v_mfma_f32_16x16x32_bf16 v[52:55], a[40:43], a[16:19], v[52:55]
    buffer_load_dwordx4 v229, s[4:7], s28 offen offset:1024 lds
    v_mfma_f32_16x16x32_bf16 v[112:115], a[44:47], a[16:19], v[112:115]
    ds_read_b128 a[96:99], v243
    v_mfma_f32_16x16x32_bf16 v[116:119], a[48:51], a[16:19], v[116:119]
    v_add_u32 v241, s37, v241
    v_mfma_f32_16x16x32_bf16 v[184:187], a[16:19], a[52:55], v[184:187]
    v_add_u32 v240, s37, v240
    v_mfma_f32_16x16x32_bf16 v[188:191], a[16:19], a[56:59], v[188:191]
    buffer_load_dwordx4 v230, s[4:7], s28 offen offset:2048 lds
    v_mfma_f32_16x16x32_bf16 a[144:147], a[60:63], a[16:19], a[144:147]
    v_add_u32 v243, s37, v243
    v_mfma_f32_16x16x32_bf16 v[56:59], a[36:39], a[20:23], v[56:59]
    v_add_u32 v242, s37, v242
    v_mfma_f32_16x16x32_bf16 v[60:63], a[40:43], a[20:23], v[60:63]
    v_add_u32 v250, s40, v250
    v_mfma_f32_16x16x32_bf16 v[120:123], a[44:47], a[20:23], v[120:123]
    buffer_load_dwordx4 v231, s[4:7], s28 offen offset:3072 lds
    v_mfma_f32_16x16x32_bf16 v[124:127], a[48:51], a[20:23], v[124:127]
    v_add_u32 v244, s40, v244
    v_mfma_f32_16x16x32_bf16 v[192:195], a[20:23], a[52:55], v[192:195]
    v_add_u32 v245, s40, v245
    v_mfma_f32_16x16x32_bf16 v[196:199], a[20:23], a[56:59], v[196:199]
    v_add_u32 v246, s40, v246
    v_mfma_f32_16x16x32_bf16 a[148:151], a[60:63], a[20:23], a[148:151]
    s_add_u32 m0, s32, s35
    v_mfma_f32_16x16x32_bf16 v[64:67], a[36:39], a[24:27], v[64:67]
    v_add_u32 v247, s40, v247
    v_mfma_f32_16x16x32_bf16 v[68:71], a[40:43], a[24:27], v[68:71]
    v_add_u32 v248, s40, v248
    v_mfma_f32_16x16x32_bf16 v[128:131], a[44:47], a[24:27], v[128:131]
    v_add_u32 v249, s40, v249
    v_mfma_f32_16x16x32_bf16 v[132:135], a[48:51], a[24:27], v[132:135]
    s_mov_b32 exec_hi, 0
    buffer_load_dwordx4 v232, s[4:7], s28 offen lds
    s_mov_b32 exec_hi, -1
    v_mfma_f32_16x16x32_bf16 v[200:203], a[24:27], a[52:55], v[200:203]
    v_mfma_f32_16x16x32_bf16 v[204:207], a[24:27], a[56:59], v[204:207]
    v_mfma_f32_16x16x32_bf16 a[152:155], a[60:63], a[24:27], a[152:155]
    v_mfma_f32_16x16x32_bf16 v[72:75], a[36:39], a[28:31], v[72:75]
    v_mfma_f32_16x16x32_bf16 v[76:79], a[40:43], a[28:31], v[76:79]
    v_mfma_f32_16x16x32_bf16 v[136:139], a[44:47], a[28:31], v[136:139]
    v_mfma_f32_16x16x32_bf16 v[140:143], a[48:51], a[28:31], v[140:143]
    v_mfma_f32_16x16x32_bf16 v[208:211], a[28:31], a[52:55], v[208:211]
    v_mfma_f32_16x16x32_bf16 v[212:215], a[28:31], a[56:59], v[212:215]
    v_mfma_f32_16x16x32_bf16 a[156:159], a[60:63], a[28:31], a[156:159]
    v_mfma_f32_16x16x32_bf16 v[144:147], a[44:47], a[32:35], v[144:147]
    v_mfma_f32_16x16x32_bf16 v[148:151], a[48:51], a[32:35], v[148:151]
    v_mfma_f32_16x16x32_bf16 v[216:219], a[32:35], a[52:55], v[216:219]
    v_mfma_f32_16x16x32_bf16 v[220:223], a[32:35], a[56:59], v[220:223]
    s_waitcnt vmcnt(10) lgkmcnt(0)
    s_barrier
    v_mfma_f32_16x16x32_bf16 v[16:19], a[100:103], a[64:67], v[16:19]
    s_mov_b32 m0, s33
    v_mfma_f32_16x16x32_bf16 v[20:23], a[104:107], a[64:67], v[20:23]
    ds_read_b128 a[0:3], v240 offset:0
    v_mfma_f32_16x16x32_bf16 v[80:83], a[108:111], a[64:67], v[80:83]
    ds_read_b64_tr_b16 a[36:37], v244 offset:0
    v_mfma_f32_16x16x32_bf16 v[84:87], a[112:115], a[64:67], v[84:87]
    buffer_load_dwordx4 v233, s[8:11], s29 offen lds
    v_mfma_f32_16x16x32_bf16 v[152:155], a[64:67], a[116:119], v[152:155]
    ds_read_b64_tr_b16 a[38:39], v244 offset:512
    v_mfma_f32_16x16x32_bf16 v[156:159], a[64:67], a[120:123], v[156:159]
    ds_read_b64_tr_b16 a[40:41], v245 offset:0
    v_mfma_f32_16x16x32_bf16 a[128:131], a[124:127], a[64:67], a[128:131]
    buffer_load_dwordx4 v234, s[8:11], s29 offen offset:1024 lds
    v_mfma_f32_16x16x32_bf16 v[24:27], a[100:103], a[68:71], v[24:27]
    ds_read_b64_tr_b16 a[42:43], v245 offset:512
    v_mfma_f32_16x16x32_bf16 v[28:31], a[104:107], a[68:71], v[28:31]
    ds_read_b64_tr_b16 a[44:45], v246 offset:0
    v_mfma_f32_16x16x32_bf16 v[88:91], a[108:111], a[68:71], v[88:91]
    buffer_load_dwordx4 v235, s[8:11], s29 offen offset:2048 lds
    v_mfma_f32_16x16x32_bf16 v[92:95], a[112:115], a[68:71], v[92:95]
    ds_read_b64_tr_b16 a[46:47], v246 offset:512
    v_mfma_f32_16x16x32_bf16 v[160:163], a[68:71], a[116:119], v[160:163]
    ds_read_b64_tr_b16 a[48:49], v247 offset:0
    v_mfma_f32_16x16x32_bf16 v[164:167], a[68:71], a[120:123], v[164:167]
    buffer_load_dwordx4 v236, s[8:11], s29 offen offset:3072 lds
    v_mfma_f32_16x16x32_bf16 a[132:135], a[124:127], a[68:71], a[132:135]
    ds_read_b64_tr_b16 a[50:51], v247 offset:512
    v_mfma_f32_16x16x32_bf16 v[32:35], a[100:103], a[72:75], v[32:35]
    ds_read_b64_tr_b16 a[52:53], v248 offset:0
    v_mfma_f32_16x16x32_bf16 v[36:39], a[104:107], a[72:75], v[36:39]
    s_add_u32 m0, s33, 4096
    v_mfma_f32_16x16x32_bf16 v[96:99], a[108:111], a[72:75], v[96:99]
    ds_read_b64_tr_b16 a[54:55], v248 offset:512
    v_mfma_f32_16x16x32_bf16 v[100:103], a[112:115], a[72:75], v[100:103]
    ds_read_b64_tr_b16 a[56:57], v249 offset:0
    v_mfma_f32_16x16x32_bf16 v[168:171], a[72:75], a[116:119], v[168:171]
    buffer_load_dwordx4 v237, s[8:11], s29 offen lds
    v_mfma_f32_16x16x32_bf16 v[172:175], a[72:75], a[120:123], v[172:175]
    ds_read_b64_tr_b16 a[58:59], v249 offset:512
    v_mfma_f32_16x16x32_bf16 a[136:139], a[124:127], a[72:75], a[136:139]
    ds_read_b64_tr_b16 a[60:61], v250 offset:0
    v_mfma_f32_16x16x32_bf16 v[40:43], a[100:103], a[76:79], v[40:43]
    buffer_load_dwordx4 v238, s[8:11], s29 offen offset:1024 lds
    v_mfma_f32_16x16x32_bf16 v[44:47], a[104:107], a[76:79], v[44:47]
    ds_read_b64_tr_b16 a[62:63], v250 offset:256
    v_mfma_f32_16x16x32_bf16 v[104:107], a[108:111], a[76:79], v[104:107]
    ds_read_b128 a[4:7], v240 offset:2048
    v_mfma_f32_16x16x32_bf16 v[108:111], a[112:115], a[76:79], v[108:111]
    s_add_u32 m0, s33, s34
    v_mfma_f32_16x16x32_bf16 v[176:179], a[76:79], a[116:119], v[176:179]
    ds_read_b128 a[8:11], v240 offset:4096
    v_mfma_f32_16x16x32_bf16 v[180:183], a[76:79], a[120:123], v[180:183]
    ds_read_b128 a[12:15], v240 offset:6144
    v_mfma_f32_16x16x32_bf16 a[140:143], a[124:127], a[76:79], a[140:143]
    buffer_load_dwordx4 v239, s[12:15], s30 offen lds
    v_mfma_f32_16x16x32_bf16 v[48:51], a[100:103], a[80:83], v[48:51]
    ds_read_b128 a[16:19], v240 offset:8192
    v_mfma_f32_16x16x32_bf16 v[52:55], a[104:107], a[80:83], v[52:55]
    ds_read_b128 a[20:23], v240 offset:10240
    v_mfma_f32_16x16x32_bf16 v[112:115], a[108:111], a[80:83], v[112:115]
    buffer_load_dword a160, v252, s[80:83], s84 offen
    v_mfma_f32_16x16x32_bf16 v[116:119], a[112:115], a[80:83], v[116:119]
    ds_read_b128 a[24:27], v240 offset:12288
    v_mfma_f32_16x16x32_bf16 v[184:187], a[80:83], a[116:119], v[184:187]
    ds_read_b128 a[28:31], v240 offset:14336
    v_mfma_f32_16x16x32_bf16 v[188:191], a[80:83], a[120:123], v[188:191]
    s_add_u32 s84, s84, 2816
    v_mfma_f32_16x16x32_bf16 a[144:147], a[124:127], a[80:83], a[144:147]
    ds_read_b128 a[32:35], v242
    v_mfma_f32_16x16x32_bf16 v[56:59], a[100:103], a[84:87], v[56:59]
    s_add_u32 s32, s32, s39
    v_mfma_f32_16x16x32_bf16 v[60:63], a[104:107], a[84:87], v[60:63]
    s_add_u32 s33, s33, s40
    v_mfma_f32_16x16x32_bf16 v[120:123], a[108:111], a[84:87], v[120:123]
    s_add_u32 s53, s53, 1
    v_mfma_f32_16x16x32_bf16 v[124:127], a[112:115], a[84:87], v[124:127]
    s_add_u32 s42, s53, s52
    v_mfma_f32_16x16x32_bf16 v[192:195], a[84:87], a[116:119], v[192:195]
    s_and_b32 s42, s42, 3
    v_mfma_f32_16x16x32_bf16 v[196:199], a[84:87], a[120:123], v[196:199]
    s_and_b32 s54, s53, -4
    v_mfma_f32_16x16x32_bf16 a[148:151], a[124:127], a[84:87], a[148:151]
    s_or_b32 s54, s54, s42
    v_mfma_f32_16x16x32_bf16 v[64:67], a[100:103], a[88:91], v[64:67]
    s_lshl_b32 s28, s54, 7
    v_mfma_f32_16x16x32_bf16 v[68:71], a[104:107], a[88:91], v[68:71]
    s_mul_i32 s29, s54, 393216
    v_mfma_f32_16x16x32_bf16 v[128:131], a[108:111], a[88:91], v[128:131]
    s_mul_i32 s30, s54, 458752
    v_mfma_f32_16x16x32_bf16 v[132:135], a[112:115], a[88:91], v[132:135]
    s_sub_u32 s40, 0, s40
    v_mfma_f32_16x16x32_bf16 v[200:203], a[88:91], a[116:119], v[200:203]
    s_mov_b32 s41, s37
    v_mfma_f32_16x16x32_bf16 v[204:207], a[88:91], a[120:123], v[204:207]
    s_mov_b32 s37, s38
    v_mfma_f32_16x16x32_bf16 a[152:155], a[124:127], a[88:91], a[152:155]
    s_mov_b32 s38, s39
    v_mfma_f32_16x16x32_bf16 v[72:75], a[100:103], a[92:95], v[72:75]
    s_mov_b32 s39, s41
    v_mfma_f32_16x16x32_bf16 v[76:79], a[104:107], a[92:95], v[76:79]
    s_add_u32 s36, s36, 1
    v_mfma_f32_16x16x32_bf16 v[136:139], a[108:111], a[92:95], v[136:139]
    v_mfma_f32_16x16x32_bf16 v[140:143], a[112:115], a[92:95], v[140:143]
    v_mfma_f32_16x16x32_bf16 v[208:211], a[92:95], a[116:119], v[208:211]
    v_mfma_f32_16x16x32_bf16 v[212:215], a[92:95], a[120:123], v[212:215]
    v_mfma_f32_16x16x32_bf16 a[156:159], a[124:127], a[92:95], a[156:159]
    v_mfma_f32_16x16x32_bf16 v[144:147], a[108:111], a[96:99], v[144:147]
    v_mfma_f32_16x16x32_bf16 v[148:151], a[112:115], a[96:99], v[148:151]
    v_mfma_f32_16x16x32_bf16 v[216:219], a[96:99], a[116:119], v[216:219]
    v_mfma_f32_16x16x32_bf16 v[220:223], a[96:99], a[120:123], v[220:223]
    s_waitcnt lgkmcnt(0)
    s_cmp_lt_u32 s36, 13
    s_cbranch_scc1 L_p1a_loop
    v_mfma_f32_16x16x32_bf16 v[16:19], a[36:39], a[0:3], v[16:19]
    ds_read_b128 a[64:67], v241 offset:0
    v_mfma_f32_16x16x32_bf16 v[20:23], a[40:43], a[0:3], v[20:23]
    ds_read_b64_tr_b16 a[100:101], v244 offset:4096
    v_mfma_f32_16x16x32_bf16 v[80:83], a[44:47], a[0:3], v[80:83]
    ds_read_b64_tr_b16 a[102:103], v244 offset:4608
    v_mfma_f32_16x16x32_bf16 v[84:87], a[48:51], a[0:3], v[84:87]
    ds_read_b64_tr_b16 a[104:105], v245 offset:4096
    v_mfma_f32_16x16x32_bf16 v[152:155], a[0:3], a[52:55], v[152:155]
    ds_read_b64_tr_b16 a[106:107], v245 offset:4608
    v_mfma_f32_16x16x32_bf16 v[156:159], a[0:3], a[56:59], v[156:159]
    ds_read_b64_tr_b16 a[108:109], v246 offset:4096
    v_mfma_f32_16x16x32_bf16 a[128:131], a[60:63], a[0:3], a[128:131]
    ds_read_b64_tr_b16 a[110:111], v246 offset:4608
    v_mfma_f32_16x16x32_bf16 v[24:27], a[36:39], a[4:7], v[24:27]
    ds_read_b64_tr_b16 a[112:113], v247 offset:4096
    v_mfma_f32_16x16x32_bf16 v[28:31], a[40:43], a[4:7], v[28:31]
    ds_read_b64_tr_b16 a[114:115], v247 offset:4608
    v_mfma_f32_16x16x32_bf16 v[88:91], a[44:47], a[4:7], v[88:91]
    ds_read_b64_tr_b16 a[116:117], v248 offset:4096
    v_mfma_f32_16x16x32_bf16 v[92:95], a[48:51], a[4:7], v[92:95]
    ds_read_b64_tr_b16 a[118:119], v248 offset:4608
    v_mfma_f32_16x16x32_bf16 v[160:163], a[4:7], a[52:55], v[160:163]
    ds_read_b64_tr_b16 a[120:121], v249 offset:4096
    v_mfma_f32_16x16x32_bf16 v[164:167], a[4:7], a[56:59], v[164:167]
    ds_read_b64_tr_b16 a[122:123], v249 offset:4608
    v_mfma_f32_16x16x32_bf16 a[132:135], a[60:63], a[4:7], a[132:135]
    ds_read_b64_tr_b16 a[124:125], v250 offset:2048
    v_mfma_f32_16x16x32_bf16 v[32:35], a[36:39], a[8:11], v[32:35]
    ds_read_b64_tr_b16 a[126:127], v250 offset:2304
    v_mfma_f32_16x16x32_bf16 v[36:39], a[40:43], a[8:11], v[36:39]
    ds_read_b128 a[68:71], v241 offset:2048
    v_mfma_f32_16x16x32_bf16 v[96:99], a[44:47], a[8:11], v[96:99]
    ds_read_b128 a[72:75], v241 offset:4096
    v_mfma_f32_16x16x32_bf16 v[100:103], a[48:51], a[8:11], v[100:103]
    ds_read_b128 a[76:79], v241 offset:6144
    v_mfma_f32_16x16x32_bf16 v[168:171], a[8:11], a[52:55], v[168:171]
    ds_read_b128 a[80:83], v241 offset:8192
    v_mfma_f32_16x16x32_bf16 v[172:175], a[8:11], a[56:59], v[172:175]
    ds_read_b128 a[84:87], v241 offset:10240
    v_mfma_f32_16x16x32_bf16 a[136:139], a[60:63], a[8:11], a[136:139]
    ds_read_b128 a[88:91], v241 offset:12288
    v_mfma_f32_16x16x32_bf16 v[40:43], a[36:39], a[12:15], v[40:43]
    ds_read_b128 a[92:95], v241 offset:14336
    v_mfma_f32_16x16x32_bf16 v[44:47], a[40:43], a[12:15], v[44:47]
    ds_read_b128 a[96:99], v243
    v_mfma_f32_16x16x32_bf16 v[104:107], a[44:47], a[12:15], v[104:107]
    v_add_u32 v241, s37, v241
    v_mfma_f32_16x16x32_bf16 v[108:111], a[48:51], a[12:15], v[108:111]
    v_add_u32 v240, s37, v240
    v_mfma_f32_16x16x32_bf16 v[176:179], a[12:15], a[52:55], v[176:179]
    v_add_u32 v243, s37, v243
    v_mfma_f32_16x16x32_bf16 v[180:183], a[12:15], a[56:59], v[180:183]
    v_add_u32 v242, s37, v242
    v_mfma_f32_16x16x32_bf16 a[140:143], a[60:63], a[12:15], a[140:143]
    v_add_u32 v250, s40, v250
    v_mfma_f32_16x16x32_bf16 v[48:51], a[36:39], a[16:19], v[48:51]
    v_add_u32 v244, s40, v244
    v_mfma_f32_16x16x32_bf16 v[52:55], a[40:43], a[16:19], v[52:55]
    v_add_u32 v245, s40, v245
    v_mfma_f32_16x16x32_bf16 v[112:115], a[44:47], a[16:19], v[112:115]
    v_add_u32 v246, s40, v246
    v_mfma_f32_16x16x32_bf16 v[116:119], a[48:51], a[16:19], v[116:119]
    v_add_u32 v247, s40, v247
    v_mfma_f32_16x16x32_bf16 v[184:187], a[16:19], a[52:55], v[184:187]
    v_add_u32 v248, s40, v248
    v_mfma_f32_16x16x32_bf16 v[188:191], a[16:19], a[56:59], v[188:191]
    v_add_u32 v249, s40, v249
    v_mfma_f32_16x16x32_bf16 a[144:147], a[60:63], a[16:19], a[144:147]
    v_mfma_f32_16x16x32_bf16 v[56:59], a[36:39], a[20:23], v[56:59]
    v_mfma_f32_16x16x32_bf16 v[60:63], a[40:43], a[20:23], v[60:63]
    v_mfma_f32_16x16x32_bf16 v[120:123], a[44:47], a[20:23], v[120:123]
    v_mfma_f32_16x16x32_bf16 v[124:127], a[48:51], a[20:23], v[124:127]
    v_mfma_f32_16x16x32_bf16 v[192:195], a[20:23], a[52:55], v[192:195]
    v_mfma_f32_16x16x32_bf16 v[196:199], a[20:23], a[56:59], v[196:199]
    v_mfma_f32_16x16x32_bf16 a[148:151], a[60:63], a[20:23], a[148:151]
    v_mfma_f32_16x16x32_bf16 v[64:67], a[36:39], a[24:27], v[64:67]
    v_mfma_f32_16x16x32_bf16 v[68:71], a[40:43], a[24:27], v[68:71]
    v_mfma_f32_16x16x32_bf16 v[128:131], a[44:47], a[24:27], v[128:131]
    v_mfma_f32_16x16x32_bf16 v[132:135], a[48:51], a[24:27], v[132:135]
    v_mfma_f32_16x16x32_bf16 v[200:203], a[24:27], a[52:55], v[200:203]
    v_mfma_f32_16x16x32_bf16 v[204:207], a[24:27], a[56:59], v[204:207]
    v_mfma_f32_16x16x32_bf16 a[152:155], a[60:63], a[24:27], a[152:155]
    v_mfma_f32_16x16x32_bf16 v[72:75], a[36:39], a[28:31], v[72:75]
    v_mfma_f32_16x16x32_bf16 v[76:79], a[40:43], a[28:31], v[76:79]
    v_mfma_f32_16x16x32_bf16 v[136:139], a[44:47], a[28:31], v[136:139]
    v_mfma_f32_16x16x32_bf16 v[140:143], a[48:51], a[28:31], v[140:143]
    v_mfma_f32_16x16x32_bf16 v[208:211], a[28:31], a[52:55], v[208:211]
    v_mfma_f32_16x16x32_bf16 v[212:215], a[28:31], a[56:59], v[212:215]
    v_mfma_f32_16x16x32_bf16 a[156:159], a[60:63], a[28:31], a[156:159]
    v_mfma_f32_16x16x32_bf16 v[144:147], a[44:47], a[32:35], v[144:147]
    v_mfma_f32_16x16x32_bf16 v[148:151], a[48:51], a[32:35], v[148:151]
    v_mfma_f32_16x16x32_bf16 v[216:219], a[32:35], a[52:55], v[216:219]
    v_mfma_f32_16x16x32_bf16 v[220:223], a[32:35], a[56:59], v[220:223]
    s_waitcnt vmcnt(1) lgkmcnt(0)
    s_barrier
    v_mfma_f32_16x16x32_bf16 v[16:19], a[100:103], a[64:67], v[16:19]
    ds_read_b128 a[0:3], v240 offset:0
    v_mfma_f32_16x16x32_bf16 v[20:23], a[104:107], a[64:67], v[20:23]
    ds_read_b64_tr_b16 a[36:37], v244 offset:0
    v_mfma_f32_16x16x32_bf16 v[80:83], a[108:111], a[64:67], v[80:83]
    ds_read_b64_tr_b16 a[38:39], v244 offset:512
    v_mfma_f32_16x16x32_bf16 v[84:87], a[112:115], a[64:67], v[84:87]
    ds_read_b64_tr_b16 a[40:41], v245 offset:0
    v_mfma_f32_16x16x32_bf16 v[152:155], a[64:67], a[116:119], v[152:155]
    ds_read_b64_tr_b16 a[42:43], v245 offset:512
    v_mfma_f32_16x16x32_bf16 v[156:159], a[64:67], a[120:123], v[156:159]
    ds_read_b64_tr_b16 a[44:45], v246 offset:0
    v_mfma_f32_16x16x32_bf16 a[128:131], a[124:127], a[64:67], a[128:131]
    ds_read_b64_tr_b16 a[46:47], v246 offset:512
    v_mfma_f32_16x16x32_bf16 v[24:27], a[100:103], a[68:71], v[24:27]
    ds_read_b64_tr_b16 a[48:49], v247 offset:0
    v_mfma_f32_16x16x32_bf16 v[28:31], a[104:107], a[68:71], v[28:31]
    ds_read_b64_tr_b16 a[50:51], v247 offset:512
    v_mfma_f32_16x16x32_bf16 v[88:91], a[108:111], a[68:71], v[88:91]
    ds_read_b64_tr_b16 a[52:53], v248 offset:0
    v_mfma_f32_16x16x32_bf16 v[92:95], a[112:115], a[68:71], v[92:95]
    ds_read_b64_tr_b16 a[54:55], v248 offset:512
    v_mfma_f32_16x16x32_bf16 v[160:163], a[68:71], a[116:119], v[160:163]
    ds_read_b64_tr_b16 a[56:57], v249 offset:0
    v_mfma_f32_16x16x32_bf16 v[164:167], a[68:71], a[120:123], v[164:167]
    ds_read_b64_tr_b16 a[58:59], v249 offset:512
    v_mfma_f32_16x16x32_bf16 a[132:135], a[124:127], a[68:71], a[132:135]
    ds_read_b64_tr_b16 a[60:61], v250 offset:0
    v_mfma_f32_16x16x32_bf16 v[32:35], a[100:103], a[72:75], v[32:35]
    ds_read_b64_tr_b16 a[62:63], v250 offset:256
    v_mfma_f32_16x16x32_bf16 v[36:39], a[104:107], a[72:75], v[36:39]
    ds_read_b128 a[4:7], v240 offset:2048
    v_mfma_f32_16x16x32_bf16 v[96:99], a[108:111], a[72:75], v[96:99]
    ds_read_b128 a[8:11], v240 offset:4096
    v_mfma_f32_16x16x32_bf16 v[100:103], a[112:115], a[72:75], v[100:103]
    ds_read_b128 a[12:15], v240 offset:6144
    v_mfma_f32_16x16x32_bf16 v[168:171], a[72:75], a[116:119], v[168:171]
    ds_read_b128 a[16:19], v240 offset:8192
    v_mfma_f32_16x16x32_bf16 v[172:175], a[72:75], a[120:123], v[172:175]
    ds_read_b128 a[20:23], v240 offset:10240
    v_mfma_f32_16x16x32_bf16 a[136:139], a[124:127], a[72:75], a[136:139]
    ds_read_b128 a[24:27], v240 offset:12288
    v_mfma_f32_16x16x32_bf16 v[40:43], a[100:103], a[76:79], v[40:43]
    ds_read_b128 a[28:31], v240 offset:14336
    v_mfma_f32_16x16x32_bf16 v[44:47], a[104:107], a[76:79], v[44:47]
    ds_read_b128 a[32:35], v242
    v_mfma_f32_16x16x32_bf16 v[104:107], a[108:111], a[76:79], v[104:107]
    s_sub_u32 s40, 0, s40
    v_mfma_f32_16x16x32_bf16 v[108:111], a[112:115], a[76:79], v[108:111]
    s_mov_b32 s41, s37
    v_mfma_f32_16x16x32_bf16 v[176:179], a[76:79], a[116:119], v[176:179]
    s_mov_b32 s37, s38
    v_mfma_f32_16x16x32_bf16 v[180:183], a[76:79], a[120:123], v[180:183]
    s_mov_b32 s38, s39
    v_mfma_f32_16x16x32_bf16 a[140:143], a[124:127], a[76:79], a[140:143]
    s_mov_b32 s39, s41
    v_mfma_f32_16x16x32_bf16 v[48:51], a[100:103], a[80:83], v[48:51]
    v_mov_b32 v226, 0
    v_mfma_f32_16x16x32_bf16 v[52:55], a[104:107], a[80:83], v[52:55]
    buffer_load_dword v251, v226, s[20:23], 0 offen sc1
    v_mfma_f32_16x16x32_bf16 v[112:115], a[108:111], a[80:83], v[112:115]
    v_mfma_f32_16x16x32_bf16 v[116:119], a[112:115], a[80:83], v[116:119]
    v_mfma_f32_16x16x32_bf16 v[184:187], a[80:83], a[116:119], v[184:187]
    v_mfma_f32_16x16x32_bf16 v[188:191], a[80:83], a[120:123], v[188:191]
    v_mfma_f32_16x16x32_bf16 a[144:147], a[124:127], a[80:83], a[144:147]
    v_mfma_f32_16x16x32_bf16 v[56:59], a[100:103], a[84:87], v[56:59]
    v_mfma_f32_16x16x32_bf16 v[60:63], a[104:107], a[84:87], v[60:63]
    v_mfma_f32_16x16x32_bf16 v[120:123], a[108:111], a[84:87], v[120:123]
    v_mfma_f32_16x16x32_bf16 v[124:127], a[112:115], a[84:87], v[124:127]
    v_mfma_f32_16x16x32_bf16 v[192:195], a[84:87], a[116:119], v[192:195]
    v_mfma_f32_16x16x32_bf16 v[196:199], a[84:87], a[120:123], v[196:199]
    v_mfma_f32_16x16x32_bf16 a[148:151], a[124:127], a[84:87], a[148:151]
    v_mfma_f32_16x16x32_bf16 v[64:67], a[100:103], a[88:91], v[64:67]
    v_mfma_f32_16x16x32_bf16 v[68:71], a[104:107], a[88:91], v[68:71]
    v_mfma_f32_16x16x32_bf16 v[128:131], a[108:111], a[88:91], v[128:131]
    v_mfma_f32_16x16x32_bf16 v[132:135], a[112:115], a[88:91], v[132:135]
    v_mfma_f32_16x16x32_bf16 v[200:203], a[88:91], a[116:119], v[200:203]
    v_mfma_f32_16x16x32_bf16 v[204:207], a[88:91], a[120:123], v[204:207]
    v_mfma_f32_16x16x32_bf16 a[152:155], a[124:127], a[88:91], a[152:155]
    v_mfma_f32_16x16x32_bf16 v[72:75], a[100:103], a[92:95], v[72:75]
    v_mfma_f32_16x16x32_bf16 v[76:79], a[104:107], a[92:95], v[76:79]
    v_mfma_f32_16x16x32_bf16 v[136:139], a[108:111], a[92:95], v[136:139]
    v_mfma_f32_16x16x32_bf16 v[140:143], a[112:115], a[92:95], v[140:143]
    v_mfma_f32_16x16x32_bf16 v[208:211], a[92:95], a[116:119], v[208:211]
    v_mfma_f32_16x16x32_bf16 v[212:215], a[92:95], a[120:123], v[212:215]
    v_mfma_f32_16x16x32_bf16 a[156:159], a[124:127], a[92:95], a[156:159]
    v_mfma_f32_16x16x32_bf16 v[144:147], a[108:111], a[96:99], v[144:147]
    v_mfma_f32_16x16x32_bf16 v[148:151], a[112:115], a[96:99], v[148:151]
    v_mfma_f32_16x16x32_bf16 v[216:219], a[96:99], a[116:119], v[216:219]
    v_mfma_f32_16x16x32_bf16 v[220:223], a[96:99], a[120:123], v[220:223]
    s_waitcnt lgkmcnt(0)
    v_mfma_f32_16x16x32_bf16 v[16:19], a[36:39], a[0:3], v[16:19]
    ds_read_b128 a[64:67], v241 offset:0
    v_mfma_f32_16x16x32_bf16 v[20:23], a[40:43], a[0:3], v[20:23]
    ds_read_b64_tr_b16 a[100:101], v244 offset:4096
    v_mfma_f32_16x16x32_bf16 v[80:83], a[44:47], a[0:3], v[80:83]
    ds_read_b64_tr_b16 a[102:103], v244 offset:4608
    v_mfma_f32_16x16x32_bf16 v[84:87], a[48:51], a[0:3], v[84:87]
    ds_read_b64_tr_b16 a[104:105], v245 offset:4096
    v_mfma_f32_16x16x32_bf16 v[152:155], a[0:3], a[52:55], v[152:155]
    ds_read_b64_tr_b16 a[106:107], v245 offset:4608
    v_mfma_f32_16x16x32_bf16 v[156:159], a[0:3], a[56:59], v[156:159]
    ds_read_b64_tr_b16 a[108:109], v246 offset:4096
    v_mfma_f32_16x16x32_bf16 a[128:131], a[60:63], a[0:3], a[128:131]
    ds_read_b64_tr_b16 a[110:111], v246 offset:4608
    v_mfma_f32_16x16x32_bf16 v[24:27], a[36:39], a[4:7], v[24:27]
    ds_read_b64_tr_b16 a[112:113], v247 offset:4096
    v_mfma_f32_16x16x32_bf16 v[28:31], a[40:43], a[4:7], v[28:31]
    ds_read_b64_tr_b16 a[114:115], v247 offset:4608
    v_mfma_f32_16x16x32_bf16 v[88:91], a[44:47], a[4:7], v[88:91]
    ds_read_b64_tr_b16 a[116:117], v248 offset:4096
    v_mfma_f32_16x16x32_bf16 v[92:95], a[48:51], a[4:7], v[92:95]
    ds_read_b64_tr_b16 a[118:119], v248 offset:4608
    v_mfma_f32_16x16x32_bf16 v[160:163], a[4:7], a[52:55], v[160:163]
    ds_read_b64_tr_b16 a[120:121], v249 offset:4096
    v_mfma_f32_16x16x32_bf16 v[164:167], a[4:7], a[56:59], v[164:167]
    ds_read_b64_tr_b16 a[122:123], v249 offset:4608
    v_mfma_f32_16x16x32_bf16 a[132:135], a[60:63], a[4:7], a[132:135]
    ds_read_b64_tr_b16 a[124:125], v250 offset:2048
    v_mfma_f32_16x16x32_bf16 v[32:35], a[36:39], a[8:11], v[32:35]
    ds_read_b64_tr_b16 a[126:127], v250 offset:2304
    v_mfma_f32_16x16x32_bf16 v[36:39], a[40:43], a[8:11], v[36:39]
    ds_read_b128 a[68:71], v241 offset:2048
    v_mfma_f32_16x16x32_bf16 v[96:99], a[44:47], a[8:11], v[96:99]
    ds_read_b128 a[72:75], v241 offset:4096
    v_mfma_f32_16x16x32_bf16 v[100:103], a[48:51], a[8:11], v[100:103]
    ds_read_b128 a[76:79], v241 offset:6144
    v_mfma_f32_16x16x32_bf16 v[168:171], a[8:11], a[52:55], v[168:171]
    ds_read_b128 a[80:83], v241 offset:8192
    v_mfma_f32_16x16x32_bf16 v[172:175], a[8:11], a[56:59], v[172:175]
    ds_read_b128 a[84:87], v241 offset:10240
    v_mfma_f32_16x16x32_bf16 a[136:139], a[60:63], a[8:11], a[136:139]
    ds_read_b128 a[88:91], v241 offset:12288
    v_mfma_f32_16x16x32_bf16 v[40:43], a[36:39], a[12:15], v[40:43]
    ds_read_b128 a[92:95], v241 offset:14336
    v_mfma_f32_16x16x32_bf16 v[44:47], a[40:43], a[12:15], v[44:47]
    ds_read_b128 a[96:99], v243
    v_mfma_f32_16x16x32_bf16 v[104:107], a[44:47], a[12:15], v[104:107]
    v_mfma_f32_16x16x32_bf16 v[108:111], a[48:51], a[12:15], v[108:111]
    v_mfma_f32_16x16x32_bf16 v[176:179], a[12:15], a[52:55], v[176:179]
    v_mfma_f32_16x16x32_bf16 v[180:183], a[12:15], a[56:59], v[180:183]
    v_mfma_f32_16x16x32_bf16 a[140:143], a[60:63], a[12:15], a[140:143]
    v_mfma_f32_16x16x32_bf16 v[48:51], a[36:39], a[16:19], v[48:51]
    v_mfma_f32_16x16x32_bf16 v[52:55], a[40:43], a[16:19], v[52:55]
    v_mfma_f32_16x16x32_bf16 v[112:115], a[44:47], a[16:19], v[112:115]
    v_mfma_f32_16x16x32_bf16 v[116:119], a[48:51], a[16:19], v[116:119]
    v_mfma_f32_16x16x32_bf16 v[184:187], a[16:19], a[52:55], v[184:187]
    v_mfma_f32_16x16x32_bf16 v[188:191], a[16:19], a[56:59], v[188:191]
    v_mfma_f32_16x16x32_bf16 a[144:147], a[60:63], a[16:19], a[144:147]
    v_mfma_f32_16x16x32_bf16 v[56:59], a[36:39], a[20:23], v[56:59]
    v_mfma_f32_16x16x32_bf16 v[60:63], a[40:43], a[20:23], v[60:63]
    v_mfma_f32_16x16x32_bf16 v[120:123], a[44:47], a[20:23], v[120:123]
    v_mfma_f32_16x16x32_bf16 v[124:127], a[48:51], a[20:23], v[124:127]
    v_mfma_f32_16x16x32_bf16 v[192:195], a[20:23], a[52:55], v[192:195]
    v_mfma_f32_16x16x32_bf16 v[196:199], a[20:23], a[56:59], v[196:199]
    v_mfma_f32_16x16x32_bf16 a[148:151], a[60:63], a[20:23], a[148:151]
    v_mfma_f32_16x16x32_bf16 v[64:67], a[36:39], a[24:27], v[64:67]
    v_mfma_f32_16x16x32_bf16 v[68:71], a[40:43], a[24:27], v[68:71]
    v_mfma_f32_16x16x32_bf16 v[128:131], a[44:47], a[24:27], v[128:131]
    v_mfma_f32_16x16x32_bf16 v[132:135], a[48:51], a[24:27], v[132:135]
    v_mfma_f32_16x16x32_bf16 v[200:203], a[24:27], a[52:55], v[200:203]
    v_mfma_f32_16x16x32_bf16 v[204:207], a[24:27], a[56:59], v[204:207]
    v_mfma_f32_16x16x32_bf16 a[152:155], a[60:63], a[24:27], a[152:155]
    v_mfma_f32_16x16x32_bf16 v[72:75], a[36:39], a[28:31], v[72:75]
    v_mfma_f32_16x16x32_bf16 v[76:79], a[40:43], a[28:31], v[76:79]
    v_mfma_f32_16x16x32_bf16 v[136:139], a[44:47], a[28:31], v[136:139]
    v_mfma_f32_16x16x32_bf16 v[140:143], a[48:51], a[28:31], v[140:143]
    v_mfma_f32_16x16x32_bf16 v[208:211], a[28:31], a[52:55], v[208:211]
    v_mfma_f32_16x16x32_bf16 v[212:215], a[28:31], a[56:59], v[212:215]
    v_mfma_f32_16x16x32_bf16 a[156:159], a[60:63], a[28:31], a[156:159]
    v_mfma_f32_16x16x32_bf16 v[144:147], a[44:47], a[32:35], v[144:147]
    v_mfma_f32_16x16x32_bf16 v[148:151], a[48:51], a[32:35], v[148:151]
    v_mfma_f32_16x16x32_bf16 v[216:219], a[32:35], a[52:55], v[216:219]
    v_mfma_f32_16x16x32_bf16 v[220:223], a[32:35], a[56:59], v[220:223]
    s_waitcnt lgkmcnt(0)
    v_mfma_f32_16x16x32_bf16 v[16:19], a[100:103], a[64:67], v[16:19]
    v_mfma_f32_16x16x32_bf16 v[20:23], a[104:107], a[64:67], v[20:23]
    v_mfma_f32_16x16x32_bf16 v[80:83], a[108:111], a[64:67], v[80:83]
    v_mfma_f32_16x16x32_bf16 v[84:87], a[112:115], a[64:67], v[84:87]
    v_mfma_f32_16x16x32_bf16 v[152:155], a[64:67], a[116:119], v[152:155]
    v_mfma_f32_16x16x32_bf16 v[156:159], a[64:67], a[120:123], v[156:159]
    v_mfma_f32_16x16x32_bf16 a[128:131], a[124:127], a[64:67], a[128:131]
    v_mfma_f32_16x16x32_bf16 v[24:27], a[100:103], a[68:71], v[24:27]
    v_mfma_f32_16x16x32_bf16 v[28:31], a[104:107], a[68:71], v[28:31]
    v_mfma_f32_16x16x32_bf16 v[88:91], a[108:111], a[68:71], v[88:91]
    v_mfma_f32_16x16x32_bf16 v[92:95], a[112:115], a[68:71], v[92:95]
    v_mfma_f32_16x16x32_bf16 v[160:163], a[68:71], a[116:119], v[160:163]
    v_mfma_f32_16x16x32_bf16 v[164:167], a[68:71], a[120:123], v[164:167]
    v_mfma_f32_16x16x32_bf16 a[132:135], a[124:127], a[68:71], a[132:135]
    v_mfma_f32_16x16x32_bf16 v[32:35], a[100:103], a[72:75], v[32:35]
    v_mfma_f32_16x16x32_bf16 v[36:39], a[104:107], a[72:75], v[36:39]
    v_mfma_f32_16x16x32_bf16 v[96:99], a[108:111], a[72:75], v[96:99]
    v_mfma_f32_16x16x32_bf16 v[100:103], a[112:115], a[72:75], v[100:103]
    v_mfma_f32_16x16x32_bf16 v[168:171], a[72:75], a[116:119], v[168:171]
    v_mfma_f32_16x16x32_bf16 v[172:175], a[72:75], a[120:123], v[172:175]
    v_mfma_f32_16x16x32_bf16 a[136:139], a[124:127], a[72:75], a[136:139]
    v_mfma_f32_16x16x32_bf16 v[40:43], a[100:103], a[76:79], v[40:43]
    v_mfma_f32_16x16x32_bf16 v[44:47], a[104:107], a[76:79], v[44:47]
    v_mfma_f32_16x16x32_bf16 v[104:107], a[108:111], a[76:79], v[104:107]
    v_mfma_f32_16x16x32_bf16 v[108:111], a[112:115], a[76:79], v[108:111]
    v_mfma_f32_16x16x32_bf16 v[176:179], a[76:79], a[116:119], v[176:179]
    v_mfma_f32_16x16x32_bf16 v[180:183], a[76:79], a[120:123], v[180:183]
    v_mfma_f32_16x16x32_bf16 a[140:143], a[124:127], a[76:79], a[140:143]
    v_mfma_f32_16x16x32_bf16 v[48:51], a[100:103], a[80:83], v[48:51]
    v_mfma_f32_16x16x32_bf16 v[52:55], a[104:107], a[80:83], v[52:55]
    v_mfma_f32_16x16x32_bf16 v[112:115], a[108:111], a[80:83], v[112:115]
    v_mfma_f32_16x16x32_bf16 v[116:119], a[112:115], a[80:83], v[116:119]
    v_mfma_f32_16x16x32_bf16 v[184:187], a[80:83], a[116:119], v[184:187]
    v_mfma_f32_16x16x32_bf16 v[188:191], a[80:83], a[120:123], v[188:191]
    v_mfma_f32_16x16x32_bf16 a[144:147], a[124:127], a[80:83], a[144:147]
    v_mfma_f32_16x16x32_bf16 v[56:59], a[100:103], a[84:87], v[56:59]
    v_mfma_f32_16x16x32_bf16 v[60:63], a[104:107], a[84:87], v[60:63]
    v_mfma_f32_16x16x32_bf16 v[120:123], a[108:111], a[84:87], v[120:123]
    v_mfma_f32_16x16x32_bf16 v[124:127], a[112:115], a[84:87], v[124:127]
    v_mfma_f32_16x16x32_bf16 v[192:195], a[84:87], a[116:119], v[192:195]
    v_mfma_f32_16x16x32_bf16 v[196:199], a[84:87], a[120:123], v[196:199]
    v_mfma_f32_16x16x32_bf16 a[148:151], a[124:127], a[84:87], a[148:151]
    v_mfma_f32_16x16x32_bf16 v[64:67], a[100:103], a[88:91], v[64:67]
    v_mfma_f32_16x16x32_bf16 v[68:71], a[104:107], a[88:91], v[68:71]
    v_mfma_f32_16x16x32_bf16 v[128:131], a[108:111], a[88:91], v[128:131]
    v_mfma_f32_16x16x32_bf16 v[132:135], a[112:115], a[88:91], v[132:135]
    v_mfma_f32_16x16x32_bf16 v[200:203], a[88:91], a[116:119], v[200:203]
    v_mfma_f32_16x16x32_bf16 v[204:207], a[88:91], a[120:123], v[204:207]
    v_mfma_f32_16x16x32_bf16 a[152:155], a[124:127], a[88:91], a[152:155]
    v_mfma_f32_16x16x32_bf16 v[72:75], a[100:103], a[92:95], v[72:75]
    v_mfma_f32_16x16x32_bf16 v[76:79], a[104:107], a[92:95], v[76:79]
    v_mfma_f32_16x16x32_bf16 v[136:139], a[108:111], a[92:95], v[136:139]
    v_mfma_f32_16x16x32_bf16 v[140:143], a[112:115], a[92:95], v[140:143]
    v_mfma_f32_16x16x32_bf16 v[208:211], a[92:95], a[116:119], v[208:211]
    v_mfma_f32_16x16x32_bf16 v[212:215], a[92:95], a[120:123], v[212:215]
    v_mfma_f32_16x16x32_bf16 a[156:159], a[124:127], a[92:95], a[156:159]
    v_mfma_f32_16x16x32_bf16 v[144:147], a[108:111], a[96:99], v[144:147]
    v_mfma_f32_16x16x32_bf16 v[148:151], a[112:115], a[96:99], v[148:151]
    v_mfma_f32_16x16x32_bf16 v[216:219], a[96:99], a[116:119], v[216:219]
    v_mfma_f32_16x16x32_bf16 v[220:223], a[96:99], a[120:123], v[220:223]
    s_waitcnt vmcnt(0)
    v_readfirstlane_b32 s97, v251
    s_nop 0
    s_cmp_ge_u32 s97, 64
    s_cbranch_scc1 L_p1a_c0_out
    v_mov_b32 v225, 0
    s_mov_b32 s96, 0
L_p1a_c0:
    buffer_load_dword v251, v225, s[20:23], 0 offen sc1
    s_waitcnt vmcnt(0)
    v_readfirstlane_b32 s97, v251
    s_nop 0
    s_cmp_ge_u32 s97, 64
    s_cbranch_scc1 L_p1a_c0_out
    s_add_u32 s96, s96, 1
    s_cmp_lt_u32 s96, 0x40000
    s_cbranch_scc1 L_p1a_c0
L_p1a_c0_out:
L_pad_p1a_0:
    s_cbranch_execz L_pad_p1a_4
    v_mbcnt_lo_u32_b32 v224, -1, 0
    v_mbcnt_hi_u32_b32 v224, -1, v224
    v_lshlrev_b32 v224, 4, v224
    s_lshl_b32 s49, s26, 1
    s_add_u32 s49, s49, s51
    v_cvt_pk_bf16_f32 v16, v16, v17
    v_cvt_pk_bf16_f32 v17, v18, v19
    v_cvt_pk_bf16_f32 v18, v20, v21
    v_cvt_pk_bf16_f32 v19, v22, v23
    v_cvt_pk_bf16_f32 v20, v24, v25
    v_cvt_pk_bf16_f32 v21, v26, v27
    v_cvt_pk_bf16_f32 v22, v28, v29
    v_cvt_pk_bf16_f32 v23, v30, v31
    v_cvt_pk_bf16_f32 v24, v32, v33
    v_cvt_pk_bf16_f32 v25, v34, v35
    v_cvt_pk_bf16_f32 v26, v36, v37
    v_cvt_pk_bf16_f32 v27, v38, v39
    v_cvt_pk_bf16_f32 v28, v40, v41
    v_cvt_pk_bf16_f32 v29, v42, v43
    v_cvt_pk_bf16_f32 v30, v44, v45
    v_cvt_pk_bf16_f32 v31, v46, v47
    v_cvt_pk_bf16_f32 v32, v48, v49
    v_cvt_pk_bf16_f32 v33, v50, v51
    v_cvt_pk_bf16_f32 v34, v52, v53
    v_cvt_pk_bf16_f32 v35, v54, v55
    v_cvt_pk_bf16_f32 v36, v56, v57
    v_cvt_pk_bf16_f32 v37, v58, v59
    v_cvt_pk_bf16_f32 v38, v60, v61
    v_cvt_pk_bf16_f32 v39, v62, v63
    v_cvt_pk_bf16_f32 v40, v64, v65
    v_cvt_pk_bf16_f32 v41, v66, v67
    v_cvt_pk_bf16_f32 v42, v68, v69
    v_cvt_pk_bf16_f32 v43, v70, v71
    v_cvt_pk_bf16_f32 v44, v72, v73
    v_cvt_pk_bf16_f32 v45, v74, v75
    v_cvt_pk_bf16_f32 v46, v76, v77
    v_cvt_pk_bf16_f32 v47, v78, v79
    v_cvt_pk_bf16_f32 v80, v80, v81
    v_cvt_pk_bf16_f32 v81, v82, v83
    v_cvt_pk_bf16_f32 v82, v84, v85
    v_cvt_pk_bf16_f32 v83, v86, v87
    v_cvt_pk_bf16_f32 v84, v88, v89
    v_cvt_pk_bf16_f32 v85, v90, v91
    v_cvt_pk_bf16_f32 v86, v92, v93
    v_cvt_pk_bf16_f32 v87, v94, v95
    v_cvt_pk_bf16_f32 v88, v96, v97
    v_cvt_pk_bf16_f32 v89, v98, v99
    v_cvt_pk_bf16_f32 v90, v100, v101
    v_cvt_pk_bf16_f32 v91, v102, v103
    v_cvt_pk_bf16_f32 v92, v104, v105
    v_cvt_pk_bf16_f32 v93, v106, v107
    v_cvt_pk_bf16_f32 v94, v108, v109
    v_cvt_pk_bf16_f32 v95, v110, v111
    v_cvt_pk_bf16_f32 v96, v112, v113
L_pad_p1a_1:
    s_cbranch_execz L_pad_p1a_5
    v_cvt_pk_bf16_f32 v97, v114, v115
    v_cvt_pk_bf16_f32 v98, v116, v117
    v_cvt_pk_bf16_f32 v99, v118, v119
    v_cvt_pk_bf16_f32 v100, v120, v121
    v_cvt_pk_bf16_f32 v101, v122, v123
    v_cvt_pk_bf16_f32 v102, v124, v125
    v_cvt_pk_bf16_f32 v103, v126, v127
    v_cvt_pk_bf16_f32 v104, v128, v129
    v_cvt_pk_bf16_f32 v105, v130, v131
    v_cvt_pk_bf16_f32 v106, v132, v133
    v_cvt_pk_bf16_f32 v107, v134, v135
    v_cvt_pk_bf16_f32 v108, v136, v137
    v_cvt_pk_bf16_f32 v109, v138, v139
    v_cvt_pk_bf16_f32 v110, v140, v141
    v_cvt_pk_bf16_f32 v111, v142, v143
    v_cvt_pk_bf16_f32 v112, v144, v145
    v_cvt_pk_bf16_f32 v113, v146, v147
    v_cvt_pk_bf16_f32 v114, v148, v149
    v_cvt_pk_bf16_f32 v115, v150, v151
    v_cvt_pk_bf16_f32 v48, v216, v217
    v_cvt_pk_bf16_f32 v49, v218, v219
    v_cvt_pk_bf16_f32 v50, v152, v153
    v_cvt_pk_bf16_f32 v51, v154, v155
    v_cvt_pk_bf16_f32 v52, v168, v169
    v_cvt_pk_bf16_f32 v53, v170, v171
    v_cvt_pk_bf16_f32 v54, v184, v185
    v_cvt_pk_bf16_f32 v55, v186, v187
    v_cvt_pk_bf16_f32 v56, v200, v201
    v_cvt_pk_bf16_f32 v57, v202, v203
    v_cvt_pk_bf16_f32 v58, v220, v221
    v_cvt_pk_bf16_f32 v59, v222, v223
    v_cvt_pk_bf16_f32 v60, v156, v157
    v_cvt_pk_bf16_f32 v61, v158, v159
    v_cvt_pk_bf16_f32 v62, v172, v173
    v_cvt_pk_bf16_f32 v63, v174, v175
    v_cvt_pk_bf16_f32 v64, v188, v189
    v_cvt_pk_bf16_f32 v65, v190, v191
    v_cvt_pk_bf16_f32 v66, v204, v205
    v_cvt_pk_bf16_f32 v67, v206, v207
    v_cvt_pk_bf16_f32 v68, v216, v217
    v_cvt_pk_bf16_f32 v69, v218, v219
    v_cvt_pk_bf16_f32 v70, v160, v161
    v_cvt_pk_bf16_f32 v71, v162, v163
    v_cvt_pk_bf16_f32 v72, v176, v177
    v_cvt_pk_bf16_f32 v73, v178, v179
    v_cvt_pk_bf16_f32 v74, v192, v193
    v_cvt_pk_bf16_f32 v75, v194, v195
    v_cvt_pk_bf16_f32 v76, v208, v209
    v_cvt_pk_bf16_f32 v77, v210, v211
    v_cvt_pk_bf16_f32 v116, v220, v221
    v_cvt_pk_bf16_f32 v117, v222, v223
    v_cvt_pk_bf16_f32 v118, v164, v165
    v_cvt_pk_bf16_f32 v119, v166, v167
L_pad_p1a_2:
    s_cbranch_execz L_pad_p1a_6
    v_cvt_pk_bf16_f32 v120, v180, v181
    v_cvt_pk_bf16_f32 v121, v182, v183
    v_cvt_pk_bf16_f32 v122, v196, v197
    v_cvt_pk_bf16_f32 v123, v198, v199
    v_cvt_pk_bf16_f32 v124, v212, v213
    v_cvt_pk_bf16_f32 v125, v214, v215
    v_accvgpr_read_b32 v152, a128
    v_accvgpr_read_b32 v153, a129
    v_accvgpr_read_b32 v154, a130
    v_accvgpr_read_b32 v155, a131
    v_accvgpr_read_b32 v156, a132
    v_accvgpr_read_b32 v157, a133
    v_accvgpr_read_b32 v158, a134
    v_accvgpr_read_b32 v159, a135
    v_accvgpr_read_b32 v160, a136
    v_accvgpr_read_b32 v161, a137
    v_accvgpr_read_b32 v162, a138
    v_accvgpr_read_b32 v163, a139
    v_accvgpr_read_b32 v164, a140
    v_accvgpr_read_b32 v165, a141
    v_accvgpr_read_b32 v166, a142
    v_accvgpr_read_b32 v167, a143
    v_accvgpr_read_b32 v168, a144
    v_accvgpr_read_b32 v169, a145
    v_accvgpr_read_b32 v170, a146
    v_accvgpr_read_b32 v171, a147
    v_accvgpr_read_b32 v172, a148
    v_accvgpr_read_b32 v173, a149
    v_accvgpr_read_b32 v174, a150
    v_accvgpr_read_b32 v175, a151
    v_accvgpr_read_b32 v176, a152
    v_accvgpr_read_b32 v177, a153
    v_accvgpr_read_b32 v178, a154
    v_accvgpr_read_b32 v179, a155
    v_accvgpr_read_b32 v180, a156
    v_accvgpr_read_b32 v181, a157
    v_accvgpr_read_b32 v182, a158
    v_accvgpr_read_b32 v183, a159
    v_mov_b32 v226, 0xbdd2d3e8
    v_mov_b32 v227, 0xc0135761
    s_lshl_b32 s41, s25, 3
    s_lshl_b32 s42, s50, 2
    s_add_u32 s41, s41, s42
    s_mul_i32 s41, s41, 112
    s_add_u32 s41, s41, s49
    s_lshl_b32 s41, s41, 10
    s_add_u32 s41, s41, 0xc00000
    v_pk_mul_f32 v[184:185], v[152:153], v[152:153]
    v_pk_mul_f32 v[186:187], v[154:155], v[154:155]
    v_pk_mul_f32 v[188:189], v[156:157], v[156:157]
    v_pk_mul_f32 v[190:191], v[158:159], v[158:159]
    v_pk_mul_f32 v[192:193], v[160:161], v[160:161]
    v_pk_mul_f32 v[194:195], v[162:163], v[162:163]
    v_pk_mul_f32 v[196:197], v[164:165], v[164:165]
L_pad_p1a_3:
    s_cbranch_execz L_pad_p1a_7
    v_pk_mul_f32 v[198:199], v[166:167], v[166:167]
    v_pk_fma_f32 v[184:185], v[184:185], v[226:227], v[226:227] op_sel:[0,0,1] op_sel_hi:[1,0,1]
    v_pk_fma_f32 v[186:187], v[186:187], v[226:227], v[226:227] op_sel:[0,0,1] op_sel_hi:[1,0,1]
    v_pk_fma_f32 v[188:189], v[188:189], v[226:227], v[226:227] op_sel:[0,0,1] op_sel_hi:[1,0,1]
    v_pk_fma_f32 v[190:191], v[190:191], v[226:227], v[226:227] op_sel:[0,0,1] op_sel_hi:[1,0,1]
    v_pk_fma_f32 v[192:193], v[192:193], v[226:227], v[226:227] op_sel:[0,0,1] op_sel_hi:[1,0,1]
    v_pk_fma_f32 v[194:195], v[194:195], v[226:227], v[226:227] op_sel:[0,0,1] op_sel_hi:[1,0,1]
    v_pk_fma_f32 v[196:197], v[196:197], v[226:227], v[226:227] op_sel:[0,0,1] op_sel_hi:[1,0,1]
    v_pk_fma_f32 v[198:199], v[198:199], v[226:227], v[226:227] op_sel:[0,0,1] op_sel_hi:[1,0,1]
    v_pk_mul_f32 v[184:185], v[184:185], v[152:153]
    v_pk_mul_f32 v[186:187], v[186:187], v[154:155]
    v_pk_mul_f32 v[188:189], v[188:189], v[156:157]
    v_pk_mul_f32 v[190:191], v[190:191], v[158:159]
    v_pk_mul_f32 v[192:193], v[192:193], v[160:161]
    v_pk_mul_f32 v[194:195], v[194:195], v[162:163]
    v_pk_mul_f32 v[196:197], v[196:197], v[164:165]
    v_pk_mul_f32 v[198:199], v[198:199], v[166:167]
    v_exp_f32 v184, v184
    v_exp_f32 v185, v185
    v_exp_f32 v186, v186
    v_exp_f32 v187, v187
    v_exp_f32 v188, v188
    v_exp_f32 v189, v189
    v_exp_f32 v190, v190
    v_exp_f32 v191, v191
    v_exp_f32 v192, v192
    v_exp_f32 v193, v193
    v_exp_f32 v194, v194
    v_exp_f32 v195, v195
    v_exp_f32 v196, v196
    v_exp_f32 v197, v197
    v_exp_f32 v198, v198
    v_exp_f32 v199, v199
    v_pk_add_f32 v[184:185], v[184:185], 1.0 op_sel_hi:[1,0]
    v_pk_add_f32 v[186:187], v[186:187], 1.0 op_sel_hi:[1,0]
    v_pk_add_f32 v[188:189], v[188:189], 1.0 op_sel_hi:[1,0]
    v_pk_add_f32 v[190:191], v[190:191], 1.0 op_sel_hi:[1,0]
    v_pk_add_f32 v[192:193], v[192:193], 1.0 op_sel_hi:[1,0]
    v_pk_add_f32 v[194:195], v[194:195], 1.0 op_sel_hi:[1,0]
    v_pk_add_f32 v[196:197], v[196:197], 1.0 op_sel_hi:[1,0]
    v_pk_add_f32 v[198:199], v[198:199], 1.0 op_sel_hi:[1,0]
    v_rcp_f32 v184, v184
    v_pk_mul_f32 v[200:201], v[168:169], v[168:169]
    v_pk_mul_f32 v[202:203], v[170:171], v[170:171]
    v_rcp_f32 v185, v185
    v_pk_mul_f32 v[204:205], v[172:173], v[172:173]
    v_rcp_f32 v186, v186
    v_pk_mul_f32 v[206:207], v[174:175], v[174:175]
    v_pk_mul_f32 v[208:209], v[176:177], v[176:177]
    v_rcp_f32 v187, v187
    v_pk_mul_f32 v[210:211], v[178:179], v[178:179]
    v_rcp_f32 v188, v188
    v_pk_mul_f32 v[212:213], v[180:181], v[180:181]
    v_pk_mul_f32 v[214:215], v[182:183], v[182:183]
    v_rcp_f32 v189, v189
    v_pk_fma_f32 v[200:201], v[200:201], v[226:227], v[226:227] op_sel:[0,0,1] op_sel_hi:[1,0,1]
    v_rcp_f32 v190, v190
    v_pk_fma_f32 v[202:203], v[202:203], v[226:227], v[226:227] op_sel:[0,0,1] op_sel_hi:[1,0,1]
    v_pk_fma_f32 v[204:205], v[204:205], v[226:227], v[226:227] op_sel:[0,0,1] op_sel_hi:[1,0,1]
    v_rcp_f32 v191, v191
    v_pk_fma_f32 v[206:207], v[206:207], v[226:227], v[226:227] op_sel:[0,0,1] op_sel_hi:[1,0,1]
    v_rcp_f32 v192, v192
    v_pk_fma_f32 v[208:209], v[208:209], v[226:227], v[226:227] op_sel:[0,0,1] op_sel_hi:[1,0,1]
    v_pk_fma_f32 v[210:211], v[210:211], v[226:227], v[226:227] op_sel:[0,0,1] op_sel_hi:[1,0,1]
    v_rcp_f32 v193, v193
    v_pk_fma_f32 v[212:213], v[212:213], v[226:227], v[226:227] op_sel:[0,0,1] op_sel_hi:[1,0,1]
L_pad_p1a_4:
    s_cbranch_execz L_pad_p1a_8
    v_rcp_f32 v194, v194
    v_pk_fma_f32 v[214:215], v[214:215], v[226:227], v[226:227] op_sel:[0,0,1] op_sel_hi:[1,0,1]
    v_pk_mul_f32 v[200:201], v[200:201], v[168:169]
    v_rcp_f32 v195, v195
    v_pk_mul_f32 v[202:203], v[202:203], v[170:171]
    v_rcp_f32 v196, v196
    v_pk_mul_f32 v[204:205], v[204:205], v[172:173]
    v_pk_mul_f32 v[206:207], v[206:207], v[174:175]
    v_rcp_f32 v197, v197
    v_pk_mul_f32 v[208:209], v[208:209], v[176:177]
    v_rcp_f32 v198, v198
    v_pk_mul_f32 v[210:211], v[210:211], v[178:179]
    v_pk_mul_f32 v[212:213], v[212:213], v[180:181]
    v_rcp_f32 v199, v199
    v_pk_mul_f32 v[214:215], v[214:215], v[182:183]
    v_exp_f32 v200, v200
    v_pk_mul_f32 v[152:153], v[152:153], v[184:185]
    v_pk_mul_f32 v[154:155], v[154:155], v[186:187]
    v_exp_f32 v201, v201
    v_pk_mul_f32 v[156:157], v[156:157], v[188:189]
    v_exp_f32 v202, v202
    v_pk_mul_f32 v[158:159], v[158:159], v[190:191]
    v_exp_f32 v203, v203
    v_pk_mul_f32 v[160:161], v[160:161], v[192:193]
    v_exp_f32 v204, v204
    v_pk_mul_f32 v[162:163], v[162:163], v[194:195]
    v_exp_f32 v205, v205
    v_pk_mul_f32 v[164:165], v[164:165], v[196:197]
    v_pk_mul_f32 v[166:167], v[166:167], v[198:199]
    v_exp_f32 v206, v206
    v_cvt_pk_bf16_f32 v228, v152, v153
    v_exp_f32 v207, v207
    v_cvt_pk_bf16_f32 v229, v154, v155
    v_exp_f32 v208, v208
    v_cvt_pk_bf16_f32 v230, v156, v157
    v_exp_f32 v209, v209
    v_cvt_pk_bf16_f32 v231, v158, v159
    v_exp_f32 v210, v210
    buffer_store_dwordx4 v[228:231], v224, s[16:19], s41 offen  sc1
    v_cvt_pk_bf16_f32 v232, v160, v161
    v_exp_f32 v211, v211
    v_cvt_pk_bf16_f32 v233, v162, v163
    v_exp_f32 v212, v212
    v_cvt_pk_bf16_f32 v234, v164, v165
    v_exp_f32 v213, v213
    v_cvt_pk_bf16_f32 v235, v166, v167
    v_exp_f32 v214, v214
    s_add_u32 s41, s41, 114688
    v_exp_f32 v215, v215
    buffer_store_dwordx4 v[232:235], v224, s[16:19], s41 offen  sc1
    v_pk_add_f32 v[200:201], v[200:201], 1.0 op_sel_hi:[1,0]
    v_pk_add_f32 v[202:203], v[202:203], 1.0 op_sel_hi:[1,0]
    v_pk_add_f32 v[204:205], v[204:205], 1.0 op_sel_hi:[1,0]
    v_pk_add_f32 v[206:207], v[206:207], 1.0 op_sel_hi:[1,0]
    v_pk_add_f32 v[208:209], v[208:209], 1.0 op_sel_hi:[1,0]
    v_pk_add_f32 v[210:211], v[210:211], 1.0 op_sel_hi:[1,0]
    v_pk_add_f32 v[212:213], v[212:213], 1.0 op_sel_hi:[1,0]
    v_pk_add_f32 v[214:215], v[214:215], 1.0 op_sel_hi:[1,0]
    v_rcp_f32 v200, v200
    v_rcp_f32 v201, v201
    v_rcp_f32 v202, v202
    v_rcp_f32 v203, v203
    v_rcp_f32 v204, v204
    v_rcp_f32 v205, v205
    v_rcp_f32 v206, v206
    v_rcp_f32 v207, v207
    v_rcp_f32 v208, v208
    v_rcp_f32 v209, v209
L_pad_p1a_5:
    s_cbranch_execz L_pad_p1a_9
    v_rcp_f32 v210, v210
    v_rcp_f32 v211, v211
    v_rcp_f32 v212, v212
    v_rcp_f32 v213, v213
    v_rcp_f32 v214, v214
    v_rcp_f32 v215, v215
    v_pk_mul_f32 v[168:169], v[168:169], v[200:201]
    v_pk_mul_f32 v[170:171], v[170:171], v[202:203]
    v_pk_mul_f32 v[172:173], v[172:173], v[204:205]
    v_pk_mul_f32 v[174:175], v[174:175], v[206:207]
    v_pk_mul_f32 v[176:177], v[176:177], v[208:209]
    v_pk_mul_f32 v[178:179], v[178:179], v[210:211]
    v_pk_mul_f32 v[180:181], v[180:181], v[212:213]
    v_pk_mul_f32 v[182:183], v[182:183], v[214:215]
    v_cvt_pk_bf16_f32 v236, v168, v169
    v_cvt_pk_bf16_f32 v237, v170, v171
    v_cvt_pk_bf16_f32 v238, v172, v173
    v_cvt_pk_bf16_f32 v239, v174, v175
    s_add_u32 s41, s41, 114688
    buffer_store_dwordx4 v[236:239], v224, s[16:19], s41 offen  sc1
    v_cvt_pk_bf16_f32 v240, v176, v177
    v_cvt_pk_bf16_f32 v241, v178, v179
    v_cvt_pk_bf16_f32 v242, v180, v181
    v_cvt_pk_bf16_f32 v243, v182, v183
    s_add_u32 s41, s41, 114688
    buffer_store_dwordx4 v[240:243], v224, s[16:19], s41 offen  sc1
    v_mov_b32 v128, 0x3f803f80
    v_mov_b32 v129, 0x3f803f80
    v_mov_b32 v130, 0x3f803f80
    v_mov_b32 v131, 0x3f803f80
    s_mov_b32 s44, 0x3e8293ee
    s_mov_b32 s45, 0x3e8293ee
    s_lshl_b32 s41, s25, 3
    s_lshl_b32 s42, s50, 2
    s_add_u32 s41, s41, s42
    s_mul_i32 s41, s41, 88
    s_add_u32 s41, s41, s49
    s_lshl_b32 s41, s41, 11
    v_mfma_f32_16x16x32_bf16 v[152:155], v[112:115], v[16:19], v[8:11]
    v_mfma_f32_16x16x32_bf16 v[156:159], v[80:83], v[16:19], v[0:3]
    v_mfma_f32_16x16x32_bf16 v[160:163], v[112:115], v[20:23], v[12:15]
    v_mfma_f32_16x16x32_bf16 v[164:167], v[84:87], v[20:23], v[0:3]
    v_mfma_f32_16x16x32_bf16 v[168:171], v[80:83], v[24:27], v[4:7]
    v_mfma_f32_16x16x32_bf16 v[172:175], v[88:91], v[24:27], v[0:3]
    v_mfma_f32_16x16x32_bf16 v[176:179], v[84:87], v[28:31], v[4:7]
    v_mfma_f32_16x16x32_bf16 v[180:183], v[92:95], v[28:31], v[0:3]
    s_nop 0
    v_max3_f32 v244, v152, v153, v154
    s_nop 0
    v_max3_f32 v246, v160, v161, v162
    s_nop 0
    v_max3_f32 v248, v168, v169, v170
    s_nop 0
    v_max3_f32 v250, v176, v177, v178
    v_max3_f32 v244, v244, v155, v156
    v_max3_f32 v246, v246, v163, v164
    v_max3_f32 v248, v248, v171, v172
    v_max3_f32 v250, v250, v179, v180
    v_max3_f32 v244, v244, v157, v158
    v_max3_f32 v246, v246, v165, v166
L_pad_p1a_6:
    s_cbranch_execz L_pad_p1a_10
    v_max3_f32 v248, v248, v173, v174
    v_max3_f32 v250, v250, v181, v182
    v_max_f32 v244, v244, v159
    v_max_f32 v246, v246, v167
    v_max_f32 v248, v248, v175
    v_max_f32 v250, v250, v183
    v_mov_b32 v245, v244
    v_mov_b32 v247, v246
    v_mov_b32 v249, v248
    v_mov_b32 v251, v250
    v_permlane32_swap_b32 v244, v245
    v_permlane32_swap_b32 v246, v247
    v_permlane32_swap_b32 v248, v249
    v_permlane32_swap_b32 v250, v251
    v_max_f32 v244, v244, v245
    v_max_f32 v246, v246, v247
    v_max_f32 v248, v248, v249
    v_max_f32 v250, v250, v251
    v_mov_b32 v245, v244
    v_mov_b32 v247, v246
    v_mov_b32 v249, v248
    v_mov_b32 v251, v250
    v_permlane16_swap_b32 v244, v245
    v_permlane16_swap_b32 v246, v247
    v_permlane16_swap_b32 v248, v249
    v_permlane16_swap_b32 v250, v251
    v_max_f32 v244, v244, v245
    v_max_f32 v246, v246, v247
    v_max_f32 v248, v248, v249
    v_max_f32 v250, v250, v251
    v_mul_f32 v244, 0xbe8293ee, v244
    v_mul_f32 v246, 0xbe8293ee, v246
    v_mul_f32 v248, 0xbe8293ee, v248
    v_mul_f32 v250, 0xbe8293ee, v250
    v_pk_fma_f32 v[152:153], v[152:153], s[44:45], v[244:245] op_sel_hi:[1,1,0]
    v_pk_fma_f32 v[154:155], v[154:155], s[44:45], v[244:245] op_sel_hi:[1,1,0]
    v_pk_fma_f32 v[156:157], v[156:157], s[44:45], v[244:245] op_sel_hi:[1,1,0]
    v_pk_fma_f32 v[158:159], v[158:159], s[44:45], v[244:245] op_sel_hi:[1,1,0]
    v_pk_fma_f32 v[160:161], v[160:161], s[44:45], v[246:247] op_sel_hi:[1,1,0]
    v_pk_fma_f32 v[162:163], v[162:163], s[44:45], v[246:247] op_sel_hi:[1,1,0]
    v_pk_fma_f32 v[164:165], v[164:165], s[44:45], v[246:247] op_sel_hi:[1,1,0]
    v_pk_fma_f32 v[166:167], v[166:167], s[44:45], v[246:247] op_sel_hi:[1,1,0]
    v_pk_fma_f32 v[168:169], v[168:169], s[44:45], v[248:249] op_sel_hi:[1,1,0]
    v_pk_fma_f32 v[170:171], v[170:171], s[44:45], v[248:249] op_sel_hi:[1,1,0]
    v_pk_fma_f32 v[172:173], v[172:173], s[44:45], v[248:249] op_sel_hi:[1,1,0]
    v_pk_fma_f32 v[174:175], v[174:175], s[44:45], v[248:249] op_sel_hi:[1,1,0]
    v_pk_fma_f32 v[176:177], v[176:177], s[44:45], v[250:251] op_sel_hi:[1,1,0]
    v_pk_fma_f32 v[178:179], v[178:179], s[44:45], v[250:251] op_sel_hi:[1,1,0]
    v_pk_fma_f32 v[180:181], v[180:181], s[44:45], v[250:251] op_sel_hi:[1,1,0]
    v_pk_fma_f32 v[182:183], v[182:183], s[44:45], v[250:251] op_sel_hi:[1,1,0]
    v_exp_f32 v152, v152
    v_exp_f32 v153, v153
    v_exp_f32 v154, v154
    v_exp_f32 v155, v155
    v_exp_f32 v156, v156
    v_exp_f32 v157, v157
    v_exp_f32 v158, v158
    v_exp_f32 v159, v159
    v_exp_f32 v160, v160
    v_exp_f32 v161, v161
    v_exp_f32 v162, v162
    v_exp_f32 v163, v163
    v_exp_f32 v164, v164
    v_exp_f32 v165, v165
    v_exp_f32 v166, v166
    v_exp_f32 v167, v167
    v_exp_f32 v168, v168
    v_exp_f32 v169, v169
    v_exp_f32 v170, v170
    v_exp_f32 v171, v171
    v_exp_f32 v172, v172
    v_exp_f32 v173, v173
    v_exp_f32 v174, v174
    v_exp_f32 v175, v175
    v_exp_f32 v176, v176
    v_exp_f32 v177, v177
    v_exp_f32 v178, v178
    v_exp_f32 v179, v179
    v_exp_f32 v180, v180
    v_exp_f32 v181, v181
    v_exp_f32 v182, v182
    v_exp_f32 v183, v183
L_pad_p1a_7:
    s_cbranch_execz L_pad_p1a_ret
    v_cvt_pk_bf16_f32 v152, v152, v153
    v_cvt_pk_bf16_f32 v153, v154, v155
    v_cvt_pk_bf16_f32 v154, v156, v157
    v_cvt_pk_bf16_f32 v155, v158, v159
    v_cvt_pk_bf16_f32 v160, v160, v161
    v_cvt_pk_bf16_f32 v161, v162, v163
    v_cvt_pk_bf16_f32 v162, v164, v165
    v_cvt_pk_bf16_f32 v163, v166, v167
    v_cvt_pk_bf16_f32 v168, v168, v169
    v_cvt_pk_bf16_f32 v169, v170, v171
    v_cvt_pk_bf16_f32 v170, v172, v173
    v_cvt_pk_bf16_f32 v171, v174, v175
    v_cvt_pk_bf16_f32 v176, v176, v177
    v_cvt_pk_bf16_f32 v177, v178, v179
    v_cvt_pk_bf16_f32 v178, v180, v181
    v_cvt_pk_bf16_f32 v179, v182, v183
    v_mfma_f32_16x16x32_bf16 v[228:231], v[128:131], v[152:155], 0
    v_mfma_f32_16x16x32_bf16 v[184:187], v[48:51], v[152:155], 0
    v_mfma_f32_16x16x32_bf16 v[188:191], v[58:61], v[152:155], 0
    v_mfma_f32_16x16x32_bf16 v[232:235], v[128:131], v[160:163], 0
    v_mfma_f32_16x16x32_bf16 v[192:195], v[68:71], v[160:163], 0
    v_mfma_f32_16x16x32_bf16 v[196:199], v[116:119], v[160:163], 0
    v_mfma_f32_16x16x32_bf16 v[236:239], v[128:131], v[168:171], 0
    v_mfma_f32_16x16x32_bf16 v[200:203], v[50:53], v[168:171], 0
    v_mfma_f32_16x16x32_bf16 v[204:207], v[60:63], v[168:171], 0
    v_mfma_f32_16x16x32_bf16 v[240:243], v[128:131], v[176:179], 0
    v_mfma_f32_16x16x32_bf16 v[208:211], v[70:73], v[176:179], 0
    v_mfma_f32_16x16x32_bf16 v[212:215], v[118:121], v[176:179], 0
    v_rcp_f32 v228, v228
    v_rcp_f32 v232, v232
    s_nop 0
    v_rcp_f32 v236, v236
    s_nop 1
    v_rcp_f32 v240, v240
    v_pk_mul_f32 v[184:185], v[184:185], v[228:229] op_sel_hi:[1,0]
    v_pk_mul_f32 v[186:187], v[186:187], v[228:229] op_sel_hi:[1,0]
    v_pk_mul_f32 v[188:189], v[188:189], v[228:229] op_sel_hi:[1,0]
    v_pk_mul_f32 v[190:191], v[190:191], v[228:229] op_sel_hi:[1,0]
    v_pk_mul_f32 v[192:193], v[192:193], v[232:233] op_sel_hi:[1,0]
    v_pk_mul_f32 v[194:195], v[194:195], v[232:233] op_sel_hi:[1,0]
    v_pk_mul_f32 v[196:197], v[196:197], v[232:233] op_sel_hi:[1,0]
    v_pk_mul_f32 v[198:199], v[198:199], v[232:233] op_sel_hi:[1,0]
    v_pk_mul_f32 v[200:201], v[200:201], v[236:237] op_sel_hi:[1,0]
    v_pk_mul_f32 v[202:203], v[202:203], v[236:237] op_sel_hi:[1,0]
    v_pk_mul_f32 v[204:205], v[204:205], v[236:237] op_sel_hi:[1,0]
    v_pk_mul_f32 v[206:207], v[206:207], v[236:237] op_sel_hi:[1,0]
    v_pk_mul_f32 v[208:209], v[208:209], v[240:241] op_sel_hi:[1,0]
    v_pk_mul_f32 v[210:211], v[210:211], v[240:241] op_sel_hi:[1,0]
    v_pk_mul_f32 v[212:213], v[212:213], v[240:241] op_sel_hi:[1,0]
    v_pk_mul_f32 v[214:215], v[214:215], v[240:241] op_sel_hi:[1,0]
    v_cvt_pk_bf16_f32 v184, v184, v185
    v_cvt_pk_bf16_f32 v185, v186, v187
    v_cvt_pk_bf16_f32 v186, v188, v189
    v_cvt_pk_bf16_f32 v187, v190, v191
    buffer_store_dwordx4 v[184:187], v224, s[16:19], s41 offen  sc1
    v_cvt_pk_bf16_f32 v192, v192, v193
L_pad_p1a_8:
    s_cbranch_execz L_pad_p1a_ret
    v_cvt_pk_bf16_f32 v193, v194, v195
    v_cvt_pk_bf16_f32 v194, v196, v197
    v_cvt_pk_bf16_f32 v195, v198, v199
    buffer_store_dwordx4 v[192:195], v224, s[16:19], s41 offen offset:1024  sc1
    s_add_u32 s41, s41, 180224
    v_cvt_pk_bf16_f32 v200, v200, v201
    v_cvt_pk_bf16_f32 v201, v202, v203
    v_cvt_pk_bf16_f32 v202, v204, v205
    v_cvt_pk_bf16_f32 v203, v206, v207
    buffer_store_dwordx4 v[200:203], v224, s[16:19], s41 offen  sc1
    v_cvt_pk_bf16_f32 v208, v208, v209
    v_cvt_pk_bf16_f32 v209, v210, v211
    v_cvt_pk_bf16_f32 v210, v212, v213
    v_cvt_pk_bf16_f32 v211, v214, v215
    buffer_store_dwordx4 v[208:211], v224, s[16:19], s41 offen offset:1024  sc1
    s_add_u32 s41, s41, 180224
    v_mfma_f32_16x16x32_bf16 v[152:155], v[88:91], v[32:35], v[4:7]
    v_mfma_f32_16x16x32_bf16 v[156:159], v[96:99], v[32:35], v[0:3]
    v_mfma_f32_16x16x32_bf16 v[160:163], v[92:95], v[36:39], v[4:7]
    v_mfma_f32_16x16x32_bf16 v[164:167], v[100:103], v[36:39], v[0:3]
    v_mfma_f32_16x16x32_bf16 v[168:171], v[96:99], v[40:43], v[4:7]
    v_mfma_f32_16x16x32_bf16 v[172:175], v[104:107], v[40:43], v[0:3]
    v_mfma_f32_16x16x32_bf16 v[176:179], v[100:103], v[44:47], v[4:7]
    v_mfma_f32_16x16x32_bf16 v[180:183], v[108:111], v[44:47], v[0:3]
    s_nop 0
    v_max3_f32 v244, v152, v153, v154
    s_nop 0
    v_max3_f32 v246, v160, v161, v162
    s_nop 0
    v_max3_f32 v248, v168, v169, v170
    s_nop 0
    v_max3_f32 v250, v176, v177, v178
    v_max3_f32 v244, v244, v155, v156
    v_max3_f32 v246, v246, v163, v164
    v_max3_f32 v248, v248, v171, v172
    v_max3_f32 v250, v250, v179, v180
    v_max3_f32 v244, v244, v157, v158
    v_max3_f32 v246, v246, v165, v166
    v_max3_f32 v248, v248, v173, v174
    v_max3_f32 v250, v250, v181, v182
    v_max_f32 v244, v244, v159
    v_max_f32 v246, v246, v167
    v_max_f32 v248, v248, v175
    v_max_f32 v250, v250, v183
    v_mov_b32 v245, v244
    v_mov_b32 v247, v246
    v_mov_b32 v249, v248
    v_mov_b32 v251, v250
    v_permlane32_swap_b32 v244, v245
    v_permlane32_swap_b32 v246, v247
    v_permlane32_swap_b32 v248, v249
    v_permlane32_swap_b32 v250, v251
    v_max_f32 v244, v244, v245
    v_max_f32 v246, v246, v247
    v_max_f32 v248, v248, v249
    v_max_f32 v250, v250, v251
    v_mov_b32 v245, v244
    v_mov_b32 v247, v246
    v_mov_b32 v249, v248
    v_mov_b32 v251, v250
    v_permlane16_swap_b32 v244, v245
    v_permlane16_swap_b32 v246, v247
    v_permlane16_swap_b32 v248, v249
    v_permlane16_swap_b32 v250, v251
    v_max_f32 v244, v244, v245
    v_max_f32 v246, v246, v247
    v_max_f32 v248, v248, v249
L_pad_p1a_9:
    s_cbranch_execz L_pad_p1a_ret
    v_max_f32 v250, v250, v251
    v_mul_f32 v244, 0xbe8293ee, v244
    v_mul_f32 v246, 0xbe8293ee, v246
    v_mul_f32 v248, 0xbe8293ee, v248
    v_mul_f32 v250, 0xbe8293ee, v250
    v_pk_fma_f32 v[152:153], v[152:153], s[44:45], v[244:245] op_sel_hi:[1,1,0]
    v_pk_fma_f32 v[154:155], v[154:155], s[44:45], v[244:245] op_sel_hi:[1,1,0]
    v_pk_fma_f32 v[156:157], v[156:157], s[44:45], v[244:245] op_sel_hi:[1,1,0]
    v_pk_fma_f32 v[158:159], v[158:159], s[44:45], v[244:245] op_sel_hi:[1,1,0]
    v_pk_fma_f32 v[160:161], v[160:161], s[44:45], v[246:247] op_sel_hi:[1,1,0]
    v_pk_fma_f32 v[162:163], v[162:163], s[44:45], v[246:247] op_sel_hi:[1,1,0]
    v_pk_fma_f32 v[164:165], v[164:165], s[44:45], v[246:247] op_sel_hi:[1,1,0]
    v_pk_fma_f32 v[166:167], v[166:167], s[44:45], v[246:247] op_sel_hi:[1,1,0]
    v_pk_fma_f32 v[168:169], v[168:169], s[44:45], v[248:249] op_sel_hi:[1,1,0]
    v_pk_fma_f32 v[170:171], v[170:171], s[44:45], v[248:249] op_sel_hi:[1,1,0]
    v_pk_fma_f32 v[172:173], v[172:173], s[44:45], v[248:249] op_sel_hi:[1,1,0]
    v_pk_fma_f32 v[174:175], v[174:175], s[44:45], v[248:249] op_sel_hi:[1,1,0]
    v_pk_fma_f32 v[176:177], v[176:177], s[44:45], v[250:251] op_sel_hi:[1,1,0]
    v_pk_fma_f32 v[178:179], v[178:179], s[44:45], v[250:251] op_sel_hi:[1,1,0]
    v_pk_fma_f32 v[180:181], v[180:181], s[44:45], v[250:251] op_sel_hi:[1,1,0]
    v_pk_fma_f32 v[182:183], v[182:183], s[44:45], v[250:251] op_sel_hi:[1,1,0]
    v_exp_f32 v152, v152
    v_exp_f32 v153, v153
    v_exp_f32 v154, v154
    v_exp_f32 v155, v155
    v_exp_f32 v156, v156
    v_exp_f32 v157, v157
    v_exp_f32 v158, v158
    v_exp_f32 v159, v159
    v_exp_f32 v160, v160
    v_exp_f32 v161, v161
    v_exp_f32 v162, v162
    v_exp_f32 v163, v163
    v_exp_f32 v164, v164
    v_exp_f32 v165, v165
    v_exp_f32 v166, v166
    v_exp_f32 v167, v167
    v_exp_f32 v168, v168
    v_exp_f32 v169, v169
    v_exp_f32 v170, v170
    v_exp_f32 v171, v171
    v_exp_f32 v172, v172
    v_exp_f32 v173, v173
    v_exp_f32 v174, v174
    v_exp_f32 v175, v175
    v_exp_f32 v176, v176
    v_exp_f32 v177, v177
    v_exp_f32 v178, v178
    v_exp_f32 v179, v179
    v_exp_f32 v180, v180
    v_exp_f32 v181, v181
    v_exp_f32 v182, v182
    v_exp_f32 v183, v183
    v_cvt_pk_bf16_f32 v152, v152, v153
    v_cvt_pk_bf16_f32 v153, v154, v155
    v_cvt_pk_bf16_f32 v154, v156, v157
    v_cvt_pk_bf16_f32 v155, v158, v159
    v_cvt_pk_bf16_f32 v160, v160, v161
    v_cvt_pk_bf16_f32 v161, v162, v163
    v_cvt_pk_bf16_f32 v162, v164, v165
    v_cvt_pk_bf16_f32 v163, v166, v167
    v_cvt_pk_bf16_f32 v168, v168, v169
    v_cvt_pk_bf16_f32 v169, v170, v171
    v_cvt_pk_bf16_f32 v170, v172, v173
    v_cvt_pk_bf16_f32 v171, v174, v175
    v_cvt_pk_bf16_f32 v176, v176, v177
    v_cvt_pk_bf16_f32 v177, v178, v179
    v_cvt_pk_bf16_f32 v178, v180, v181
    v_cvt_pk_bf16_f32 v179, v182, v183
L_pad_p1a_10:
    s_cbranch_execz L_pad_p1a_ret
    v_mfma_f32_16x16x32_bf16 v[228:231], v[128:131], v[152:155], 0
    v_mfma_f32_16x16x32_bf16 v[184:187], v[52:55], v[152:155], 0
    v_mfma_f32_16x16x32_bf16 v[188:191], v[62:65], v[152:155], 0
    v_mfma_f32_16x16x32_bf16 v[232:235], v[128:131], v[160:163], 0
    v_mfma_f32_16x16x32_bf16 v[192:195], v[72:75], v[160:163], 0
    v_mfma_f32_16x16x32_bf16 v[196:199], v[120:123], v[160:163], 0
    v_mfma_f32_16x16x32_bf16 v[236:239], v[128:131], v[168:171], 0
    v_mfma_f32_16x16x32_bf16 v[200:203], v[54:57], v[168:171], 0
    v_mfma_f32_16x16x32_bf16 v[204:207], v[64:67], v[168:171], 0
    v_mfma_f32_16x16x32_bf16 v[240:243], v[128:131], v[176:179], 0
    v_mfma_f32_16x16x32_bf16 v[208:211], v[74:77], v[176:179], 0
    v_mfma_f32_16x16x32_bf16 v[212:215], v[122:125], v[176:179], 0
    v_rcp_f32 v228, v228
    v_rcp_f32 v232, v232
    s_nop 0
    v_rcp_f32 v236, v236
    s_nop 1
    v_rcp_f32 v240, v240
    v_pk_mul_f32 v[184:185], v[184:185], v[228:229] op_sel_hi:[1,0]
    v_pk_mul_f32 v[186:187], v[186:187], v[228:229] op_sel_hi:[1,0]
    v_pk_mul_f32 v[188:189], v[188:189], v[228:229] op_sel_hi:[1,0]
    v_pk_mul_f32 v[190:191], v[190:191], v[228:229] op_sel_hi:[1,0]
    v_pk_mul_f32 v[192:193], v[192:193], v[232:233] op_sel_hi:[1,0]
    v_pk_mul_f32 v[194:195], v[194:195], v[232:233] op_sel_hi:[1,0]
    v_pk_mul_f32 v[196:197], v[196:197], v[232:233] op_sel_hi:[1,0]
    v_pk_mul_f32 v[198:199], v[198:199], v[232:233] op_sel_hi:[1,0]
    v_pk_mul_f32 v[200:201], v[200:201], v[236:237] op_sel_hi:[1,0]
    v_pk_mul_f32 v[202:203], v[202:203], v[236:237] op_sel_hi:[1,0]
    v_pk_mul_f32 v[204:205], v[204:205], v[236:237] op_sel_hi:[1,0]
    v_pk_mul_f32 v[206:207], v[206:207], v[236:237] op_sel_hi:[1,0]
    v_pk_mul_f32 v[208:209], v[208:209], v[240:241] op_sel_hi:[1,0]
    v_pk_mul_f32 v[210:211], v[210:211], v[240:241] op_sel_hi:[1,0]
    v_pk_mul_f32 v[212:213], v[212:213], v[240:241] op_sel_hi:[1,0]
    v_pk_mul_f32 v[214:215], v[214:215], v[240:241] op_sel_hi:[1,0]
    v_cvt_pk_bf16_f32 v184, v184, v185
    v_cvt_pk_bf16_f32 v185, v186, v187
    v_cvt_pk_bf16_f32 v186, v188, v189
    v_cvt_pk_bf16_f32 v187, v190, v191
    buffer_store_dwordx4 v[184:187], v224, s[16:19], s41 offen  sc1
    v_cvt_pk_bf16_f32 v192, v192, v193
    v_cvt_pk_bf16_f32 v193, v194, v195
    v_cvt_pk_bf16_f32 v194, v196, v197
    v_cvt_pk_bf16_f32 v195, v198, v199
    buffer_store_dwordx4 v[192:195], v224, s[16:19], s41 offen offset:1024  sc1
    s_add_u32 s41, s41, 180224
    v_cvt_pk_bf16_f32 v200, v200, v201
    v_cvt_pk_bf16_f32 v201, v202, v203
    v_cvt_pk_bf16_f32 v202, v204, v205
    v_cvt_pk_bf16_f32 v203, v206, v207
    buffer_store_dwordx4 v[200:203], v224, s[16:19], s41 offen  sc1
    v_cvt_pk_bf16_f32 v208, v208, v209
    v_cvt_pk_bf16_f32 v209, v210, v211
    v_cvt_pk_bf16_f32 v210, v212, v213
    v_cvt_pk_bf16_f32 v211, v214, v215
    buffer_store_dwordx4 v[208:211], v224, s[16:19], s41 offen offset:1024  sc1
    s_barrier
    s_branch L_p1_done
L_p1_Y:
    s_sub_u32 s26, s41, 2
    s_add_u32 s41, s26, 30
    s_lshl_b32 s41, s41, 2
    s_add_u32 s31, s31, s41
    s_mul_i32 s29, s54, 458752
    s_mov_b32 s30, s28
    s_mov_b32 s16, s78
    s_mov_b32 s17, s79
    s_mov_b32 s18, 0x10000000
    s_mov_b32 s19, 0x20000
    s_mov_b32 s20, s76
    s_mov_b32 s21, s77
    s_mov_b32 s22, 0x100
    s_mov_b32 s23, 0x20000
    s_mul_i32 s41, s26, 384
    s_add_u32 s41, s41, 2816
    s_movk_i32 s42, 128
    s_add_u32 s43, s41, 256
    s_mov_b32 s8, s64
    s_mov_b32 s9, s65
    s_mov_b32 s10, 0x700000
    s_mov_b32 s11, 0x20000
    v_lshrrev_b32 v200, 3, v0
    v_and_b32 v201, 7, v0
    v_and_b32 v202, 2, v200
    v_xor_b32 v201, v201, v202
    v_mul_u32_u24 v200, 7168, v200
    v_lshl_add_u32 v203, v201, 4, v200
    v_xor_b32 v204, 64, v203
    s_mul_i32 s44, s24, 6
    s_add_u32 s45, s44, 0
    s_lshr_b32 s46, s45, 3
    s_and_b32 s45, s45, 7
    s_mul_i32 s47, s46, s42
    s_add_u32 s47, s47, s41
    s_cmp_eq_u32 s46, 2
    s_cselect_b32 s47, s43, s47
    s_mul_i32 s45, s45, 57344
    s_add_u32 s47, s47, s45
    v_add_u32 v233, s47, v203
    s_add_u32 s45, s44, 1
    s_lshr_b32 s46, s45, 3
    s_and_b32 s45, s45, 7
    s_mul_i32 s47, s46, s42
    s_add_u32 s47, s47, s41
    s_cmp_eq_u32 s46, 2
    s_cselect_b32 s47, s43, s47
    s_mul_i32 s45, s45, 57344
    s_add_u32 s47, s47, s45
    s_sub_u32 s47, s47, 1024
    v_add_u32 v234, s47, v204
    s_add_u32 s45, s44, 2
    s_lshr_b32 s46, s45, 3
    s_and_b32 s45, s45, 7
    s_mul_i32 s47, s46, s42
    s_add_u32 s47, s47, s41
    s_cmp_eq_u32 s46, 2
    s_cselect_b32 s47, s43, s47
    s_mul_i32 s45, s45, 57344
    s_add_u32 s47, s47, s45
    s_sub_u32 s47, s47, 2048
    v_add_u32 v235, s47, v203
    s_add_u32 s45, s44, 3
    s_lshr_b32 s46, s45, 3
    s_and_b32 s45, s45, 7
    s_mul_i32 s47, s46, s42
    s_add_u32 s47, s47, s41
    s_cmp_eq_u32 s46, 2
    s_cselect_b32 s47, s43, s47
    s_mul_i32 s45, s45, 57344
    s_add_u32 s47, s47, s45
    s_sub_u32 s47, s47, 3072
    v_add_u32 v236, s47, v204
    s_add_u32 s45, s44, 4
    s_lshr_b32 s46, s45, 3
    s_and_b32 s45, s45, 7
    s_mul_i32 s47, s46, s42
    s_add_u32 s47, s47, s41
    s_cmp_eq_u32 s46, 2
    s_cselect_b32 s47, s43, s47
    s_mul_i32 s45, s45, 57344
    s_add_u32 s47, s47, s45
    v_add_u32 v237, s47, v203
    s_add_u32 s45, s44, 5
    s_lshr_b32 s46, s45, 3
    s_and_b32 s45, s45, 7
    s_mul_i32 s47, s46, s42
    s_add_u32 s47, s47, s41
    s_cmp_eq_u32 s46, 2
    s_cselect_b32 s47, s43, s47
    s_mul_i32 s45, s45, 57344
    s_add_u32 s47, s47, s45
    s_sub_u32 s47, s47, 1024
    v_add_u32 v238, s47, v204
    s_mul_i32 s33, s24, 6144
    s_add_u32 s33, s33, 104448
    s_mov_b32 m0, s33
    s_nop 0
    buffer_load_dwordx4 v233, s[8:11], s29 offen lds
    buffer_load_dwordx4 v234, s[8:11], s29 offen offset:1024 lds
    buffer_load_dwordx4 v235, s[8:11], s29 offen offset:2048 lds
    buffer_load_dwordx4 v236, s[8:11], s29 offen offset:3072 lds
    s_add_u32 m0, s33, 4096
    s_nop 0
    buffer_load_dwordx4 v237, s[8:11], s29 offen lds
    buffer_load_dwordx4 v238, s[8:11], s29 offen offset:1024 lds
    s_mov_b32 s12, s72
    s_mov_b32 s13, s73
    s_mov_b32 s14, 0x800
    s_mov_b32 s15, 0x20000
    s_lshl_b32 s41, s24, 9
    s_add_u32 m0, s41, 161792
    v_lshl_add_u32 v200, v0, 4, s41
    s_mov_b32 exec_hi, 0
    buffer_load_dwordx4 v200, s[12:15], 0 offen lds
    s_mov_b32 exec_hi, -1
    v_mov_b32 v200, -1
    v_mov_b32 v201, -1
    v_mov_b32 v202, -1
    v_mov_b32 v203, -1
    v_lshlrev_b32 v204, 4, v0
    v_mov_b32 v205, 0
    s_lshl_b32 s41, s25, 1
    s_add_u32 s41, s41, s26
    s_lshl_b32 s42, s41, 14
    s_lshl_b32 s43, s24, 12
    s_add_u32 s42, s42, s43
    s_add_u32 s42, s42, 0x1c10000
    buffer_store_dwordx4 v[200:203], v204, s[16:19], s42 offen sc1
    buffer_store_dwordx4 v[200:203], v204, s[16:19], s42 offen offset:1024 sc1
    buffer_store_dwordx4 v[200:203], v204, s[16:19], s42 offen offset:2048 sc1
    buffer_store_dwordx4 v[200:203], v204, s[16:19], s42 offen offset:3072 sc1
    v_and_b32 v206, 31, v0
    v_lshlrev_b32 v206, 2, v206
    s_lshl_b32 s42, s25, 7
    s_add_u32 s42, s42, 0x1c60000
    s_lshl_b32 s41, s41, 7
    s_add_u32 s41, s41, 0x1c60800
    buffer_store_dword v205, v206, s[16:19], s42 offen sc1
    buffer_store_dword v205, v206, s[16:19], s41 offen sc1
    s_sub_u32 s41, s41, 0x1c60800
    s_mul_i32 s41, s41, 34
    s_add_u32 s41, s41, 0x1c62000
    buffer_store_dword v205, v206, s[16:19], s41 offen sc1
    v_mul_u32_u24 v252, 44, v0
    v_and_b32 v206, 15, v0
    v_lshrrev_b32 v207, 4, v0
    v_bfe_u32 v208, v0, 2, 2
    v_and_b32 v209, 3, v0
    v_lshrrev_b32 v200, 1, v206
    v_xor_b32 v200, v207, v200
    v_lshlrev_b32 v200, 4, v200
    v_lshl_add_u32 v200, v206, 7, v200
    s_lshl_b32 s41, s50, 14
    v_add_u32 v240, s41, v200
    v_xor_b32 v241, 64, v240
    v_lshl_add_u32 v200, v207, 3, v208
    v_lshrrev_b32 v201, 1, v208
    v_and_b32 v202, 1, v207
    v_lshl_or_b32 v201, v202, 1, v201
    v_lshlrev_b32 v203, 3, v209
    v_lshl_add_u32 v203, v200, 7, v203
    s_mul_i32 s41, s51, 6
    s_add_u32 s41, s41, 0
    s_lshr_b32 s42, s41, 2
    s_lshl_b32 s42, s42, 13
    s_add_u32 s42, s42, 104448
    s_and_b32 s41, s41, 3
    v_xor_b32 v204, s41, v201
    v_lshl_add_u32 v204, v204, 5, v203
    v_add_u32 v244, s42, v204
    s_mul_i32 s41, s51, 6
    s_add_u32 s41, s41, 1
    s_lshr_b32 s42, s41, 2
    s_lshl_b32 s42, s42, 13
    s_add_u32 s42, s42, 104448
    s_and_b32 s41, s41, 3
    v_xor_b32 v204, s41, v201
    v_lshl_add_u32 v204, v204, 5, v203
    v_add_u32 v245, s42, v204
    s_mul_i32 s41, s51, 6
    s_add_u32 s41, s41, 2
    s_lshr_b32 s42, s41, 2
    s_lshl_b32 s42, s42, 13
    s_add_u32 s42, s42, 104448
    s_and_b32 s41, s41, 3
    v_xor_b32 v204, s41, v201
    v_lshl_add_u32 v204, v204, 5, v203
    v_add_u32 v246, s42, v204
    s_mul_i32 s41, s51, 6
    s_add_u32 s41, s41, 3
    s_lshr_b32 s42, s41, 2
    s_lshl_b32 s42, s42, 13
    s_add_u32 s42, s42, 104448
    s_and_b32 s41, s41, 3
    v_xor_b32 v204, s41, v201
    v_lshl_add_u32 v204, v204, 5, v203
    v_add_u32 v247, s42, v204
    s_mul_i32 s41, s51, 6
    s_add_u32 s41, s41, 4
    s_lshr_b32 s42, s41, 2
    s_lshl_b32 s42, s42, 13
    s_add_u32 s42, s42, 104448
    s_and_b32 s41, s41, 3
    v_xor_b32 v204, s41, v201
    v_lshl_add_u32 v204, v204, 5, v203
    v_add_u32 v248, s42, v204
    s_mul_i32 s41, s51, 6
    s_add_u32 s41, s41, 5
    s_lshr_b32 s42, s41, 2
    s_lshl_b32 s42, s42, 13
    s_add_u32 s42, s42, 104448
    s_and_b32 s41, s41, 3
    v_xor_b32 v204, s41, v201
    v_lshl_add_u32 v204, v204, 5, v203
    v_add_u32 v249, s42, v204
    v_lshlrev_b32 v204, 4, v207
    v_add_u32 v250, 161792, v204
    v_add_u32 v250, s30, v250
    v_mov_b32 v232, 0
    v_mov_b32 v239, 0
    s_mov_b32 s80, s72
    s_mov_b32 s81, s73
    s_mov_b32 s82, 0x800
    s_mov_b32 s83, 0x20000
    s_mov_b32 s36, 0
    s_mov_b32 s37, 34816
    s_mov_b32 s38, 34816
    s_mov_b32 s39, -69632
    s_mov_b32 s40, 28672
    s_mov_b64 exec, 0
    s_cmp_eq_u32 s24, 0
    s_cbranch_scc1 L_pad_p1y_0
    s_cmp_eq_u32 s24, 1
    s_cbranch_scc1 L_pad_p1y_1
    s_cmp_eq_u32 s24, 2
    s_cbranch_scc1 L_pad_p1y_2
    s_branch L_pad_p1y_3
L_pad_p1y_ret:
    s_mov_b64 exec, -1
    s_add_u32 s32, s32, 34816
    s_add_u32 s53, s53, 1
    s_add_u32 s42, s53, s52
    s_and_b32 s42, s42, 3
    s_and_b32 s54, s53, -4
    s_or_b32 s54, s54, s42
    s_lshl_b32 s28, s54, 7
    s_mul_i32 s29, s54, 458752
    s_mov_b32 m0, s32
    s_nop 0
    buffer_load_dwordx4 v224, s[4:7], s28 offen lds
    buffer_load_dwordx4 v225, s[4:7], s28 offen offset:1024 lds
    buffer_load_dwordx4 v226, s[4:7], s28 offen offset:2048 lds
    buffer_load_dwordx4 v227, s[4:7], s28 offen offset:3072 lds
    s_add_u32 m0, s32, 4096
    s_nop 0
    buffer_load_dwordx4 v228, s[4:7], s28 offen lds
    buffer_load_dwordx4 v229, s[4:7], s28 offen offset:1024 lds
    buffer_load_dwordx4 v230, s[4:7], s28 offen offset:2048 lds
    buffer_load_dwordx4 v231, s[4:7], s28 offen offset:3072 lds
    s_add_u32 s33, s33, 28672
    s_mov_b32 m0, s33
    s_nop 0
    buffer_load_dwordx4 v233, s[8:11], s29 offen lds
    buffer_load_dwordx4 v234, s[8:11], s29 offen offset:1024 lds
    buffer_load_dwordx4 v235, s[8:11], s29 offen offset:2048 lds
    buffer_load_dwordx4 v236, s[8:11], s29 offen offset:3072 lds
    s_add_u32 m0, s33, 4096
    s_nop 0
    buffer_load_dwordx4 v237, s[8:11], s29 offen lds
    buffer_load_dwordx4 v238, s[8:11], s29 offen offset:1024 lds
    s_add_u32 s32, s32, 34816
    s_sub_u32 s33, s33, 28672
    s_sub_u32 s34, s28, s30
    s_mov_b32 s30, s28
    s_add_u32 s53, s53, 1
    s_add_u32 s42, s53, s52
    s_and_b32 s42, s42, 3
    s_and_b32 s54, s53, -4
    s_or_b32 s54, s54, s42
    s_lshl_b32 s28, s54, 7
    s_mul_i32 s29, s54, 458752
    s_waitcnt vmcnt(14)
    s_barrier
    v_mov_b32 v212, 1
    v_mov_b32 v213, 0
    s_mov_b64 exec, 1
    buffer_atomic_add v212, v213, s[20:23], 0 offen sc1
    s_mov_b64 exec, -1
    ds_read_b128 a[0:3], v240 offset:0
    ds_read_b64_tr_b16 a[36:37], v244 offset:0
    ds_read_b64_tr_b16 a[38:39], v244 offset:512
    ds_read_b64_tr_b16 a[40:41], v245 offset:0
    ds_read_b64_tr_b16 a[42:43], v245 offset:512
    ds_read_b64_tr_b16 a[44:45], v246 offset:0
    ds_read_b64_tr_b16 a[46:47], v246 offset:512
    ds_read_b64_tr_b16 a[48:49], v247 offset:0
    ds_read_b64_tr_b16 a[50:51], v247 offset:512
    ds_read_b64_tr_b16 a[52:53], v248 offset:0
    ds_read_b64_tr_b16 a[54:55], v248 offset:512
    ds_read_b64_tr_b16 a[56:57], v249 offset:0
    ds_read_b64_tr_b16 a[58:59], v249 offset:512
    ds_read_b128 a[60:63], v250 offset:0
    ds_read_b128 a[4:7], v240 offset:2048
    ds_read_b128 a[8:11], v240 offset:4096
    ds_read_b128 a[12:15], v240 offset:6144
    ds_read_b128 a[16:19], v240 offset:8192
    ds_read_b128 a[20:23], v240 offset:10240
    ds_read_b128 a[24:27], v240 offset:12288
    ds_read_b128 a[28:31], v240 offset:14336
    s_waitcnt lgkmcnt(0)
    v_mfma_f32_16x16x32_bf16 v[16:19], a[36:39], a[0:3], 0
    ds_read_b128 a[64:67], v241 offset:0
    v_mfma_f32_16x16x32_bf16 v[20:23], a[40:43], a[0:3], 0
    s_mov_b32 m0, s32
    v_mfma_f32_16x16x32_bf16 v[24:27], a[44:47], a[0:3], 0
    ds_read_b64_tr_b16 a[100:101], v244 offset:4096
    v_mfma_f32_16x16x32_bf16 v[28:31], a[48:51], a[0:3], 0
    ds_read_b64_tr_b16 a[102:103], v244 offset:4608
    v_mfma_f32_16x16x32_bf16 v[32:35], a[52:55], a[0:3], 0
    ds_read_b64_tr_b16 a[104:105], v245 offset:4096
    v_mfma_f32_16x16x32_bf16 v[36:39], a[56:59], a[0:3], 0
    buffer_load_dwordx4 v224, s[4:7], s28 offen lds
    v_mfma_f32_16x16x32_bf16 a[128:131], a[60:63], a[0:3], 0
    ds_read_b64_tr_b16 a[106:107], v245 offset:4608
    v_mfma_f32_16x16x32_bf16 v[40:43], a[36:39], a[4:7], 0
    ds_read_b64_tr_b16 a[108:109], v246 offset:4096
    v_mfma_f32_16x16x32_bf16 v[44:47], a[40:43], a[4:7], 0
    ds_read_b64_tr_b16 a[110:111], v246 offset:4608
    v_mfma_f32_16x16x32_bf16 v[48:51], a[44:47], a[4:7], 0
    buffer_load_dwordx4 v225, s[4:7], s28 offen offset:1024 lds
    v_mfma_f32_16x16x32_bf16 v[52:55], a[48:51], a[4:7], 0
    ds_read_b64_tr_b16 a[112:113], v247 offset:4096
    v_mfma_f32_16x16x32_bf16 v[56:59], a[52:55], a[4:7], 0
    ds_read_b64_tr_b16 a[114:115], v247 offset:4608
    v_mfma_f32_16x16x32_bf16 v[60:63], a[56:59], a[4:7], 0
    ds_read_b64_tr_b16 a[116:117], v248 offset:4096
    v_mfma_f32_16x16x32_bf16 a[132:135], a[60:63], a[4:7], 0
    ds_read_b64_tr_b16 a[118:119], v248 offset:4608
    v_mfma_f32_16x16x32_bf16 v[64:67], a[36:39], a[8:11], 0
    buffer_load_dwordx4 v226, s[4:7], s28 offen offset:2048 lds
    v_mfma_f32_16x16x32_bf16 v[68:71], a[40:43], a[8:11], 0
    ds_read_b64_tr_b16 a[120:121], v249 offset:4096
    v_mfma_f32_16x16x32_bf16 v[72:75], a[44:47], a[8:11], 0
    ds_read_b64_tr_b16 a[122:123], v249 offset:4608
    v_mfma_f32_16x16x32_bf16 v[76:79], a[48:51], a[8:11], 0
    ds_read_b128 a[124:127], v250 offset:64
    v_mfma_f32_16x16x32_bf16 v[80:83], a[52:55], a[8:11], 0
    buffer_load_dwordx4 v227, s[4:7], s28 offen offset:3072 lds
    v_mfma_f32_16x16x32_bf16 v[84:87], a[56:59], a[8:11], 0
    ds_read_b128 a[68:71], v241 offset:2048
    v_mfma_f32_16x16x32_bf16 a[136:139], a[60:63], a[8:11], 0
    ds_read_b128 a[72:75], v241 offset:4096
    v_mfma_f32_16x16x32_bf16 v[88:91], a[36:39], a[12:15], 0
    ds_read_b128 a[76:79], v241 offset:6144
    v_mfma_f32_16x16x32_bf16 v[92:95], a[40:43], a[12:15], 0
    ds_read_b128 a[80:83], v241 offset:8192
    v_mfma_f32_16x16x32_bf16 v[96:99], a[44:47], a[12:15], 0
    s_add_u32 m0, s32, 4096
    v_mfma_f32_16x16x32_bf16 v[100:103], a[48:51], a[12:15], 0
    ds_read_b128 a[84:87], v241 offset:10240
    v_mfma_f32_16x16x32_bf16 v[104:107], a[52:55], a[12:15], 0
    ds_read_b128 a[88:91], v241 offset:12288
    v_mfma_f32_16x16x32_bf16 v[108:111], a[56:59], a[12:15], 0
    ds_read_b128 a[92:95], v241 offset:14336
    v_mfma_f32_16x16x32_bf16 a[140:143], a[60:63], a[12:15], 0
    buffer_load_dwordx4 v228, s[4:7], s28 offen lds
    v_mfma_f32_16x16x32_bf16 v[112:115], a[36:39], a[16:19], 0
    v_add_u32 v241, s37, v241
    v_mfma_f32_16x16x32_bf16 v[116:119], a[40:43], a[16:19], 0
    v_add_u32 v240, s37, v240
    v_mfma_f32_16x16x32_bf16 v[120:123], a[44:47], a[16:19], 0
    v_add_u32 v250, s34, v250
    v_mfma_f32_16x16x32_bf16 v[124:127], a[48:51], a[16:19], 0
    buffer_load_dwordx4 v229, s[4:7], s28 offen offset:1024 lds
    v_mfma_f32_16x16x32_bf16 v[128:131], a[52:55], a[16:19], 0
    v_add_u32 v244, s40, v244
    v_mfma_f32_16x16x32_bf16 v[132:135], a[56:59], a[16:19], 0
    v_add_u32 v245, s40, v245
    v_mfma_f32_16x16x32_bf16 a[144:147], a[60:63], a[16:19], 0
    v_add_u32 v246, s40, v246
    v_mfma_f32_16x16x32_bf16 v[136:139], a[36:39], a[20:23], 0
    v_add_u32 v247, s40, v247
    v_mfma_f32_16x16x32_bf16 v[140:143], a[40:43], a[20:23], 0
    buffer_load_dwordx4 v230, s[4:7], s28 offen offset:2048 lds
    v_mfma_f32_16x16x32_bf16 v[144:147], a[44:47], a[20:23], 0
    v_add_u32 v248, s40, v248
    v_mfma_f32_16x16x32_bf16 v[148:151], a[48:51], a[20:23], 0
    v_add_u32 v249, s40, v249
    v_mfma_f32_16x16x32_bf16 v[152:155], a[52:55], a[20:23], 0
    v_mfma_f32_16x16x32_bf16 v[156:159], a[56:59], a[20:23], 0
    buffer_load_dwordx4 v231, s[4:7], s28 offen offset:3072 lds
    v_mfma_f32_16x16x32_bf16 a[148:151], a[60:63], a[20:23], 0
    v_mfma_f32_16x16x32_bf16 v[160:163], a[36:39], a[24:27], 0
    v_mfma_f32_16x16x32_bf16 v[164:167], a[40:43], a[24:27], 0
    v_mfma_f32_16x16x32_bf16 v[168:171], a[44:47], a[24:27], 0
    v_mfma_f32_16x16x32_bf16 v[172:175], a[48:51], a[24:27], 0
    v_mfma_f32_16x16x32_bf16 v[176:179], a[52:55], a[24:27], 0
    v_mfma_f32_16x16x32_bf16 v[180:183], a[56:59], a[24:27], 0
    v_mfma_f32_16x16x32_bf16 a[152:155], a[60:63], a[24:27], 0
    v_mfma_f32_16x16x32_bf16 v[184:187], a[36:39], a[28:31], 0
    v_mfma_f32_16x16x32_bf16 v[188:191], a[40:43], a[28:31], 0
    v_mfma_f32_16x16x32_bf16 v[192:195], a[44:47], a[28:31], 0
    v_mfma_f32_16x16x32_bf16 v[196:199], a[48:51], a[28:31], 0
    v_mfma_f32_16x16x32_bf16 v[200:203], a[52:55], a[28:31], 0
    v_mfma_f32_16x16x32_bf16 v[204:207], a[56:59], a[28:31], 0
    v_mfma_f32_16x16x32_bf16 a[156:159], a[60:63], a[28:31], 0
    s_waitcnt vmcnt(9) lgkmcnt(0)
    s_barrier
    v_mfma_f32_16x16x32_bf16 v[16:19], a[100:103], a[64:67], v[16:19]
    s_mov_b32 m0, s33
    v_mfma_f32_16x16x32_bf16 v[20:23], a[104:107], a[64:67], v[20:23]
    ds_read_b128 a[0:3], v240 offset:0
    v_mfma_f32_16x16x32_bf16 v[24:27], a[108:111], a[64:67], v[24:27]
    ds_read_b64_tr_b16 a[36:37], v244 offset:0
    v_mfma_f32_16x16x32_bf16 v[28:31], a[112:115], a[64:67], v[28:31]
    ds_read_b64_tr_b16 a[38:39], v244 offset:512
    v_mfma_f32_16x16x32_bf16 v[32:35], a[116:119], a[64:67], v[32:35]
    buffer_load_dwordx4 v233, s[8:11], s29 offen lds
    v_mfma_f32_16x16x32_bf16 v[36:39], a[120:123], a[64:67], v[36:39]
    ds_read_b64_tr_b16 a[40:41], v245 offset:0
    v_mfma_f32_16x16x32_bf16 a[128:131], a[124:127], a[64:67], a[128:131]
    ds_read_b64_tr_b16 a[42:43], v245 offset:512
    v_mfma_f32_16x16x32_bf16 v[40:43], a[100:103], a[68:71], v[40:43]
    ds_read_b64_tr_b16 a[44:45], v246 offset:0
    v_mfma_f32_16x16x32_bf16 v[44:47], a[104:107], a[68:71], v[44:47]
    buffer_load_dwordx4 v234, s[8:11], s29 offen offset:1024 lds
    v_mfma_f32_16x16x32_bf16 v[48:51], a[108:111], a[68:71], v[48:51]
    ds_read_b64_tr_b16 a[46:47], v246 offset:512
    v_mfma_f32_16x16x32_bf16 v[52:55], a[112:115], a[68:71], v[52:55]
    ds_read_b64_tr_b16 a[48:49], v247 offset:0
    v_mfma_f32_16x16x32_bf16 v[56:59], a[116:119], a[68:71], v[56:59]
    ds_read_b64_tr_b16 a[50:51], v247 offset:512
    v_mfma_f32_16x16x32_bf16 v[60:63], a[120:123], a[68:71], v[60:63]
    buffer_load_dwordx4 v235, s[8:11], s29 offen offset:2048 lds
    v_mfma_f32_16x16x32_bf16 a[132:135], a[124:127], a[68:71], a[132:135]
    ds_read_b64_tr_b16 a[52:53], v248 offset:0
    v_mfma_f32_16x16x32_bf16 v[64:67], a[100:103], a[72:75], v[64:67]
    ds_read_b64_tr_b16 a[54:55], v248 offset:512
    v_mfma_f32_16x16x32_bf16 v[68:71], a[104:107], a[72:75], v[68:71]
    ds_read_b64_tr_b16 a[56:57], v249 offset:0
    v_mfma_f32_16x16x32_bf16 v[72:75], a[108:111], a[72:75], v[72:75]
    buffer_load_dwordx4 v236, s[8:11], s29 offen offset:3072 lds
    v_mfma_f32_16x16x32_bf16 v[76:79], a[112:115], a[72:75], v[76:79]
    ds_read_b64_tr_b16 a[58:59], v249 offset:512
    v_mfma_f32_16x16x32_bf16 v[80:83], a[116:119], a[72:75], v[80:83]
    ds_read_b128 a[60:63], v250 offset:0
    v_mfma_f32_16x16x32_bf16 v[84:87], a[120:123], a[72:75], v[84:87]
    ds_read_b128 a[4:7], v240 offset:2048
    v_mfma_f32_16x16x32_bf16 a[136:139], a[124:127], a[72:75], a[136:139]
    ds_read_b128 a[8:11], v240 offset:4096
    v_mfma_f32_16x16x32_bf16 v[88:91], a[100:103], a[76:79], v[88:91]
    s_add_u32 m0, s33, 4096
    v_mfma_f32_16x16x32_bf16 v[92:95], a[104:107], a[76:79], v[92:95]
    ds_read_b128 a[12:15], v240 offset:6144
    v_mfma_f32_16x16x32_bf16 v[96:99], a[108:111], a[76:79], v[96:99]
    ds_read_b128 a[16:19], v240 offset:8192
    v_mfma_f32_16x16x32_bf16 v[100:103], a[112:115], a[76:79], v[100:103]
    ds_read_b128 a[20:23], v240 offset:10240
    v_mfma_f32_16x16x32_bf16 v[104:107], a[116:119], a[76:79], v[104:107]
    buffer_load_dwordx4 v237, s[8:11], s29 offen lds
    v_mfma_f32_16x16x32_bf16 v[108:111], a[120:123], a[76:79], v[108:111]
    ds_read_b128 a[24:27], v240 offset:12288
    v_mfma_f32_16x16x32_bf16 a[140:143], a[124:127], a[76:79], a[140:143]
    ds_read_b128 a[28:31], v240 offset:14336
    v_mfma_f32_16x16x32_bf16 v[112:115], a[100:103], a[80:83], v[112:115]
    v_mfma_f32_16x16x32_bf16 v[116:119], a[104:107], a[80:83], v[116:119]
    buffer_load_dwordx4 v238, s[8:11], s29 offen offset:1024 lds
    v_mfma_f32_16x16x32_bf16 v[120:123], a[108:111], a[80:83], v[120:123]
    s_add_u32 s32, s32, s39
    v_mfma_f32_16x16x32_bf16 v[124:127], a[112:115], a[80:83], v[124:127]
    s_add_u32 s33, s33, s40
    v_mfma_f32_16x16x32_bf16 v[128:131], a[116:119], a[80:83], v[128:131]
    s_sub_u32 s34, s28, s30
    v_mfma_f32_16x16x32_bf16 v[132:135], a[120:123], a[80:83], v[132:135]
    s_mov_b32 s30, s28
    v_mfma_f32_16x16x32_bf16 a[144:147], a[124:127], a[80:83], a[144:147]
    s_add_u32 s53, s53, 1
    v_mfma_f32_16x16x32_bf16 v[136:139], a[100:103], a[84:87], v[136:139]
    s_add_u32 s42, s53, s52
    v_mfma_f32_16x16x32_bf16 v[140:143], a[104:107], a[84:87], v[140:143]
    s_and_b32 s42, s42, 3
    v_mfma_f32_16x16x32_bf16 v[144:147], a[108:111], a[84:87], v[144:147]
    s_and_b32 s54, s53, -4
    v_mfma_f32_16x16x32_bf16 v[148:151], a[112:115], a[84:87], v[148:151]
    s_or_b32 s54, s54, s42
    v_mfma_f32_16x16x32_bf16 v[152:155], a[116:119], a[84:87], v[152:155]
    s_lshl_b32 s28, s54, 7
    v_mfma_f32_16x16x32_bf16 v[156:159], a[120:123], a[84:87], v[156:159]
    s_mul_i32 s29, s54, 458752
    v_mfma_f32_16x16x32_bf16 a[148:151], a[124:127], a[84:87], a[148:151]
    s_sub_u32 s40, 0, s40
    v_mfma_f32_16x16x32_bf16 v[160:163], a[100:103], a[88:91], v[160:163]
    s_mov_b32 s41, s37
    v_mfma_f32_16x16x32_bf16 v[164:167], a[104:107], a[88:91], v[164:167]
    s_mov_b32 s37, s38
    v_mfma_f32_16x16x32_bf16 v[168:171], a[108:111], a[88:91], v[168:171]
    s_mov_b32 s38, s39
    v_mfma_f32_16x16x32_bf16 v[172:175], a[112:115], a[88:91], v[172:175]
    s_mov_b32 s39, s41
    v_mfma_f32_16x16x32_bf16 v[176:179], a[116:119], a[88:91], v[176:179]
    v_mfma_f32_16x16x32_bf16 v[180:183], a[120:123], a[88:91], v[180:183]
    v_mfma_f32_16x16x32_bf16 a[152:155], a[124:127], a[88:91], a[152:155]
    v_mfma_f32_16x16x32_bf16 v[184:187], a[100:103], a[92:95], v[184:187]
    v_mfma_f32_16x16x32_bf16 v[188:191], a[104:107], a[92:95], v[188:191]
    v_mfma_f32_16x16x32_bf16 v[192:195], a[108:111], a[92:95], v[192:195]
    v_mfma_f32_16x16x32_bf16 v[196:199], a[112:115], a[92:95], v[196:199]
    v_mfma_f32_16x16x32_bf16 v[200:203], a[116:119], a[92:95], v[200:203]
    v_mfma_f32_16x16x32_bf16 v[204:207], a[120:123], a[92:95], v[204:207]
    v_mfma_f32_16x16x32_bf16 a[156:159], a[124:127], a[92:95], a[156:159]
    s_waitcnt lgkmcnt(0)
L_p1y_loop:
    v_mfma_f32_16x16x32_bf16 v[16:19], a[36:39], a[0:3], v[16:19]
    ds_read_b128 a[64:67], v241 offset:0
    v_mfma_f32_16x16x32_bf16 v[20:23], a[40:43], a[0:3], v[20:23]
    s_mov_b32 m0, s32
    v_mfma_f32_16x16x32_bf16 v[24:27], a[44:47], a[0:3], v[24:27]
    ds_read_b64_tr_b16 a[100:101], v244 offset:4096
    v_mfma_f32_16x16x32_bf16 v[28:31], a[48:51], a[0:3], v[28:31]
    ds_read_b64_tr_b16 a[102:103], v244 offset:4608
    v_mfma_f32_16x16x32_bf16 v[32:35], a[52:55], a[0:3], v[32:35]
    ds_read_b64_tr_b16 a[104:105], v245 offset:4096
    v_mfma_f32_16x16x32_bf16 v[36:39], a[56:59], a[0:3], v[36:39]
    buffer_load_dwordx4 v224, s[4:7], s28 offen lds
    v_mfma_f32_16x16x32_bf16 a[128:131], a[60:63], a[0:3], a[128:131]
    ds_read_b64_tr_b16 a[106:107], v245 offset:4608
    v_mfma_f32_16x16x32_bf16 v[40:43], a[36:39], a[4:7], v[40:43]
    ds_read_b64_tr_b16 a[108:109], v246 offset:4096
    v_mfma_f32_16x16x32_bf16 v[44:47], a[40:43], a[4:7], v[44:47]
    ds_read_b64_tr_b16 a[110:111], v246 offset:4608
    v_mfma_f32_16x16x32_bf16 v[48:51], a[44:47], a[4:7], v[48:51]
    buffer_load_dwordx4 v225, s[4:7], s28 offen offset:1024 lds
    v_mfma_f32_16x16x32_bf16 v[52:55], a[48:51], a[4:7], v[52:55]
    ds_read_b64_tr_b16 a[112:113], v247 offset:4096
    v_mfma_f32_16x16x32_bf16 v[56:59], a[52:55], a[4:7], v[56:59]
    ds_read_b64_tr_b16 a[114:115], v247 offset:4608
    v_mfma_f32_16x16x32_bf16 v[60:63], a[56:59], a[4:7], v[60:63]
    ds_read_b64_tr_b16 a[116:117], v248 offset:4096
    v_mfma_f32_16x16x32_bf16 a[132:135], a[60:63], a[4:7], a[132:135]
    ds_read_b64_tr_b16 a[118:119], v248 offset:4608
    v_mfma_f32_16x16x32_bf16 v[64:67], a[36:39], a[8:11], v[64:67]
    buffer_load_dwordx4 v226, s[4:7], s28 offen offset:2048 lds
    v_mfma_f32_16x16x32_bf16 v[68:71], a[40:43], a[8:11], v[68:71]
    ds_read_b64_tr_b16 a[120:121], v249 offset:4096
    v_mfma_f32_16x16x32_bf16 v[72:75], a[44:47], a[8:11], v[72:75]
    ds_read_b64_tr_b16 a[122:123], v249 offset:4608
    v_mfma_f32_16x16x32_bf16 v[76:79], a[48:51], a[8:11], v[76:79]
    ds_read_b128 a[124:127], v250 offset:64
    v_mfma_f32_16x16x32_bf16 v[80:83], a[52:55], a[8:11], v[80:83]
    buffer_load_dwordx4 v227, s[4:7], s28 offen offset:3072 lds
    v_mfma_f32_16x16x32_bf16 v[84:87], a[56:59], a[8:11], v[84:87]
    ds_read_b128 a[68:71], v241 offset:2048
    v_mfma_f32_16x16x32_bf16 a[136:139], a[60:63], a[8:11], a[136:139]
    ds_read_b128 a[72:75], v241 offset:4096
    v_mfma_f32_16x16x32_bf16 v[88:91], a[36:39], a[12:15], v[88:91]
    ds_read_b128 a[76:79], v241 offset:6144
    v_mfma_f32_16x16x32_bf16 v[92:95], a[40:43], a[12:15], v[92:95]
    ds_read_b128 a[80:83], v241 offset:8192
    v_mfma_f32_16x16x32_bf16 v[96:99], a[44:47], a[12:15], v[96:99]
    s_add_u32 m0, s32, 4096
    v_mfma_f32_16x16x32_bf16 v[100:103], a[48:51], a[12:15], v[100:103]
    ds_read_b128 a[84:87], v241 offset:10240
    v_mfma_f32_16x16x32_bf16 v[104:107], a[52:55], a[12:15], v[104:107]
    ds_read_b128 a[88:91], v241 offset:12288
    v_mfma_f32_16x16x32_bf16 v[108:111], a[56:59], a[12:15], v[108:111]
    ds_read_b128 a[92:95], v241 offset:14336
    v_mfma_f32_16x16x32_bf16 a[140:143], a[60:63], a[12:15], a[140:143]
    buffer_load_dwordx4 v228, s[4:7], s28 offen lds
    v_mfma_f32_16x16x32_bf16 v[112:115], a[36:39], a[16:19], v[112:115]
    v_add_u32 v241, s37, v241
    v_mfma_f32_16x16x32_bf16 v[116:119], a[40:43], a[16:19], v[116:119]
    v_add_u32 v240, s37, v240
    v_mfma_f32_16x16x32_bf16 v[120:123], a[44:47], a[16:19], v[120:123]
    v_add_u32 v250, s34, v250
    v_mfma_f32_16x16x32_bf16 v[124:127], a[48:51], a[16:19], v[124:127]
    buffer_load_dwordx4 v229, s[4:7], s28 offen offset:1024 lds
    v_mfma_f32_16x16x32_bf16 v[128:131], a[52:55], a[16:19], v[128:131]
    v_add_u32 v244, s40, v244
    v_mfma_f32_16x16x32_bf16 v[132:135], a[56:59], a[16:19], v[132:135]
    v_add_u32 v245, s40, v245
    v_mfma_f32_16x16x32_bf16 a[144:147], a[60:63], a[16:19], a[144:147]
    v_add_u32 v246, s40, v246
    v_mfma_f32_16x16x32_bf16 v[136:139], a[36:39], a[20:23], v[136:139]
    v_add_u32 v247, s40, v247
    v_mfma_f32_16x16x32_bf16 v[140:143], a[40:43], a[20:23], v[140:143]
    buffer_load_dwordx4 v230, s[4:7], s28 offen offset:2048 lds
    v_mfma_f32_16x16x32_bf16 v[144:147], a[44:47], a[20:23], v[144:147]
    v_add_u32 v248, s40, v248
    v_mfma_f32_16x16x32_bf16 v[148:151], a[48:51], a[20:23], v[148:151]
    v_add_u32 v249, s40, v249
    v_mfma_f32_16x16x32_bf16 v[152:155], a[52:55], a[20:23], v[152:155]
    v_mfma_f32_16x16x32_bf16 v[156:159], a[56:59], a[20:23], v[156:159]
    buffer_load_dwordx4 v231, s[4:7], s28 offen offset:3072 lds
    v_mfma_f32_16x16x32_bf16 a[148:151], a[60:63], a[20:23], a[148:151]
    v_mfma_f32_16x16x32_bf16 v[160:163], a[36:39], a[24:27], v[160:163]
    v_mfma_f32_16x16x32_bf16 v[164:167], a[40:43], a[24:27], v[164:167]
    v_mfma_f32_16x16x32_bf16 v[168:171], a[44:47], a[24:27], v[168:171]
    v_mfma_f32_16x16x32_bf16 v[172:175], a[48:51], a[24:27], v[172:175]
    v_mfma_f32_16x16x32_bf16 v[176:179], a[52:55], a[24:27], v[176:179]
    v_mfma_f32_16x16x32_bf16 v[180:183], a[56:59], a[24:27], v[180:183]
    v_mfma_f32_16x16x32_bf16 a[152:155], a[60:63], a[24:27], a[152:155]
    v_mfma_f32_16x16x32_bf16 v[184:187], a[36:39], a[28:31], v[184:187]
    v_mfma_f32_16x16x32_bf16 v[188:191], a[40:43], a[28:31], v[188:191]
    v_mfma_f32_16x16x32_bf16 v[192:195], a[44:47], a[28:31], v[192:195]
    v_mfma_f32_16x16x32_bf16 v[196:199], a[48:51], a[28:31], v[196:199]
    v_mfma_f32_16x16x32_bf16 v[200:203], a[52:55], a[28:31], v[200:203]
    v_mfma_f32_16x16x32_bf16 v[204:207], a[56:59], a[28:31], v[204:207]
    v_mfma_f32_16x16x32_bf16 a[156:159], a[60:63], a[28:31], a[156:159]
    s_waitcnt vmcnt(8) lgkmcnt(0)
    s_barrier
    v_mfma_f32_16x16x32_bf16 v[16:19], a[100:103], a[64:67], v[16:19]
    s_mov_b32 m0, s33
    v_mfma_f32_16x16x32_bf16 v[20:23], a[104:107], a[64:67], v[20:23]
    ds_read_b128 a[0:3], v240 offset:0
    v_mfma_f32_16x16x32_bf16 v[24:27], a[108:111], a[64:67], v[24:27]
    ds_read_b64_tr_b16 a[36:37], v244 offset:0
    v_mfma_f32_16x16x32_bf16 v[28:31], a[112:115], a[64:67], v[28:31]
    ds_read_b64_tr_b16 a[38:39], v244 offset:512
    v_mfma_f32_16x16x32_bf16 v[32:35], a[116:119], a[64:67], v[32:35]
    buffer_load_dwordx4 v233, s[8:11], s29 offen lds
    v_mfma_f32_16x16x32_bf16 v[36:39], a[120:123], a[64:67], v[36:39]
    ds_read_b64_tr_b16 a[40:41], v245 offset:0
    v_mfma_f32_16x16x32_bf16 a[128:131], a[124:127], a[64:67], a[128:131]
    ds_read_b64_tr_b16 a[42:43], v245 offset:512
    v_mfma_f32_16x16x32_bf16 v[40:43], a[100:103], a[68:71], v[40:43]
    ds_read_b64_tr_b16 a[44:45], v246 offset:0
    v_mfma_f32_16x16x32_bf16 v[44:47], a[104:107], a[68:71], v[44:47]
    buffer_load_dwordx4 v234, s[8:11], s29 offen offset:1024 lds
    v_mfma_f32_16x16x32_bf16 v[48:51], a[108:111], a[68:71], v[48:51]
    ds_read_b64_tr_b16 a[46:47], v246 offset:512
    v_mfma_f32_16x16x32_bf16 v[52:55], a[112:115], a[68:71], v[52:55]
    ds_read_b64_tr_b16 a[48:49], v247 offset:0
    v_mfma_f32_16x16x32_bf16 v[56:59], a[116:119], a[68:71], v[56:59]
    ds_read_b64_tr_b16 a[50:51], v247 offset:512
    v_mfma_f32_16x16x32_bf16 v[60:63], a[120:123], a[68:71], v[60:63]
    buffer_load_dwordx4 v235, s[8:11], s29 offen offset:2048 lds
    v_mfma_f32_16x16x32_bf16 a[132:135], a[124:127], a[68:71], a[132:135]
    ds_read_b64_tr_b16 a[52:53], v248 offset:0
    v_mfma_f32_16x16x32_bf16 v[64:67], a[100:103], a[72:75], v[64:67]
    ds_read_b64_tr_b16 a[54:55], v248 offset:512
    v_mfma_f32_16x16x32_bf16 v[68:71], a[104:107], a[72:75], v[68:71]
    ds_read_b64_tr_b16 a[56:57], v249 offset:0
    v_mfma_f32_16x16x32_bf16 v[72:75], a[108:111], a[72:75], v[72:75]
    buffer_load_dwordx4 v236, s[8:11], s29 offen offset:3072 lds
    v_mfma_f32_16x16x32_bf16 v[76:79], a[112:115], a[72:75], v[76:79]
    ds_read_b64_tr_b16 a[58:59], v249 offset:512
    v_mfma_f32_16x16x32_bf16 v[80:83], a[116:119], a[72:75], v[80:83]
    ds_read_b128 a[60:63], v250 offset:0
    v_mfma_f32_16x16x32_bf16 v[84:87], a[120:123], a[72:75], v[84:87]
    ds_read_b128 a[4:7], v240 offset:2048
    v_mfma_f32_16x16x32_bf16 a[136:139], a[124:127], a[72:75], a[136:139]
    ds_read_b128 a[8:11], v240 offset:4096
    v_mfma_f32_16x16x32_bf16 v[88:91], a[100:103], a[76:79], v[88:91]
    s_add_u32 m0, s33, 4096
    v_mfma_f32_16x16x32_bf16 v[92:95], a[104:107], a[76:79], v[92:95]
    ds_read_b128 a[12:15], v240 offset:6144
    v_mfma_f32_16x16x32_bf16 v[96:99], a[108:111], a[76:79], v[96:99]
    ds_read_b128 a[16:19], v240 offset:8192
    v_mfma_f32_16x16x32_bf16 v[100:103], a[112:115], a[76:79], v[100:103]
    ds_read_b128 a[20:23], v240 offset:10240
    v_mfma_f32_16x16x32_bf16 v[104:107], a[116:119], a[76:79], v[104:107]
    buffer_load_dwordx4 v237, s[8:11], s29 offen lds
    v_mfma_f32_16x16x32_bf16 v[108:111], a[120:123], a[76:79], v[108:111]
    ds_read_b128 a[24:27], v240 offset:12288
    v_mfma_f32_16x16x32_bf16 a[140:143], a[124:127], a[76:79], a[140:143]
    ds_read_b128 a[28:31], v240 offset:14336
    v_mfma_f32_16x16x32_bf16 v[112:115], a[100:103], a[80:83], v[112:115]
    v_mfma_f32_16x16x32_bf16 v[116:119], a[104:107], a[80:83], v[116:119]
    buffer_load_dwordx4 v238, s[8:11], s29 offen offset:1024 lds
    v_mfma_f32_16x16x32_bf16 v[120:123], a[108:111], a[80:83], v[120:123]
    s_add_u32 s32, s32, s39
    v_mfma_f32_16x16x32_bf16 v[124:127], a[112:115], a[80:83], v[124:127]
    s_add_u32 s33, s33, s40
    v_mfma_f32_16x16x32_bf16 v[128:131], a[116:119], a[80:83], v[128:131]
    s_sub_u32 s34, s28, s30
    v_mfma_f32_16x16x32_bf16 v[132:135], a[120:123], a[80:83], v[132:135]
    s_mov_b32 s30, s28
    v_mfma_f32_16x16x32_bf16 a[144:147], a[124:127], a[80:83], a[144:147]
    s_add_u32 s53, s53, 1
    v_mfma_f32_16x16x32_bf16 v[136:139], a[100:103], a[84:87], v[136:139]
    s_add_u32 s42, s53, s52
    v_mfma_f32_16x16x32_bf16 v[140:143], a[104:107], a[84:87], v[140:143]
    s_and_b32 s42, s42, 3
    v_mfma_f32_16x16x32_bf16 v[144:147], a[108:111], a[84:87], v[144:147]
    s_and_b32 s54, s53, -4
    v_mfma_f32_16x16x32_bf16 v[148:151], a[112:115], a[84:87], v[148:151]
    s_or_b32 s54, s54, s42
    v_mfma_f32_16x16x32_bf16 v[152:155], a[116:119], a[84:87], v[152:155]
    s_lshl_b32 s28, s54, 7
    v_mfma_f32_16x16x32_bf16 v[156:159], a[120:123], a[84:87], v[156:159]
    s_mul_i32 s29, s54, 458752
    v_mfma_f32_16x16x32_bf16 a[148:151], a[124:127], a[84:87], a[148:151]
    s_sub_u32 s40, 0, s40
    v_mfma_f32_16x16x32_bf16 v[160:163], a[100:103], a[88:91], v[160:163]
    s_mov_b32 s41, s37
    v_mfma_f32_16x16x32_bf16 v[164:167], a[104:107], a[88:91], v[164:167]
    s_mov_b32 s37, s38
    v_mfma_f32_16x16x32_bf16 v[168:171], a[108:111], a[88:91], v[168:171]
    s_mov_b32 s38, s39
    v_mfma_f32_16x16x32_bf16 v[172:175], a[112:115], a[88:91], v[172:175]
    s_mov_b32 s39, s41
    v_mfma_f32_16x16x32_bf16 v[176:179], a[116:119], a[88:91], v[176:179]
    s_add_u32 s36, s36, 1
    v_mfma_f32_16x16x32_bf16 v[180:183], a[120:123], a[88:91], v[180:183]
    v_mfma_f32_16x16x32_bf16 a[152:155], a[124:127], a[88:91], a[152:155]
    v_mfma_f32_16x16x32_bf16 v[184:187], a[100:103], a[92:95], v[184:187]
    v_mfma_f32_16x16x32_bf16 v[188:191], a[104:107], a[92:95], v[188:191]
    v_mfma_f32_16x16x32_bf16 v[192:195], a[108:111], a[92:95], v[192:195]
    v_mfma_f32_16x16x32_bf16 v[196:199], a[112:115], a[92:95], v[196:199]
    v_mfma_f32_16x16x32_bf16 v[200:203], a[116:119], a[92:95], v[200:203]
    v_mfma_f32_16x16x32_bf16 v[204:207], a[120:123], a[92:95], v[204:207]
    v_mfma_f32_16x16x32_bf16 a[156:159], a[124:127], a[92:95], a[156:159]
    s_waitcnt lgkmcnt(0)
    s_cmp_lt_u32 s36, 13
    s_cbranch_scc1 L_p1y_loop
    v_mfma_f32_16x16x32_bf16 v[16:19], a[36:39], a[0:3], v[16:19]
    ds_read_b128 a[64:67], v241 offset:0
    v_mfma_f32_16x16x32_bf16 v[20:23], a[40:43], a[0:3], v[20:23]
    ds_read_b64_tr_b16 a[100:101], v244 offset:4096
    v_mfma_f32_16x16x32_bf16 v[24:27], a[44:47], a[0:3], v[24:27]
    ds_read_b64_tr_b16 a[102:103], v244 offset:4608
    v_mfma_f32_16x16x32_bf16 v[28:31], a[48:51], a[0:3], v[28:31]
    ds_read_b64_tr_b16 a[104:105], v245 offset:4096
    v_mfma_f32_16x16x32_bf16 v[32:35], a[52:55], a[0:3], v[32:35]
    ds_read_b64_tr_b16 a[106:107], v245 offset:4608
    v_mfma_f32_16x16x32_bf16 v[36:39], a[56:59], a[0:3], v[36:39]
    ds_read_b64_tr_b16 a[108:109], v246 offset:4096
    v_mfma_f32_16x16x32_bf16 a[128:131], a[60:63], a[0:3], a[128:131]
    ds_read_b64_tr_b16 a[110:111], v246 offset:4608
    v_mfma_f32_16x16x32_bf16 v[40:43], a[36:39], a[4:7], v[40:43]
    ds_read_b64_tr_b16 a[112:113], v247 offset:4096
    v_mfma_f32_16x16x32_bf16 v[44:47], a[40:43], a[4:7], v[44:47]
    ds_read_b64_tr_b16 a[114:115], v247 offset:4608
    v_mfma_f32_16x16x32_bf16 v[48:51], a[44:47], a[4:7], v[48:51]
    ds_read_b64_tr_b16 a[116:117], v248 offset:4096
    v_mfma_f32_16x16x32_bf16 v[52:55], a[48:51], a[4:7], v[52:55]
    ds_read_b64_tr_b16 a[118:119], v248 offset:4608
    v_mfma_f32_16x16x32_bf16 v[56:59], a[52:55], a[4:7], v[56:59]
    ds_read_b64_tr_b16 a[120:121], v249 offset:4096
    v_mfma_f32_16x16x32_bf16 v[60:63], a[56:59], a[4:7], v[60:63]
    ds_read_b64_tr_b16 a[122:123], v249 offset:4608
    v_mfma_f32_16x16x32_bf16 a[132:135], a[60:63], a[4:7], a[132:135]
    ds_read_b128 a[124:127], v250 offset:64
    v_mfma_f32_16x16x32_bf16 v[64:67], a[36:39], a[8:11], v[64:67]
    ds_read_b128 a[68:71], v241 offset:2048
    v_mfma_f32_16x16x32_bf16 v[68:71], a[40:43], a[8:11], v[68:71]
    ds_read_b128 a[72:75], v241 offset:4096
    v_mfma_f32_16x16x32_bf16 v[72:75], a[44:47], a[8:11], v[72:75]
    ds_read_b128 a[76:79], v241 offset:6144
    v_mfma_f32_16x16x32_bf16 v[76:79], a[48:51], a[8:11], v[76:79]
    ds_read_b128 a[80:83], v241 offset:8192
    v_mfma_f32_16x16x32_bf16 v[80:83], a[52:55], a[8:11], v[80:83]
    ds_read_b128 a[84:87], v241 offset:10240
    v_mfma_f32_16x16x32_bf16 v[84:87], a[56:59], a[8:11], v[84:87]
    ds_read_b128 a[88:91], v241 offset:12288
    v_mfma_f32_16x16x32_bf16 a[136:139], a[60:63], a[8:11], a[136:139]
    ds_read_b128 a[92:95], v241 offset:14336
    v_mfma_f32_16x16x32_bf16 v[88:91], a[36:39], a[12:15], v[88:91]
    v_add_u32 v241, s37, v241
    v_mfma_f32_16x16x32_bf16 v[92:95], a[40:43], a[12:15], v[92:95]
    v_add_u32 v240, s37, v240
    v_mfma_f32_16x16x32_bf16 v[96:99], a[44:47], a[12:15], v[96:99]
    v_add_u32 v250, s34, v250
    v_mfma_f32_16x16x32_bf16 v[100:103], a[48:51], a[12:15], v[100:103]
    v_add_u32 v244, s40, v244
    v_mfma_f32_16x16x32_bf16 v[104:107], a[52:55], a[12:15], v[104:107]
    v_add_u32 v245, s40, v245
    v_mfma_f32_16x16x32_bf16 v[108:111], a[56:59], a[12:15], v[108:111]
    v_add_u32 v246, s40, v246
    v_mfma_f32_16x16x32_bf16 a[140:143], a[60:63], a[12:15], a[140:143]
    v_add_u32 v247, s40, v247
    v_mfma_f32_16x16x32_bf16 v[112:115], a[36:39], a[16:19], v[112:115]
    v_add_u32 v248, s40, v248
    v_mfma_f32_16x16x32_bf16 v[116:119], a[40:43], a[16:19], v[116:119]
    v_add_u32 v249, s40, v249
    v_mfma_f32_16x16x32_bf16 v[120:123], a[44:47], a[16:19], v[120:123]
    v_mfma_f32_16x16x32_bf16 v[124:127], a[48:51], a[16:19], v[124:127]
    v_mfma_f32_16x16x32_bf16 v[128:131], a[52:55], a[16:19], v[128:131]
    v_mfma_f32_16x16x32_bf16 v[132:135], a[56:59], a[16:19], v[132:135]
    v_mfma_f32_16x16x32_bf16 a[144:147], a[60:63], a[16:19], a[144:147]
    v_mfma_f32_16x16x32_bf16 v[136:139], a[36:39], a[20:23], v[136:139]
    v_mfma_f32_16x16x32_bf16 v[140:143], a[40:43], a[20:23], v[140:143]
    v_mfma_f32_16x16x32_bf16 v[144:147], a[44:47], a[20:23], v[144:147]
    v_mfma_f32_16x16x32_bf16 v[148:151], a[48:51], a[20:23], v[148:151]
    v_mfma_f32_16x16x32_bf16 v[152:155], a[52:55], a[20:23], v[152:155]
    v_mfma_f32_16x16x32_bf16 v[156:159], a[56:59], a[20:23], v[156:159]
    v_mfma_f32_16x16x32_bf16 a[148:151], a[60:63], a[20:23], a[148:151]
    v_mfma_f32_16x16x32_bf16 v[160:163], a[36:39], a[24:27], v[160:163]
    v_mfma_f32_16x16x32_bf16 v[164:167], a[40:43], a[24:27], v[164:167]
    v_mfma_f32_16x16x32_bf16 v[168:171], a[44:47], a[24:27], v[168:171]
    v_mfma_f32_16x16x32_bf16 v[172:175], a[48:51], a[24:27], v[172:175]
    v_mfma_f32_16x16x32_bf16 v[176:179], a[52:55], a[24:27], v[176:179]
    v_mfma_f32_16x16x32_bf16 v[180:183], a[56:59], a[24:27], v[180:183]
    v_mfma_f32_16x16x32_bf16 a[152:155], a[60:63], a[24:27], a[152:155]
    v_mfma_f32_16x16x32_bf16 v[184:187], a[36:39], a[28:31], v[184:187]
    v_mfma_f32_16x16x32_bf16 v[188:191], a[40:43], a[28:31], v[188:191]
    v_mfma_f32_16x16x32_bf16 v[192:195], a[44:47], a[28:31], v[192:195]
    v_mfma_f32_16x16x32_bf16 v[196:199], a[48:51], a[28:31], v[196:199]
    v_mfma_f32_16x16x32_bf16 v[200:203], a[52:55], a[28:31], v[200:203]
    v_mfma_f32_16x16x32_bf16 v[204:207], a[56:59], a[28:31], v[204:207]
    v_mfma_f32_16x16x32_bf16 a[156:159], a[60:63], a[28:31], a[156:159]
    s_waitcnt vmcnt(0) lgkmcnt(0)
    s_barrier
    v_mfma_f32_16x16x32_bf16 v[16:19], a[100:103], a[64:67], v[16:19]
    ds_read_b128 a[0:3], v240 offset:0
    v_mfma_f32_16x16x32_bf16 v[20:23], a[104:107], a[64:67], v[20:23]
    ds_read_b64_tr_b16 a[36:37], v244 offset:0
    v_mfma_f32_16x16x32_bf16 v[24:27], a[108:111], a[64:67], v[24:27]
    ds_read_b64_tr_b16 a[38:39], v244 offset:512
    v_mfma_f32_16x16x32_bf16 v[28:31], a[112:115], a[64:67], v[28:31]
    ds_read_b64_tr_b16 a[40:41], v245 offset:0
    v_mfma_f32_16x16x32_bf16 v[32:35], a[116:119], a[64:67], v[32:35]
    ds_read_b64_tr_b16 a[42:43], v245 offset:512
    v_mfma_f32_16x16x32_bf16 v[36:39], a[120:123], a[64:67], v[36:39]
    ds_read_b64_tr_b16 a[44:45], v246 offset:0
    v_mfma_f32_16x16x32_bf16 a[128:131], a[124:127], a[64:67], a[128:131]
    ds_read_b64_tr_b16 a[46:47], v246 offset:512
    v_mfma_f32_16x16x32_bf16 v[40:43], a[100:103], a[68:71], v[40:43]
    ds_read_b64_tr_b16 a[48:49], v247 offset:0
    v_mfma_f32_16x16x32_bf16 v[44:47], a[104:107], a[68:71], v[44:47]
    ds_read_b64_tr_b16 a[50:51], v247 offset:512
    v_mfma_f32_16x16x32_bf16 v[48:51], a[108:111], a[68:71], v[48:51]
    ds_read_b64_tr_b16 a[52:53], v248 offset:0
    v_mfma_f32_16x16x32_bf16 v[52:55], a[112:115], a[68:71], v[52:55]
    ds_read_b64_tr_b16 a[54:55], v248 offset:512
    v_mfma_f32_16x16x32_bf16 v[56:59], a[116:119], a[68:71], v[56:59]
    ds_read_b64_tr_b16 a[56:57], v249 offset:0
    v_mfma_f32_16x16x32_bf16 v[60:63], a[120:123], a[68:71], v[60:63]
    ds_read_b64_tr_b16 a[58:59], v249 offset:512
    v_mfma_f32_16x16x32_bf16 a[132:135], a[124:127], a[68:71], a[132:135]
    ds_read_b128 a[60:63], v250 offset:0
    v_mfma_f32_16x16x32_bf16 v[64:67], a[100:103], a[72:75], v[64:67]
    ds_read_b128 a[4:7], v240 offset:2048
    v_mfma_f32_16x16x32_bf16 v[68:71], a[104:107], a[72:75], v[68:71]
    ds_read_b128 a[8:11], v240 offset:4096
    v_mfma_f32_16x16x32_bf16 v[72:75], a[108:111], a[72:75], v[72:75]
    ds_read_b128 a[12:15], v240 offset:6144
    v_mfma_f32_16x16x32_bf16 v[76:79], a[112:115], a[72:75], v[76:79]
    ds_read_b128 a[16:19], v240 offset:8192
    v_mfma_f32_16x16x32_bf16 v[80:83], a[116:119], a[72:75], v[80:83]
    ds_read_b128 a[20:23], v240 offset:10240
    v_mfma_f32_16x16x32_bf16 v[84:87], a[120:123], a[72:75], v[84:87]
    ds_read_b128 a[24:27], v240 offset:12288
    v_mfma_f32_16x16x32_bf16 a[136:139], a[124:127], a[72:75], a[136:139]
    ds_read_b128 a[28:31], v240 offset:14336
    v_mfma_f32_16x16x32_bf16 v[88:91], a[100:103], a[76:79], v[88:91]
    s_sub_u32 s34, s28, s30
    v_mfma_f32_16x16x32_bf16 v[92:95], a[104:107], a[76:79], v[92:95]
    s_mov_b32 s30, s28
    v_mfma_f32_16x16x32_bf16 v[96:99], a[108:111], a[76:79], v[96:99]
    s_sub_u32 s40, 0, s40
    v_mfma_f32_16x16x32_bf16 v[100:103], a[112:115], a[76:79], v[100:103]
    s_mov_b32 s41, s37
    v_mfma_f32_16x16x32_bf16 v[104:107], a[116:119], a[76:79], v[104:107]
    s_mov_b32 s37, s38
    v_mfma_f32_16x16x32_bf16 v[108:111], a[120:123], a[76:79], v[108:111]
    s_mov_b32 s38, s39
    v_mfma_f32_16x16x32_bf16 a[140:143], a[124:127], a[76:79], a[140:143]
    s_mov_b32 s39, s41
    v_mfma_f32_16x16x32_bf16 v[112:115], a[100:103], a[80:83], v[112:115]
    v_mov_b32 v226, 0
    v_mfma_f32_16x16x32_bf16 v[116:119], a[104:107], a[80:83], v[116:119]
    buffer_load_dword v251, v226, s[20:23], 0 offen sc1
    v_mfma_f32_16x16x32_bf16 v[120:123], a[108:111], a[80:83], v[120:123]
    v_mfma_f32_16x16x32_bf16 v[124:127], a[112:115], a[80:83], v[124:127]
    v_mfma_f32_16x16x32_bf16 v[128:131], a[116:119], a[80:83], v[128:131]
    v_mfma_f32_16x16x32_bf16 v[132:135], a[120:123], a[80:83], v[132:135]
    v_mfma_f32_16x16x32_bf16 a[144:147], a[124:127], a[80:83], a[144:147]
    v_mfma_f32_16x16x32_bf16 v[136:139], a[100:103], a[84:87], v[136:139]
    v_mfma_f32_16x16x32_bf16 v[140:143], a[104:107], a[84:87], v[140:143]
    v_mfma_f32_16x16x32_bf16 v[144:147], a[108:111], a[84:87], v[144:147]
    v_mfma_f32_16x16x32_bf16 v[148:151], a[112:115], a[84:87], v[148:151]
    v_mfma_f32_16x16x32_bf16 v[152:155], a[116:119], a[84:87], v[152:155]
    v_mfma_f32_16x16x32_bf16 v[156:159], a[120:123], a[84:87], v[156:159]
    v_mfma_f32_16x16x32_bf16 a[148:151], a[124:127], a[84:87], a[148:151]
    v_mfma_f32_16x16x32_bf16 v[160:163], a[100:103], a[88:91], v[160:163]
    v_mfma_f32_16x16x32_bf16 v[164:167], a[104:107], a[88:91], v[164:167]
    v_mfma_f32_16x16x32_bf16 v[168:171], a[108:111], a[88:91], v[168:171]
    v_mfma_f32_16x16x32_bf16 v[172:175], a[112:115], a[88:91], v[172:175]
    v_mfma_f32_16x16x32_bf16 v[176:179], a[116:119], a[88:91], v[176:179]
    v_mfma_f32_16x16x32_bf16 v[180:183], a[120:123], a[88:91], v[180:183]
    v_mfma_f32_16x16x32_bf16 a[152:155], a[124:127], a[88:91], a[152:155]
    v_mfma_f32_16x16x32_bf16 v[184:187], a[100:103], a[92:95], v[184:187]
    v_mfma_f32_16x16x32_bf16 v[188:191], a[104:107], a[92:95], v[188:191]
    v_mfma_f32_16x16x32_bf16 v[192:195], a[108:111], a[92:95], v[192:195]
    v_mfma_f32_16x16x32_bf16 v[196:199], a[112:115], a[92:95], v[196:199]
    v_mfma_f32_16x16x32_bf16 v[200:203], a[116:119], a[92:95], v[200:203]
    v_mfma_f32_16x16x32_bf16 v[204:207], a[120:123], a[92:95], v[204:207]
    v_mfma_f32_16x16x32_bf16 a[156:159], a[124:127], a[92:95], a[156:159]
    s_waitcnt lgkmcnt(0)
    v_mfma_f32_16x16x32_bf16 v[16:19], a[36:39], a[0:3], v[16:19]
    ds_read_b128 a[64:67], v241 offset:0
    v_mfma_f32_16x16x32_bf16 v[20:23], a[40:43], a[0:3], v[20:23]
    ds_read_b64_tr_b16 a[100:101], v244 offset:4096
    v_mfma_f32_16x16x32_bf16 v[24:27], a[44:47], a[0:3], v[24:27]
    ds_read_b64_tr_b16 a[102:103], v244 offset:4608
    v_mfma_f32_16x16x32_bf16 v[28:31], a[48:51], a[0:3], v[28:31]
    ds_read_b64_tr_b16 a[104:105], v245 offset:4096
    v_mfma_f32_16x16x32_bf16 v[32:35], a[52:55], a[0:3], v[32:35]
    ds_read_b64_tr_b16 a[106:107], v245 offset:4608
    v_mfma_f32_16x16x32_bf16 v[36:39], a[56:59], a[0:3], v[36:39]
    ds_read_b64_tr_b16 a[108:109], v246 offset:4096
    v_mfma_f32_16x16x32_bf16 a[128:131], a[60:63], a[0:3], a[128:131]
    ds_read_b64_tr_b16 a[110:111], v246 offset:4608
    v_mfma_f32_16x16x32_bf16 v[40:43], a[36:39], a[4:7], v[40:43]
    ds_read_b64_tr_b16 a[112:113], v247 offset:4096
    v_mfma_f32_16x16x32_bf16 v[44:47], a[40:43], a[4:7], v[44:47]
    ds_read_b64_tr_b16 a[114:115], v247 offset:4608
    v_mfma_f32_16x16x32_bf16 v[48:51], a[44:47], a[4:7], v[48:51]
    ds_read_b64_tr_b16 a[116:117], v248 offset:4096
    v_mfma_f32_16x16x32_bf16 v[52:55], a[48:51], a[4:7], v[52:55]
    ds_read_b64_tr_b16 a[118:119], v248 offset:4608
    v_mfma_f32_16x16x32_bf16 v[56:59], a[52:55], a[4:7], v[56:59]
    ds_read_b64_tr_b16 a[120:121], v249 offset:4096
    v_mfma_f32_16x16x32_bf16 v[60:63], a[56:59], a[4:7], v[60:63]
    ds_read_b64_tr_b16 a[122:123], v249 offset:4608
    v_mfma_f32_16x16x32_bf16 a[132:135], a[60:63], a[4:7], a[132:135]
    ds_read_b128 a[124:127], v250 offset:64
    v_mfma_f32_16x16x32_bf16 v[64:67], a[36:39], a[8:11], v[64:67]
    ds_read_b128 a[68:71], v241 offset:2048
    v_mfma_f32_16x16x32_bf16 v[68:71], a[40:43], a[8:11], v[68:71]
    ds_read_b128 a[72:75], v241 offset:4096
    v_mfma_f32_16x16x32_bf16 v[72:75], a[44:47], a[8:11], v[72:75]
    ds_read_b128 a[76:79], v241 offset:6144
    v_mfma_f32_16x16x32_bf16 v[76:79], a[48:51], a[8:11], v[76:79]
    ds_read_b128 a[80:83], v241 offset:8192
    v_mfma_f32_16x16x32_bf16 v[80:83], a[52:55], a[8:11], v[80:83]
    ds_read_b128 a[84:87], v241 offset:10240
    v_mfma_f32_16x16x32_bf16 v[84:87], a[56:59], a[8:11], v[84:87]
    ds_read_b128 a[88:91], v241 offset:12288
    v_mfma_f32_16x16x32_bf16 a[136:139], a[60:63], a[8:11], a[136:139]
    ds_read_b128 a[92:95], v241 offset:14336
    v_mfma_f32_16x16x32_bf16 v[88:91], a[36:39], a[12:15], v[88:91]
    v_mfma_f32_16x16x32_bf16 v[92:95], a[40:43], a[12:15], v[92:95]
    v_mfma_f32_16x16x32_bf16 v[96:99], a[44:47], a[12:15], v[96:99]
    v_mfma_f32_16x16x32_bf16 v[100:103], a[48:51], a[12:15], v[100:103]
    v_mfma_f32_16x16x32_bf16 v[104:107], a[52:55], a[12:15], v[104:107]
    v_mfma_f32_16x16x32_bf16 v[108:111], a[56:59], a[12:15], v[108:111]
    v_mfma_f32_16x16x32_bf16 a[140:143], a[60:63], a[12:15], a[140:143]
    v_mfma_f32_16x16x32_bf16 v[112:115], a[36:39], a[16:19], v[112:115]
    v_mfma_f32_16x16x32_bf16 v[116:119], a[40:43], a[16:19], v[116:119]
    v_mfma_f32_16x16x32_bf16 v[120:123], a[44:47], a[16:19], v[120:123]
    v_mfma_f32_16x16x32_bf16 v[124:127], a[48:51], a[16:19], v[124:127]
    v_mfma_f32_16x16x32_bf16 v[128:131], a[52:55], a[16:19], v[128:131]
    v_mfma_f32_16x16x32_bf16 v[132:135], a[56:59], a[16:19], v[132:135]
    v_mfma_f32_16x16x32_bf16 a[144:147], a[60:63], a[16:19], a[144:147]
    v_mfma_f32_16x16x32_bf16 v[136:139], a[36:39], a[20:23], v[136:139]
    v_mfma_f32_16x16x32_bf16 v[140:143], a[40:43], a[20:23], v[140:143]
    v_mfma_f32_16x16x32_bf16 v[144:147], a[44:47], a[20:23], v[144:147]
    v_mfma_f32_16x16x32_bf16 v[148:151], a[48:51], a[20:23], v[148:151]
    v_mfma_f32_16x16x32_bf16 v[152:155], a[52:55], a[20:23], v[152:155]
    v_mfma_f32_16x16x32_bf16 v[156:159], a[56:59], a[20:23], v[156:159]
    v_mfma_f32_16x16x32_bf16 a[148:151], a[60:63], a[20:23], a[148:151]
    v_mfma_f32_16x16x32_bf16 v[160:163], a[36:39], a[24:27], v[160:163]
    v_mfma_f32_16x16x32_bf16 v[164:167], a[40:43], a[24:27], v[164:167]
    v_mfma_f32_16x16x32_bf16 v[168:171], a[44:47], a[24:27], v[168:171]
    v_mfma_f32_16x16x32_bf16 v[172:175], a[48:51], a[24:27], v[172:175]
    v_mfma_f32_16x16x32_bf16 v[176:179], a[52:55], a[24:27], v[176:179]
    v_mfma_f32_16x16x32_bf16 v[180:183], a[56:59], a[24:27], v[180:183]
    v_mfma_f32_16x16x32_bf16 a[152:155], a[60:63], a[24:27], a[152:155]
    v_mfma_f32_16x16x32_bf16 v[184:187], a[36:39], a[28:31], v[184:187]
    v_mfma_f32_16x16x32_bf16 v[188:191], a[40:43], a[28:31], v[188:191]
    v_mfma_f32_16x16x32_bf16 v[192:195], a[44:47], a[28:31], v[192:195]
    v_mfma_f32_16x16x32_bf16 v[196:199], a[48:51], a[28:31], v[196:199]
    v_mfma_f32_16x16x32_bf16 v[200:203], a[52:55], a[28:31], v[200:203]
    v_mfma_f32_16x16x32_bf16 v[204:207], a[56:59], a[28:31], v[204:207]
    v_mfma_f32_16x16x32_bf16 a[156:159], a[60:63], a[28:31], a[156:159]
    s_waitcnt lgkmcnt(0)
    v_mfma_f32_16x16x32_bf16 v[16:19], a[100:103], a[64:67], v[16:19]
    v_mfma_f32_16x16x32_bf16 v[20:23], a[104:107], a[64:67], v[20:23]
    v_mfma_f32_16x16x32_bf16 v[24:27], a[108:111], a[64:67], v[24:27]
    v_mfma_f32_16x16x32_bf16 v[28:31], a[112:115], a[64:67], v[28:31]
    v_mfma_f32_16x16x32_bf16 v[32:35], a[116:119], a[64:67], v[32:35]
    v_mfma_f32_16x16x32_bf16 v[36:39], a[120:123], a[64:67], v[36:39]
    v_mfma_f32_16x16x32_bf16 a[128:131], a[124:127], a[64:67], a[128:131]
    v_mfma_f32_16x16x32_bf16 v[40:43], a[100:103], a[68:71], v[40:43]
    v_mfma_f32_16x16x32_bf16 v[44:47], a[104:107], a[68:71], v[44:47]
    v_mfma_f32_16x16x32_bf16 v[48:51], a[108:111], a[68:71], v[48:51]
    v_mfma_f32_16x16x32_bf16 v[52:55], a[112:115], a[68:71], v[52:55]
    v_mfma_f32_16x16x32_bf16 v[56:59], a[116:119], a[68:71], v[56:59]
    v_mfma_f32_16x16x32_bf16 v[60:63], a[120:123], a[68:71], v[60:63]
    v_mfma_f32_16x16x32_bf16 a[132:135], a[124:127], a[68:71], a[132:135]
    v_mfma_f32_16x16x32_bf16 v[64:67], a[100:103], a[72:75], v[64:67]
    v_mfma_f32_16x16x32_bf16 v[68:71], a[104:107], a[72:75], v[68:71]
    v_mfma_f32_16x16x32_bf16 v[72:75], a[108:111], a[72:75], v[72:75]
    v_mfma_f32_16x16x32_bf16 v[76:79], a[112:115], a[72:75], v[76:79]
    v_mfma_f32_16x16x32_bf16 v[80:83], a[116:119], a[72:75], v[80:83]
    v_mfma_f32_16x16x32_bf16 v[84:87], a[120:123], a[72:75], v[84:87]
    v_mfma_f32_16x16x32_bf16 a[136:139], a[124:127], a[72:75], a[136:139]
    v_mfma_f32_16x16x32_bf16 v[88:91], a[100:103], a[76:79], v[88:91]
    v_mfma_f32_16x16x32_bf16 v[92:95], a[104:107], a[76:79], v[92:95]
    v_mfma_f32_16x16x32_bf16 v[96:99], a[108:111], a[76:79], v[96:99]
    v_mfma_f32_16x16x32_bf16 v[100:103], a[112:115], a[76:79], v[100:103]
    v_mfma_f32_16x16x32_bf16 v[104:107], a[116:119], a[76:79], v[104:107]
    v_mfma_f32_16x16x32_bf16 v[108:111], a[120:123], a[76:79], v[108:111]
    v_mfma_f32_16x16x32_bf16 a[140:143], a[124:127], a[76:79], a[140:143]
    v_mfma_f32_16x16x32_bf16 v[112:115], a[100:103], a[80:83], v[112:115]
    v_mfma_f32_16x16x32_bf16 v[116:119], a[104:107], a[80:83], v[116:119]
    v_mfma_f32_16x16x32_bf16 v[120:123], a[108:111], a[80:83], v[120:123]
    v_mfma_f32_16x16x32_bf16 v[124:127], a[112:115], a[80:83], v[124:127]
    v_mfma_f32_16x16x32_bf16 v[128:131], a[116:119], a[80:83], v[128:131]
    v_mfma_f32_16x16x32_bf16 v[132:135], a[120:123], a[80:83], v[132:135]
    v_mfma_f32_16x16x32_bf16 a[144:147], a[124:127], a[80:83], a[144:147]
    v_mfma_f32_16x16x32_bf16 v[136:139], a[100:103], a[84:87], v[136:139]
    v_mfma_f32_16x16x32_bf16 v[140:143], a[104:107], a[84:87], v[140:143]
    v_mfma_f32_16x16x32_bf16 v[144:147], a[108:111], a[84:87], v[144:147]
    v_mfma_f32_16x16x32_bf16 v[148:151], a[112:115], a[84:87], v[148:151]
    v_mfma_f32_16x16x32_bf16 v[152:155], a[116:119], a[84:87], v[152:155]
    v_mfma_f32_16x16x32_bf16 v[156:159], a[120:123], a[84:87], v[156:159]
    v_mfma_f32_16x16x32_bf16 a[148:151], a[124:127], a[84:87], a[148:151]
    v_mfma_f32_16x16x32_bf16 v[160:163], a[100:103], a[88:91], v[160:163]
    v_mfma_f32_16x16x32_bf16 v[164:167], a[104:107], a[88:91], v[164:167]
    v_mfma_f32_16x16x32_bf16 v[168:171], a[108:111], a[88:91], v[168:171]
    v_mfma_f32_16x16x32_bf16 v[172:175], a[112:115], a[88:91], v[172:175]
    v_mfma_f32_16x16x32_bf16 v[176:179], a[116:119], a[88:91], v[176:179]
    v_mfma_f32_16x16x32_bf16 v[180:183], a[120:123], a[88:91], v[180:183]
    v_mfma_f32_16x16x32_bf16 a[152:155], a[124:127], a[88:91], a[152:155]
    v_mfma_f32_16x16x32_bf16 v[184:187], a[100:103], a[92:95], v[184:187]
    v_mfma_f32_16x16x32_bf16 v[188:191], a[104:107], a[92:95], v[188:191]
    v_mfma_f32_16x16x32_bf16 v[192:195], a[108:111], a[92:95], v[192:195]
    v_mfma_f32_16x16x32_bf16 v[196:199], a[112:115], a[92:95], v[196:199]
    v_mfma_f32_16x16x32_bf16 v[200:203], a[116:119], a[92:95], v[200:203]
    v_mfma_f32_16x16x32_bf16 v[204:207], a[120:123], a[92:95], v[204:207]
    v_mfma_f32_16x16x32_bf16 a[156:159], a[124:127], a[92:95], a[156:159]
    s_waitcnt vmcnt(0)
    v_readfirstlane_b32 s97, v251
    s_nop 0
    s_cmp_ge_u32 s97, 64
    s_cbranch_scc1 L_p1y_c0_out
    v_mov_b32 v225, 0
    s_mov_b32 s96, 0
L_p1y_c0:
    buffer_load_dword v251, v225, s[20:23], 0 offen sc1
    s_waitcnt vmcnt(0)
    v_readfirstlane_b32 s97, v251
    s_nop 0
    s_cmp_ge_u32 s97, 64
    s_cbranch_scc1 L_p1y_c0_out
    s_add_u32 s96, s96, 1
    s_cmp_lt_u32 s96, 0x40000
    s_cbranch_scc1 L_p1y_c0
L_p1y_c0_out:
L_pad_p1y_0:
    s_cbranch_execz L_pad_p1y_4
    v_mbcnt_lo_u32_b32 v224, -1, 0
    v_mbcnt_hi_u32_b32 v224, -1, v224
    v_and_b32 v225, 15, v224
    v_lshlrev_b32 v224, 4, v224
    s_mul_i32 s49, s26, 12
    s_mul_i32 s48, s51, 6
    s_add_u32 s49, s49, s48
    s_add_u32 s49, s49, 88
    v_mov_b32 v226, 0xbdd2d3e8
    v_mov_b32 v227, 0xc0135761
    s_lshl_b32 s41, s25, 3
    s_lshl_b32 s42, s50, 2
    s_add_u32 s41, s41, s42
    s_mul_i32 s41, s41, 112
    s_add_u32 s41, s41, s49
    s_lshl_b32 s41, s41, 10
    s_add_u32 s41, s41, 0xc00000
    v_pk_mul_f32 v[0:1], v[16:17], v[16:17]
    v_pk_mul_f32 v[2:3], v[18:19], v[18:19]
    v_pk_mul_f32 v[4:5], v[40:41], v[40:41]
    v_pk_mul_f32 v[6:7], v[42:43], v[42:43]
    v_pk_mul_f32 v[8:9], v[20:21], v[20:21]
    v_pk_mul_f32 v[10:11], v[22:23], v[22:23]
    v_pk_mul_f32 v[12:13], v[44:45], v[44:45]
    v_pk_mul_f32 v[14:15], v[46:47], v[46:47]
    v_pk_fma_f32 v[0:1], v[0:1], v[226:227], v[226:227] op_sel:[0,0,1] op_sel_hi:[1,0,1]
    v_pk_fma_f32 v[2:3], v[2:3], v[226:227], v[226:227] op_sel:[0,0,1] op_sel_hi:[1,0,1]
    v_pk_fma_f32 v[4:5], v[4:5], v[226:227], v[226:227] op_sel:[0,0,1] op_sel_hi:[1,0,1]
    v_pk_fma_f32 v[6:7], v[6:7], v[226:227], v[226:227] op_sel:[0,0,1] op_sel_hi:[1,0,1]
    v_pk_fma_f32 v[8:9], v[8:9], v[226:227], v[226:227] op_sel:[0,0,1] op_sel_hi:[1,0,1]
    v_pk_fma_f32 v[10:11], v[10:11], v[226:227], v[226:227] op_sel:[0,0,1] op_sel_hi:[1,0,1]
    v_pk_fma_f32 v[12:13], v[12:13], v[226:227], v[226:227] op_sel:[0,0,1] op_sel_hi:[1,0,1]
    v_pk_fma_f32 v[14:15], v[14:15], v[226:227], v[226:227] op_sel:[0,0,1] op_sel_hi:[1,0,1]
    v_pk_mul_f32 v[0:1], v[0:1], v[16:17]
    v_pk_mul_f32 v[2:3], v[2:3], v[18:19]
    v_pk_mul_f32 v[4:5], v[4:5], v[40:41]
    v_pk_mul_f32 v[6:7], v[6:7], v[42:43]
    v_pk_mul_f32 v[8:9], v[8:9], v[20:21]
    v_pk_mul_f32 v[10:11], v[10:11], v[22:23]
    v_pk_mul_f32 v[12:13], v[12:13], v[44:45]
    v_pk_mul_f32 v[14:15], v[14:15], v[46:47]
    v_exp_f32 v0, v0
    v_exp_f32 v1, v1
    v_exp_f32 v2, v2
    v_exp_f32 v3, v3
    v_exp_f32 v4, v4
    v_exp_f32 v5, v5
    v_exp_f32 v6, v6
    v_exp_f32 v7, v7
    v_exp_f32 v8, v8
    v_exp_f32 v9, v9
    v_exp_f32 v10, v10
    v_exp_f32 v11, v11
    v_exp_f32 v12, v12
    v_exp_f32 v13, v13
    v_exp_f32 v14, v14
    v_exp_f32 v15, v15
    v_pk_add_f32 v[0:1], v[0:1], 1.0 op_sel_hi:[1,0]
    v_pk_add_f32 v[2:3], v[2:3], 1.0 op_sel_hi:[1,0]
    v_pk_add_f32 v[4:5], v[4:5], 1.0 op_sel_hi:[1,0]
    v_pk_add_f32 v[6:7], v[6:7], 1.0 op_sel_hi:[1,0]
    v_pk_add_f32 v[8:9], v[8:9], 1.0 op_sel_hi:[1,0]
    v_pk_add_f32 v[10:11], v[10:11], 1.0 op_sel_hi:[1,0]
    v_pk_add_f32 v[12:13], v[12:13], 1.0 op_sel_hi:[1,0]
    v_pk_add_f32 v[14:15], v[14:15], 1.0 op_sel_hi:[1,0]
    v_rcp_f32 v0, v0
    v_pk_mul_f32 v[208:209], v[24:25], v[24:25]
L_pad_p1y_1:
    s_cbranch_execz L_pad_p1y_5
    v_pk_mul_f32 v[210:211], v[26:27], v[26:27]
    v_rcp_f32 v1, v1
    v_pk_mul_f32 v[212:213], v[48:49], v[48:49]
    v_rcp_f32 v2, v2
    v_pk_mul_f32 v[214:215], v[50:51], v[50:51]
    v_pk_mul_f32 v[216:217], v[28:29], v[28:29]
    v_rcp_f32 v3, v3
    v_pk_mul_f32 v[218:219], v[30:31], v[30:31]
    v_rcp_f32 v4, v4
    v_pk_mul_f32 v[220:221], v[52:53], v[52:53]
    v_pk_mul_f32 v[222:223], v[54:55], v[54:55]
    v_rcp_f32 v5, v5
    v_pk_fma_f32 v[208:209], v[208:209], v[226:227], v[226:227] op_sel:[0,0,1] op_sel_hi:[1,0,1]
    v_rcp_f32 v6, v6
    v_pk_fma_f32 v[210:211], v[210:211], v[226:227], v[226:227] op_sel:[0,0,1] op_sel_hi:[1,0,1]
    v_pk_fma_f32 v[212:213], v[212:213], v[226:227], v[226:227] op_sel:[0,0,1] op_sel_hi:[1,0,1]
    v_rcp_f32 v7, v7
    v_pk_fma_f32 v[214:215], v[214:215], v[226:227], v[226:227] op_sel:[0,0,1] op_sel_hi:[1,0,1]
    v_rcp_f32 v8, v8
    v_pk_fma_f32 v[216:217], v[216:217], v[226:227], v[226:227] op_sel:[0,0,1] op_sel_hi:[1,0,1]
    v_pk_fma_f32 v[218:219], v[218:219], v[226:227], v[226:227] op_sel:[0,0,1] op_sel_hi:[1,0,1]
    v_rcp_f32 v9, v9
    v_pk_fma_f32 v[220:221], v[220:221], v[226:227], v[226:227] op_sel:[0,0,1] op_sel_hi:[1,0,1]
    v_rcp_f32 v10, v10
    v_pk_fma_f32 v[222:223], v[222:223], v[226:227], v[226:227] op_sel:[0,0,1] op_sel_hi:[1,0,1]
    v_pk_mul_f32 v[208:209], v[208:209], v[24:25]
    v_rcp_f32 v11, v11
    v_pk_mul_f32 v[210:211], v[210:211], v[26:27]
    v_rcp_f32 v12, v12
    v_pk_mul_f32 v[212:213], v[212:213], v[48:49]
    v_pk_mul_f32 v[214:215], v[214:215], v[50:51]
    v_rcp_f32 v13, v13
    v_pk_mul_f32 v[216:217], v[216:217], v[28:29]
    v_rcp_f32 v14, v14
    v_pk_mul_f32 v[218:219], v[218:219], v[30:31]
    v_pk_mul_f32 v[220:221], v[220:221], v[52:53]
    v_rcp_f32 v15, v15
    v_pk_mul_f32 v[222:223], v[222:223], v[54:55]
    v_exp_f32 v208, v208
    v_pk_mul_f32 v[16:17], v[16:17], v[0:1]
    v_pk_mul_f32 v[18:19], v[18:19], v[2:3]
    v_exp_f32 v209, v209
    v_pk_mul_f32 v[40:41], v[40:41], v[4:5]
    v_exp_f32 v210, v210
    v_pk_mul_f32 v[42:43], v[42:43], v[6:7]
    v_exp_f32 v211, v211
    v_pk_mul_f32 v[20:21], v[20:21], v[8:9]
    v_exp_f32 v212, v212
    v_pk_mul_f32 v[22:23], v[22:23], v[10:11]
    v_exp_f32 v213, v213
    v_pk_mul_f32 v[44:45], v[44:45], v[12:13]
    v_exp_f32 v214, v214
    v_pk_mul_f32 v[46:47], v[46:47], v[14:15]
    v_exp_f32 v215, v215
    v_cvt_pk_bf16_f32 v228, v16, v17
    v_exp_f32 v216, v216
    v_cvt_pk_bf16_f32 v229, v18, v19
    v_cvt_pk_bf16_f32 v230, v40, v41
    v_exp_f32 v217, v217
    v_cvt_pk_bf16_f32 v231, v42, v43
    v_exp_f32 v218, v218
    buffer_store_dwordx4 v[228:231], v224, s[16:19], s41 offen  sc1
    v_exp_f32 v219, v219
    v_cvt_pk_bf16_f32 v232, v20, v21
    v_exp_f32 v220, v220
    v_cvt_pk_bf16_f32 v233, v22, v23
    v_exp_f32 v221, v221
L_pad_p1y_2:
    s_cbranch_execz L_pad_p1y_6
    v_cvt_pk_bf16_f32 v234, v44, v45
    v_exp_f32 v222, v222
    v_cvt_pk_bf16_f32 v235, v46, v47
    v_exp_f32 v223, v223
    buffer_store_dwordx4 v[232:235], v224, s[16:19], s41 offen offset:1024  sc1
    v_pk_add_f32 v[208:209], v[208:209], 1.0 op_sel_hi:[1,0]
    v_pk_add_f32 v[210:211], v[210:211], 1.0 op_sel_hi:[1,0]
    v_pk_add_f32 v[212:213], v[212:213], 1.0 op_sel_hi:[1,0]
    v_pk_add_f32 v[214:215], v[214:215], 1.0 op_sel_hi:[1,0]
    v_pk_add_f32 v[216:217], v[216:217], 1.0 op_sel_hi:[1,0]
    v_pk_add_f32 v[218:219], v[218:219], 1.0 op_sel_hi:[1,0]
    v_pk_add_f32 v[220:221], v[220:221], 1.0 op_sel_hi:[1,0]
    v_pk_add_f32 v[222:223], v[222:223], 1.0 op_sel_hi:[1,0]
    v_rcp_f32 v208, v208
    v_pk_mul_f32 v[0:1], v[32:33], v[32:33]
    v_pk_mul_f32 v[2:3], v[34:35], v[34:35]
    v_rcp_f32 v209, v209
    v_pk_mul_f32 v[4:5], v[56:57], v[56:57]
    v_rcp_f32 v210, v210
    v_pk_mul_f32 v[6:7], v[58:59], v[58:59]
    v_pk_mul_f32 v[8:9], v[36:37], v[36:37]
    v_rcp_f32 v211, v211
    v_pk_mul_f32 v[10:11], v[38:39], v[38:39]
    v_rcp_f32 v212, v212
    v_pk_mul_f32 v[12:13], v[60:61], v[60:61]
    v_pk_mul_f32 v[14:15], v[62:63], v[62:63]
    v_rcp_f32 v213, v213
    v_pk_fma_f32 v[0:1], v[0:1], v[226:227], v[226:227] op_sel:[0,0,1] op_sel_hi:[1,0,1]
    v_rcp_f32 v214, v214
    v_pk_fma_f32 v[2:3], v[2:3], v[226:227], v[226:227] op_sel:[0,0,1] op_sel_hi:[1,0,1]
    v_pk_fma_f32 v[4:5], v[4:5], v[226:227], v[226:227] op_sel:[0,0,1] op_sel_hi:[1,0,1]
    v_rcp_f32 v215, v215
    v_pk_fma_f32 v[6:7], v[6:7], v[226:227], v[226:227] op_sel:[0,0,1] op_sel_hi:[1,0,1]
    v_rcp_f32 v216, v216
    v_pk_fma_f32 v[8:9], v[8:9], v[226:227], v[226:227] op_sel:[0,0,1] op_sel_hi:[1,0,1]
    v_pk_fma_f32 v[10:11], v[10:11], v[226:227], v[226:227] op_sel:[0,0,1] op_sel_hi:[1,0,1]
    v_rcp_f32 v217, v217
    v_pk_fma_f32 v[12:13], v[12:13], v[226:227], v[226:227] op_sel:[0,0,1] op_sel_hi:[1,0,1]
    v_rcp_f32 v218, v218
    v_pk_fma_f32 v[14:15], v[14:15], v[226:227], v[226:227] op_sel:[0,0,1] op_sel_hi:[1,0,1]
    v_pk_mul_f32 v[0:1], v[0:1], v[32:33]
    v_rcp_f32 v219, v219
    v_pk_mul_f32 v[2:3], v[2:3], v[34:35]
    v_rcp_f32 v220, v220
    v_pk_mul_f32 v[4:5], v[4:5], v[56:57]
    v_pk_mul_f32 v[6:7], v[6:7], v[58:59]
    v_rcp_f32 v221, v221
    v_pk_mul_f32 v[8:9], v[8:9], v[36:37]
    v_rcp_f32 v222, v222
    v_pk_mul_f32 v[10:11], v[10:11], v[38:39]
    v_pk_mul_f32 v[12:13], v[12:13], v[60:61]
    v_rcp_f32 v223, v223
    v_pk_mul_f32 v[14:15], v[14:15], v[62:63]
    v_exp_f32 v0, v0
    v_pk_mul_f32 v[24:25], v[24:25], v[208:209]
    v_pk_mul_f32 v[26:27], v[26:27], v[210:211]
    v_exp_f32 v1, v1
    v_pk_mul_f32 v[48:49], v[48:49], v[212:213]
    v_exp_f32 v2, v2
    v_pk_mul_f32 v[50:51], v[50:51], v[214:215]
    v_exp_f32 v3, v3
    v_pk_mul_f32 v[28:29], v[28:29], v[216:217]
    v_exp_f32 v4, v4
    v_pk_mul_f32 v[30:31], v[30:31], v[218:219]
    v_exp_f32 v5, v5
L_pad_p1y_3:
    s_cbranch_execz L_pad_p1y_7
    v_pk_mul_f32 v[52:53], v[52:53], v[220:221]
    v_exp_f32 v6, v6
    v_pk_mul_f32 v[54:55], v[54:55], v[222:223]
    v_exp_f32 v7, v7
    v_cvt_pk_bf16_f32 v236, v24, v25
    v_exp_f32 v8, v8
    v_cvt_pk_bf16_f32 v237, v26, v27
    v_cvt_pk_bf16_f32 v238, v48, v49
    v_exp_f32 v9, v9
    v_cvt_pk_bf16_f32 v239, v50, v51
    v_exp_f32 v10, v10
    buffer_store_dwordx4 v[236:239], v224, s[16:19], s41 offen offset:2048  sc1
    v_exp_f32 v11, v11
    v_cvt_pk_bf16_f32 v240, v28, v29
    v_exp_f32 v12, v12
    v_cvt_pk_bf16_f32 v241, v30, v31
    v_exp_f32 v13, v13
    v_cvt_pk_bf16_f32 v242, v52, v53
    v_exp_f32 v14, v14
    v_cvt_pk_bf16_f32 v243, v54, v55
    v_exp_f32 v15, v15
    buffer_store_dwordx4 v[240:243], v224, s[16:19], s41 offen offset:3072  sc1
    v_pk_add_f32 v[0:1], v[0:1], 1.0 op_sel_hi:[1,0]
    v_pk_add_f32 v[2:3], v[2:3], 1.0 op_sel_hi:[1,0]
    v_pk_add_f32 v[4:5], v[4:5], 1.0 op_sel_hi:[1,0]
    v_pk_add_f32 v[6:7], v[6:7], 1.0 op_sel_hi:[1,0]
    v_pk_add_f32 v[8:9], v[8:9], 1.0 op_sel_hi:[1,0]
    v_pk_add_f32 v[10:11], v[10:11], 1.0 op_sel_hi:[1,0]
    v_pk_add_f32 v[12:13], v[12:13], 1.0 op_sel_hi:[1,0]
    v_pk_add_f32 v[14:15], v[14:15], 1.0 op_sel_hi:[1,0]
    v_rcp_f32 v0, v0
    v_pk_mul_f32 v[208:209], v[64:65], v[64:65]
    v_pk_mul_f32 v[210:211], v[66:67], v[66:67]
    v_rcp_f32 v1, v1
    v_pk_mul_f32 v[212:213], v[88:89], v[88:89]
    v_rcp_f32 v2, v2
    v_pk_mul_f32 v[214:215], v[90:91], v[90:91]
    v_pk_mul_f32 v[216:217], v[68:69], v[68:69]
    v_rcp_f32 v3, v3
    v_pk_mul_f32 v[218:219], v[70:71], v[70:71]
    v_rcp_f32 v4, v4
    v_pk_mul_f32 v[220:221], v[92:93], v[92:93]
    v_pk_mul_f32 v[222:223], v[94:95], v[94:95]
    v_rcp_f32 v5, v5
    v_pk_fma_f32 v[208:209], v[208:209], v[226:227], v[226:227] op_sel:[0,0,1] op_sel_hi:[1,0,1]
    v_rcp_f32 v6, v6
    v_pk_fma_f32 v[210:211], v[210:211], v[226:227], v[226:227] op_sel:[0,0,1] op_sel_hi:[1,0,1]
    v_pk_fma_f32 v[212:213], v[212:213], v[226:227], v[226:227] op_sel:[0,0,1] op_sel_hi:[1,0,1]
    v_rcp_f32 v7, v7
    v_pk_fma_f32 v[214:215], v[214:215], v[226:227], v[226:227] op_sel:[0,0,1] op_sel_hi:[1,0,1]
    v_rcp_f32 v8, v8
    v_pk_fma_f32 v[216:217], v[216:217], v[226:227], v[226:227] op_sel:[0,0,1] op_sel_hi:[1,0,1]
    v_pk_fma_f32 v[218:219], v[218:219], v[226:227], v[226:227] op_sel:[0,0,1] op_sel_hi:[1,0,1]
    v_rcp_f32 v9, v9
    v_pk_fma_f32 v[220:221], v[220:221], v[226:227], v[226:227] op_sel:[0,0,1] op_sel_hi:[1,0,1]
    v_rcp_f32 v10, v10
    v_pk_fma_f32 v[222:223], v[222:223], v[226:227], v[226:227] op_sel:[0,0,1] op_sel_hi:[1,0,1]
    v_pk_mul_f32 v[208:209], v[208:209], v[64:65]
    v_rcp_f32 v11, v11
    v_pk_mul_f32 v[210:211], v[210:211], v[66:67]
    v_rcp_f32 v12, v12
    v_pk_mul_f32 v[212:213], v[212:213], v[88:89]
    v_pk_mul_f32 v[214:215], v[214:215], v[90:91]
    v_rcp_f32 v13, v13
    v_pk_mul_f32 v[216:217], v[216:217], v[68:69]
L_pad_p1y_4:
    s_cbranch_execz L_pad_p1y_8
    v_rcp_f32 v14, v14
    v_pk_mul_f32 v[218:219], v[218:219], v[70:71]
    v_pk_mul_f32 v[220:221], v[220:221], v[92:93]
    v_rcp_f32 v15, v15
    v_pk_mul_f32 v[222:223], v[222:223], v[94:95]
    v_exp_f32 v208, v208
    v_pk_mul_f32 v[32:33], v[32:33], v[0:1]
    v_pk_mul_f32 v[34:35], v[34:35], v[2:3]
    v_exp_f32 v209, v209
    v_pk_mul_f32 v[56:57], v[56:57], v[4:5]
    v_exp_f32 v210, v210
    v_pk_mul_f32 v[58:59], v[58:59], v[6:7]
    v_exp_f32 v211, v211
    v_pk_mul_f32 v[36:37], v[36:37], v[8:9]
    v_exp_f32 v212, v212
    v_pk_mul_f32 v[38:39], v[38:39], v[10:11]
    v_exp_f32 v213, v213
    v_pk_mul_f32 v[60:61], v[60:61], v[12:13]
    v_pk_mul_f32 v[62:63], v[62:63], v[14:15]
    v_exp_f32 v214, v214
    v_cvt_pk_bf16_f32 v228, v32, v33
    v_exp_f32 v215, v215
    v_cvt_pk_bf16_f32 v229, v34, v35
    v_exp_f32 v216, v216
    v_cvt_pk_bf16_f32 v230, v56, v57
    v_exp_f32 v217, v217
    v_cvt_pk_bf16_f32 v231, v58, v59
    v_exp_f32 v218, v218
    s_add_u32 s42, s41, 4096
    buffer_store_dwordx4 v[228:231], v224, s[16:19], s42 offen  sc1
    v_exp_f32 v219, v219
    v_cvt_pk_bf16_f32 v232, v36, v37
    v_exp_f32 v220, v220
    v_cvt_pk_bf16_f32 v233, v38, v39
    v_exp_f32 v221, v221
    v_cvt_pk_bf16_f32 v234, v60, v61
    v_exp_f32 v222, v222
    v_cvt_pk_bf16_f32 v235, v62, v63
    v_exp_f32 v223, v223
    buffer_store_dwordx4 v[232:235], v224, s[16:19], s42 offen offset:1024  sc1
    v_pk_add_f32 v[208:209], v[208:209], 1.0 op_sel_hi:[1,0]
    v_pk_add_f32 v[210:211], v[210:211], 1.0 op_sel_hi:[1,0]
    v_pk_add_f32 v[212:213], v[212:213], 1.0 op_sel_hi:[1,0]
    v_pk_add_f32 v[214:215], v[214:215], 1.0 op_sel_hi:[1,0]
    v_pk_add_f32 v[216:217], v[216:217], 1.0 op_sel_hi:[1,0]
    v_pk_add_f32 v[218:219], v[218:219], 1.0 op_sel_hi:[1,0]
    v_pk_add_f32 v[220:221], v[220:221], 1.0 op_sel_hi:[1,0]
    v_pk_add_f32 v[222:223], v[222:223], 1.0 op_sel_hi:[1,0]
    v_rcp_f32 v208, v208
    v_pk_mul_f32 v[0:1], v[72:73], v[72:73]
    v_pk_mul_f32 v[2:3], v[74:75], v[74:75]
    v_rcp_f32 v209, v209
    v_pk_mul_f32 v[4:5], v[96:97], v[96:97]
    v_rcp_f32 v210, v210
    v_pk_mul_f32 v[6:7], v[98:99], v[98:99]
    v_pk_mul_f32 v[8:9], v[76:77], v[76:77]
    v_rcp_f32 v211, v211
    v_pk_mul_f32 v[10:11], v[78:79], v[78:79]
    v_rcp_f32 v212, v212
    v_pk_mul_f32 v[12:13], v[100:101], v[100:101]
    v_pk_mul_f32 v[14:15], v[102:103], v[102:103]
    v_rcp_f32 v213, v213
    v_pk_fma_f32 v[0:1], v[0:1], v[226:227], v[226:227] op_sel:[0,0,1] op_sel_hi:[1,0,1]
    v_rcp_f32 v214, v214
    v_pk_fma_f32 v[2:3], v[2:3], v[226:227], v[226:227] op_sel:[0,0,1] op_sel_hi:[1,0,1]
L_pad_p1y_5:
    s_cbranch_execz L_pad_p1y_9
    v_pk_fma_f32 v[4:5], v[4:5], v[226:227], v[226:227] op_sel:[0,0,1] op_sel_hi:[1,0,1]
    v_rcp_f32 v215, v215
    v_pk_fma_f32 v[6:7], v[6:7], v[226:227], v[226:227] op_sel:[0,0,1] op_sel_hi:[1,0,1]
    v_rcp_f32 v216, v216
    v_pk_fma_f32 v[8:9], v[8:9], v[226:227], v[226:227] op_sel:[0,0,1] op_sel_hi:[1,0,1]
    v_pk_fma_f32 v[10:11], v[10:11], v[226:227], v[226:227] op_sel:[0,0,1] op_sel_hi:[1,0,1]
    v_rcp_f32 v217, v217
    v_pk_fma_f32 v[12:13], v[12:13], v[226:227], v[226:227] op_sel:[0,0,1] op_sel_hi:[1,0,1]
    v_rcp_f32 v218, v218
    v_pk_fma_f32 v[14:15], v[14:15], v[226:227], v[226:227] op_sel:[0,0,1] op_sel_hi:[1,0,1]
    v_pk_mul_f32 v[0:1], v[0:1], v[72:73]
    v_rcp_f32 v219, v219
    v_pk_mul_f32 v[2:3], v[2:3], v[74:75]
    v_rcp_f32 v220, v220
    v_pk_mul_f32 v[4:5], v[4:5], v[96:97]
    v_pk_mul_f32 v[6:7], v[6:7], v[98:99]
    v_rcp_f32 v221, v221
    v_pk_mul_f32 v[8:9], v[8:9], v[76:77]
    v_rcp_f32 v222, v222
    v_pk_mul_f32 v[10:11], v[10:11], v[78:79]
    v_pk_mul_f32 v[12:13], v[12:13], v[100:101]
    v_rcp_f32 v223, v223
    v_pk_mul_f32 v[14:15], v[14:15], v[102:103]
    v_exp_f32 v0, v0
    v_pk_mul_f32 v[64:65], v[64:65], v[208:209]
    v_pk_mul_f32 v[66:67], v[66:67], v[210:211]
    v_exp_f32 v1, v1
    v_pk_mul_f32 v[88:89], v[88:89], v[212:213]
    v_exp_f32 v2, v2
    v_pk_mul_f32 v[90:91], v[90:91], v[214:215]
    v_exp_f32 v3, v3
    v_pk_mul_f32 v[68:69], v[68:69], v[216:217]
    v_exp_f32 v4, v4
    v_pk_mul_f32 v[70:71], v[70:71], v[218:219]
    v_exp_f32 v5, v5
    v_pk_mul_f32 v[92:93], v[92:93], v[220:221]
    v_pk_mul_f32 v[94:95], v[94:95], v[222:223]
    v_exp_f32 v6, v6
    v_cvt_pk_bf16_f32 v236, v64, v65
    v_exp_f32 v7, v7
    v_cvt_pk_bf16_f32 v237, v66, v67
    v_exp_f32 v8, v8
    v_cvt_pk_bf16_f32 v238, v88, v89
    v_exp_f32 v9, v9
    v_cvt_pk_bf16_f32 v239, v90, v91
    v_exp_f32 v10, v10
    s_add_u32 s41, s41, 114688
    buffer_store_dwordx4 v[236:239], v224, s[16:19], s41 offen  sc1
    v_exp_f32 v11, v11
    v_cvt_pk_bf16_f32 v240, v68, v69
    v_exp_f32 v12, v12
    v_cvt_pk_bf16_f32 v241, v70, v71
    v_exp_f32 v13, v13
    v_cvt_pk_bf16_f32 v242, v92, v93
    v_exp_f32 v14, v14
    v_cvt_pk_bf16_f32 v243, v94, v95
    v_exp_f32 v15, v15
    buffer_store_dwordx4 v[240:243], v224, s[16:19], s41 offen offset:1024  sc1
    v_pk_add_f32 v[0:1], v[0:1], 1.0 op_sel_hi:[1,0]
    v_pk_add_f32 v[2:3], v[2:3], 1.0 op_sel_hi:[1,0]
    v_pk_add_f32 v[4:5], v[4:5], 1.0 op_sel_hi:[1,0]
    v_pk_add_f32 v[6:7], v[6:7], 1.0 op_sel_hi:[1,0]
    v_pk_add_f32 v[8:9], v[8:9], 1.0 op_sel_hi:[1,0]
    v_pk_add_f32 v[10:11], v[10:11], 1.0 op_sel_hi:[1,0]
    v_pk_add_f32 v[12:13], v[12:13], 1.0 op_sel_hi:[1,0]
    v_pk_add_f32 v[14:15], v[14:15], 1.0 op_sel_hi:[1,0]
L_pad_p1y_6:
    s_cbranch_execz L_pad_p1y_10
    v_rcp_f32 v0, v0
    v_pk_mul_f32 v[208:209], v[80:81], v[80:81]
    v_pk_mul_f32 v[210:211], v[82:83], v[82:83]
    v_rcp_f32 v1, v1
    v_pk_mul_f32 v[212:213], v[104:105], v[104:105]
    v_rcp_f32 v2, v2
    v_pk_mul_f32 v[214:215], v[106:107], v[106:107]
    v_pk_mul_f32 v[216:217], v[84:85], v[84:85]
    v_rcp_f32 v3, v3
    v_pk_mul_f32 v[218:219], v[86:87], v[86:87]
    v_rcp_f32 v4, v4
    v_pk_mul_f32 v[220:221], v[108:109], v[108:109]
    v_pk_mul_f32 v[222:223], v[110:111], v[110:111]
    v_rcp_f32 v5, v5
    v_pk_fma_f32 v[208:209], v[208:209], v[226:227], v[226:227] op_sel:[0,0,1] op_sel_hi:[1,0,1]
    v_rcp_f32 v6, v6
    v_pk_fma_f32 v[210:211], v[210:211], v[226:227], v[226:227] op_sel:[0,0,1] op_sel_hi:[1,0,1]
    v_pk_fma_f32 v[212:213], v[212:213], v[226:227], v[226:227] op_sel:[0,0,1] op_sel_hi:[1,0,1]
    v_rcp_f32 v7, v7
    v_pk_fma_f32 v[214:215], v[214:215], v[226:227], v[226:227] op_sel:[0,0,1] op_sel_hi:[1,0,1]
    v_rcp_f32 v8, v8
    v_pk_fma_f32 v[216:217], v[216:217], v[226:227], v[226:227] op_sel:[0,0,1] op_sel_hi:[1,0,1]
    v_pk_fma_f32 v[218:219], v[218:219], v[226:227], v[226:227] op_sel:[0,0,1] op_sel_hi:[1,0,1]
    v_rcp_f32 v9, v9
    v_pk_fma_f32 v[220:221], v[220:221], v[226:227], v[226:227] op_sel:[0,0,1] op_sel_hi:[1,0,1]
    v_rcp_f32 v10, v10
    v_pk_fma_f32 v[222:223], v[222:223], v[226:227], v[226:227] op_sel:[0,0,1] op_sel_hi:[1,0,1]
    v_pk_mul_f32 v[208:209], v[208:209], v[80:81]
    v_rcp_f32 v11, v11
    v_pk_mul_f32 v[210:211], v[210:211], v[82:83]
    v_rcp_f32 v12, v12
    v_pk_mul_f32 v[212:213], v[212:213], v[104:105]
    v_pk_mul_f32 v[214:215], v[214:215], v[106:107]
    v_rcp_f32 v13, v13
    v_pk_mul_f32 v[216:217], v[216:217], v[84:85]
    v_rcp_f32 v14, v14
    v_pk_mul_f32 v[218:219], v[218:219], v[86:87]
    v_pk_mul_f32 v[220:221], v[220:221], v[108:109]
    v_rcp_f32 v15, v15
    v_pk_mul_f32 v[222:223], v[222:223], v[110:111]
    v_exp_f32 v208, v208
    v_pk_mul_f32 v[72:73], v[72:73], v[0:1]
    v_pk_mul_f32 v[74:75], v[74:75], v[2:3]
    v_exp_f32 v209, v209
    v_pk_mul_f32 v[96:97], v[96:97], v[4:5]
    v_exp_f32 v210, v210
    v_pk_mul_f32 v[98:99], v[98:99], v[6:7]
    v_exp_f32 v211, v211
    v_pk_mul_f32 v[76:77], v[76:77], v[8:9]
    v_exp_f32 v212, v212
    v_pk_mul_f32 v[78:79], v[78:79], v[10:11]
    v_exp_f32 v213, v213
    v_pk_mul_f32 v[100:101], v[100:101], v[12:13]
    v_exp_f32 v214, v214
    v_pk_mul_f32 v[102:103], v[102:103], v[14:15]
    v_exp_f32 v215, v215
    v_cvt_pk_bf16_f32 v228, v72, v73
    v_exp_f32 v216, v216
    v_cvt_pk_bf16_f32 v229, v74, v75
    v_cvt_pk_bf16_f32 v230, v96, v97
    v_exp_f32 v217, v217
    v_cvt_pk_bf16_f32 v231, v98, v99
    v_exp_f32 v218, v218
    buffer_store_dwordx4 v[228:231], v224, s[16:19], s41 offen offset:2048  sc1
    v_exp_f32 v219, v219
    v_cvt_pk_bf16_f32 v232, v76, v77
    v_exp_f32 v220, v220
L_pad_p1y_7:
    s_cbranch_execz L_pad_p1y_11
    v_cvt_pk_bf16_f32 v233, v78, v79
    v_exp_f32 v221, v221
    v_cvt_pk_bf16_f32 v234, v100, v101
    v_exp_f32 v222, v222
    v_cvt_pk_bf16_f32 v235, v102, v103
    v_exp_f32 v223, v223
    buffer_store_dwordx4 v[232:235], v224, s[16:19], s41 offen offset:3072  sc1
    v_pk_add_f32 v[208:209], v[208:209], 1.0 op_sel_hi:[1,0]
    v_pk_add_f32 v[210:211], v[210:211], 1.0 op_sel_hi:[1,0]
    v_pk_add_f32 v[212:213], v[212:213], 1.0 op_sel_hi:[1,0]
    v_pk_add_f32 v[214:215], v[214:215], 1.0 op_sel_hi:[1,0]
    v_pk_add_f32 v[216:217], v[216:217], 1.0 op_sel_hi:[1,0]
    v_pk_add_f32 v[218:219], v[218:219], 1.0 op_sel_hi:[1,0]
    v_pk_add_f32 v[220:221], v[220:221], 1.0 op_sel_hi:[1,0]
    v_pk_add_f32 v[222:223], v[222:223], 1.0 op_sel_hi:[1,0]
    v_rcp_f32 v208, v208
    v_pk_mul_f32 v[0:1], v[112:113], v[112:113]
    v_pk_mul_f32 v[2:3], v[114:115], v[114:115]
    v_rcp_f32 v209, v209
    v_pk_mul_f32 v[4:5], v[136:137], v[136:137]
    v_rcp_f32 v210, v210
    v_pk_mul_f32 v[6:7], v[138:139], v[138:139]
    v_pk_mul_f32 v[8:9], v[116:117], v[116:117]
    v_rcp_f32 v211, v211
    v_pk_mul_f32 v[10:11], v[118:119], v[118:119]
    v_rcp_f32 v212, v212
    v_pk_mul_f32 v[12:13], v[140:141], v[140:141]
    v_pk_mul_f32 v[14:15], v[142:143], v[142:143]
    v_rcp_f32 v213, v213
    v_pk_fma_f32 v[0:1], v[0:1], v[226:227], v[226:227] op_sel:[0,0,1] op_sel_hi:[1,0,1]
    v_rcp_f32 v214, v214
    v_pk_fma_f32 v[2:3], v[2:3], v[226:227], v[226:227] op_sel:[0,0,1] op_sel_hi:[1,0,1]
    v_pk_fma_f32 v[4:5], v[4:5], v[226:227], v[226:227] op_sel:[0,0,1] op_sel_hi:[1,0,1]
    v_rcp_f32 v215, v215
    v_pk_fma_f32 v[6:7], v[6:7], v[226:227], v[226:227] op_sel:[0,0,1] op_sel_hi:[1,0,1]
    v_rcp_f32 v216, v216
    v_pk_fma_f32 v[8:9], v[8:9], v[226:227], v[226:227] op_sel:[0,0,1] op_sel_hi:[1,0,1]
    v_pk_fma_f32 v[10:11], v[10:11], v[226:227], v[226:227] op_sel:[0,0,1] op_sel_hi:[1,0,1]
    v_rcp_f32 v217, v217
    v_pk_fma_f32 v[12:13], v[12:13], v[226:227], v[226:227] op_sel:[0,0,1] op_sel_hi:[1,0,1]
    v_rcp_f32 v218, v218
    v_pk_fma_f32 v[14:15], v[14:15], v[226:227], v[226:227] op_sel:[0,0,1] op_sel_hi:[1,0,1]
    v_pk_mul_f32 v[0:1], v[0:1], v[112:113]
    v_rcp_f32 v219, v219
    v_pk_mul_f32 v[2:3], v[2:3], v[114:115]
    v_rcp_f32 v220, v220
    v_pk_mul_f32 v[4:5], v[4:5], v[136:137]
    v_pk_mul_f32 v[6:7], v[6:7], v[138:139]
    v_rcp_f32 v221, v221
    v_pk_mul_f32 v[8:9], v[8:9], v[116:117]
    v_rcp_f32 v222, v222
    v_pk_mul_f32 v[10:11], v[10:11], v[118:119]
    v_pk_mul_f32 v[12:13], v[12:13], v[140:141]
    v_rcp_f32 v223, v223
    v_pk_mul_f32 v[14:15], v[14:15], v[142:143]
    v_exp_f32 v0, v0
    v_pk_mul_f32 v[80:81], v[80:81], v[208:209]
    v_pk_mul_f32 v[82:83], v[82:83], v[210:211]
    v_exp_f32 v1, v1
    v_pk_mul_f32 v[104:105], v[104:105], v[212:213]
    v_exp_f32 v2, v2
    v_pk_mul_f32 v[106:107], v[106:107], v[214:215]
    v_exp_f32 v3, v3
    v_pk_mul_f32 v[84:85], v[84:85], v[216:217]
L_pad_p1y_8:
    s_cbranch_execz L_pad_p1y_12
    v_exp_f32 v4, v4
    v_pk_mul_f32 v[86:87], v[86:87], v[218:219]
    v_exp_f32 v5, v5
    v_pk_mul_f32 v[108:109], v[108:109], v[220:221]
    v_pk_mul_f32 v[110:111], v[110:111], v[222:223]
    v_exp_f32 v6, v6
    v_cvt_pk_bf16_f32 v236, v80, v81
    v_exp_f32 v7, v7
    v_cvt_pk_bf16_f32 v237, v82, v83
    v_exp_f32 v8, v8
    v_cvt_pk_bf16_f32 v238, v104, v105
    v_exp_f32 v9, v9
    v_cvt_pk_bf16_f32 v239, v106, v107
    v_exp_f32 v10, v10
    s_add_u32 s42, s41, 4096
    buffer_store_dwordx4 v[236:239], v224, s[16:19], s42 offen  sc1
    v_exp_f32 v11, v11
    v_cvt_pk_bf16_f32 v240, v84, v85
    v_exp_f32 v12, v12
    v_cvt_pk_bf16_f32 v241, v86, v87
    v_exp_f32 v13, v13
    v_cvt_pk_bf16_f32 v242, v108, v109
    v_exp_f32 v14, v14
    v_cvt_pk_bf16_f32 v243, v110, v111
    v_exp_f32 v15, v15
    buffer_store_dwordx4 v[240:243], v224, s[16:19], s42 offen offset:1024  sc1
    v_pk_add_f32 v[0:1], v[0:1], 1.0 op_sel_hi:[1,0]
    v_pk_add_f32 v[2:3], v[2:3], 1.0 op_sel_hi:[1,0]
    v_pk_add_f32 v[4:5], v[4:5], 1.0 op_sel_hi:[1,0]
    v_pk_add_f32 v[6:7], v[6:7], 1.0 op_sel_hi:[1,0]
    v_pk_add_f32 v[8:9], v[8:9], 1.0 op_sel_hi:[1,0]
    v_pk_add_f32 v[10:11], v[10:11], 1.0 op_sel_hi:[1,0]
    v_pk_add_f32 v[12:13], v[12:13], 1.0 op_sel_hi:[1,0]
    v_pk_add_f32 v[14:15], v[14:15], 1.0 op_sel_hi:[1,0]
    v_rcp_f32 v0, v0
    v_pk_mul_f32 v[208:209], v[120:121], v[120:121]
    v_pk_mul_f32 v[210:211], v[122:123], v[122:123]
    v_rcp_f32 v1, v1
    v_pk_mul_f32 v[212:213], v[144:145], v[144:145]
    v_rcp_f32 v2, v2
    v_pk_mul_f32 v[214:215], v[146:147], v[146:147]
    v_pk_mul_f32 v[216:217], v[124:125], v[124:125]
    v_rcp_f32 v3, v3
    v_pk_mul_f32 v[218:219], v[126:127], v[126:127]
    v_rcp_f32 v4, v4
    v_pk_mul_f32 v[220:221], v[148:149], v[148:149]
    v_pk_mul_f32 v[222:223], v[150:151], v[150:151]
    v_rcp_f32 v5, v5
    v_pk_fma_f32 v[208:209], v[208:209], v[226:227], v[226:227] op_sel:[0,0,1] op_sel_hi:[1,0,1]
    v_rcp_f32 v6, v6
    v_pk_fma_f32 v[210:211], v[210:211], v[226:227], v[226:227] op_sel:[0,0,1] op_sel_hi:[1,0,1]
    v_pk_fma_f32 v[212:213], v[212:213], v[226:227], v[226:227] op_sel:[0,0,1] op_sel_hi:[1,0,1]
    v_rcp_f32 v7, v7
    v_pk_fma_f32 v[214:215], v[214:215], v[226:227], v[226:227] op_sel:[0,0,1] op_sel_hi:[1,0,1]
    v_rcp_f32 v8, v8
    v_pk_fma_f32 v[216:217], v[216:217], v[226:227], v[226:227] op_sel:[0,0,1] op_sel_hi:[1,0,1]
    v_pk_fma_f32 v[218:219], v[218:219], v[226:227], v[226:227] op_sel:[0,0,1] op_sel_hi:[1,0,1]
    v_rcp_f32 v9, v9
    v_pk_fma_f32 v[220:221], v[220:221], v[226:227], v[226:227] op_sel:[0,0,1] op_sel_hi:[1,0,1]
    v_rcp_f32 v10, v10
    v_pk_fma_f32 v[222:223], v[222:223], v[226:227], v[226:227] op_sel:[0,0,1] op_sel_hi:[1,0,1]
    v_pk_mul_f32 v[208:209], v[208:209], v[120:121]
    v_rcp_f32 v11, v11
    v_pk_mul_f32 v[210:211], v[210:211], v[122:123]
    v_rcp_f32 v12, v12
    v_pk_mul_f32 v[212:213], v[212:213], v[144:145]
L_pad_p1y_9:
    s_cbranch_execz L_pad_p1y_13
    v_pk_mul_f32 v[214:215], v[214:215], v[146:147]
    v_rcp_f32 v13, v13
    v_pk_mul_f32 v[216:217], v[216:217], v[124:125]
    v_rcp_f32 v14, v14
    v_pk_mul_f32 v[218:219], v[218:219], v[126:127]
    v_pk_mul_f32 v[220:221], v[220:221], v[148:149]
    v_rcp_f32 v15, v15
    v_pk_mul_f32 v[222:223], v[222:223], v[150:151]
    v_exp_f32 v208, v208
    v_pk_mul_f32 v[112:113], v[112:113], v[0:1]
    v_pk_mul_f32 v[114:115], v[114:115], v[2:3]
    v_exp_f32 v209, v209
    v_pk_mul_f32 v[136:137], v[136:137], v[4:5]
    v_exp_f32 v210, v210
    v_pk_mul_f32 v[138:139], v[138:139], v[6:7]
    v_exp_f32 v211, v211
    v_pk_mul_f32 v[116:117], v[116:117], v[8:9]
    v_exp_f32 v212, v212
    v_pk_mul_f32 v[118:119], v[118:119], v[10:11]
    v_exp_f32 v213, v213
    v_pk_mul_f32 v[140:141], v[140:141], v[12:13]
    v_pk_mul_f32 v[142:143], v[142:143], v[14:15]
    v_exp_f32 v214, v214
    v_cvt_pk_bf16_f32 v228, v112, v113
    v_exp_f32 v215, v215
    v_cvt_pk_bf16_f32 v229, v114, v115
    v_exp_f32 v216, v216
    v_cvt_pk_bf16_f32 v230, v136, v137
    v_exp_f32 v217, v217
    v_cvt_pk_bf16_f32 v231, v138, v139
    v_exp_f32 v218, v218
    s_add_u32 s41, s41, 114688
    buffer_store_dwordx4 v[228:231], v224, s[16:19], s41 offen  sc1
    v_exp_f32 v219, v219
    v_cvt_pk_bf16_f32 v232, v116, v117
    v_exp_f32 v220, v220
    v_cvt_pk_bf16_f32 v233, v118, v119
    v_exp_f32 v221, v221
    v_cvt_pk_bf16_f32 v234, v140, v141
    v_exp_f32 v222, v222
    v_cvt_pk_bf16_f32 v235, v142, v143
    v_exp_f32 v223, v223
    buffer_store_dwordx4 v[232:235], v224, s[16:19], s41 offen offset:1024  sc1
    v_pk_add_f32 v[208:209], v[208:209], 1.0 op_sel_hi:[1,0]
    v_pk_add_f32 v[210:211], v[210:211], 1.0 op_sel_hi:[1,0]
    v_pk_add_f32 v[212:213], v[212:213], 1.0 op_sel_hi:[1,0]
    v_pk_add_f32 v[214:215], v[214:215], 1.0 op_sel_hi:[1,0]
    v_pk_add_f32 v[216:217], v[216:217], 1.0 op_sel_hi:[1,0]
    v_pk_add_f32 v[218:219], v[218:219], 1.0 op_sel_hi:[1,0]
    v_pk_add_f32 v[220:221], v[220:221], 1.0 op_sel_hi:[1,0]
    v_pk_add_f32 v[222:223], v[222:223], 1.0 op_sel_hi:[1,0]
    v_rcp_f32 v208, v208
    v_pk_mul_f32 v[0:1], v[128:129], v[128:129]
    v_pk_mul_f32 v[2:3], v[130:131], v[130:131]
    v_rcp_f32 v209, v209
    v_pk_mul_f32 v[4:5], v[152:153], v[152:153]
    v_rcp_f32 v210, v210
    v_pk_mul_f32 v[6:7], v[154:155], v[154:155]
    v_pk_mul_f32 v[8:9], v[132:133], v[132:133]
    v_rcp_f32 v211, v211
    v_pk_mul_f32 v[10:11], v[134:135], v[134:135]
    v_rcp_f32 v212, v212
    v_pk_mul_f32 v[12:13], v[156:157], v[156:157]
    v_pk_mul_f32 v[14:15], v[158:159], v[158:159]
    v_rcp_f32 v213, v213
L_pad_p1y_10:
    s_cbranch_execz L_pad_p1y_14
    v_pk_fma_f32 v[0:1], v[0:1], v[226:227], v[226:227] op_sel:[0,0,1] op_sel_hi:[1,0,1]
    v_rcp_f32 v214, v214
    v_pk_fma_f32 v[2:3], v[2:3], v[226:227], v[226:227] op_sel:[0,0,1] op_sel_hi:[1,0,1]
    v_pk_fma_f32 v[4:5], v[4:5], v[226:227], v[226:227] op_sel:[0,0,1] op_sel_hi:[1,0,1]
    v_rcp_f32 v215, v215
    v_pk_fma_f32 v[6:7], v[6:7], v[226:227], v[226:227] op_sel:[0,0,1] op_sel_hi:[1,0,1]
    v_rcp_f32 v216, v216
    v_pk_fma_f32 v[8:9], v[8:9], v[226:227], v[226:227] op_sel:[0,0,1] op_sel_hi:[1,0,1]
    v_pk_fma_f32 v[10:11], v[10:11], v[226:227], v[226:227] op_sel:[0,0,1] op_sel_hi:[1,0,1]
    v_rcp_f32 v217, v217
    v_pk_fma_f32 v[12:13], v[12:13], v[226:227], v[226:227] op_sel:[0,0,1] op_sel_hi:[1,0,1]
    v_rcp_f32 v218, v218
    v_pk_fma_f32 v[14:15], v[14:15], v[226:227], v[226:227] op_sel:[0,0,1] op_sel_hi:[1,0,1]
    v_pk_mul_f32 v[0:1], v[0:1], v[128:129]
    v_rcp_f32 v219, v219
    v_pk_mul_f32 v[2:3], v[2:3], v[130:131]
    v_rcp_f32 v220, v220
    v_pk_mul_f32 v[4:5], v[4:5], v[152:153]
    v_pk_mul_f32 v[6:7], v[6:7], v[154:155]
    v_rcp_f32 v221, v221
    v_pk_mul_f32 v[8:9], v[8:9], v[132:133]
    v_rcp_f32 v222, v222
    v_pk_mul_f32 v[10:11], v[10:11], v[134:135]
    v_pk_mul_f32 v[12:13], v[12:13], v[156:157]
    v_rcp_f32 v223, v223
    v_pk_mul_f32 v[14:15], v[14:15], v[158:159]
    v_exp_f32 v0, v0
    v_pk_mul_f32 v[120:121], v[120:121], v[208:209]
    v_pk_mul_f32 v[122:123], v[122:123], v[210:211]
    v_exp_f32 v1, v1
    v_pk_mul_f32 v[144:145], v[144:145], v[212:213]
    v_exp_f32 v2, v2
    v_pk_mul_f32 v[146:147], v[146:147], v[214:215]
    v_exp_f32 v3, v3
    v_pk_mul_f32 v[124:125], v[124:125], v[216:217]
    v_exp_f32 v4, v4
    v_pk_mul_f32 v[126:127], v[126:127], v[218:219]
    v_exp_f32 v5, v5
    v_pk_mul_f32 v[148:149], v[148:149], v[220:221]
    v_exp_f32 v6, v6
    v_pk_mul_f32 v[150:151], v[150:151], v[222:223]
    v_exp_f32 v7, v7
    v_cvt_pk_bf16_f32 v236, v120, v121
    v_exp_f32 v8, v8
    v_cvt_pk_bf16_f32 v237, v122, v123
    v_cvt_pk_bf16_f32 v238, v144, v145
    v_exp_f32 v9, v9
    v_cvt_pk_bf16_f32 v239, v146, v147
    v_exp_f32 v10, v10
    buffer_store_dwordx4 v[236:239], v224, s[16:19], s41 offen offset:2048  sc1
    v_exp_f32 v11, v11
    v_cvt_pk_bf16_f32 v240, v124, v125
    v_exp_f32 v12, v12
    v_cvt_pk_bf16_f32 v241, v126, v127
    v_exp_f32 v13, v13
    v_cvt_pk_bf16_f32 v242, v148, v149
    v_exp_f32 v14, v14
    v_cvt_pk_bf16_f32 v243, v150, v151
    v_exp_f32 v15, v15
    buffer_store_dwordx4 v[240:243], v224, s[16:19], s41 offen offset:3072  sc1
    v_pk_add_f32 v[0:1], v[0:1], 1.0 op_sel_hi:[1,0]
    v_pk_add_f32 v[2:3], v[2:3], 1.0 op_sel_hi:[1,0]
    v_pk_add_f32 v[4:5], v[4:5], 1.0 op_sel_hi:[1,0]
    v_pk_add_f32 v[6:7], v[6:7], 1.0 op_sel_hi:[1,0]
    v_pk_add_f32 v[8:9], v[8:9], 1.0 op_sel_hi:[1,0]
    v_pk_add_f32 v[10:11], v[10:11], 1.0 op_sel_hi:[1,0]
L_pad_p1y_11:
    s_cbranch_execz L_pad_p1y_15
    v_pk_add_f32 v[12:13], v[12:13], 1.0 op_sel_hi:[1,0]
    v_pk_add_f32 v[14:15], v[14:15], 1.0 op_sel_hi:[1,0]
    v_rcp_f32 v0, v0
    v_pk_mul_f32 v[208:209], v[160:161], v[160:161]
    v_pk_mul_f32 v[210:211], v[162:163], v[162:163]
    v_rcp_f32 v1, v1
    v_pk_mul_f32 v[212:213], v[184:185], v[184:185]
    v_rcp_f32 v2, v2
    v_pk_mul_f32 v[214:215], v[186:187], v[186:187]
    v_pk_mul_f32 v[216:217], v[164:165], v[164:165]
    v_rcp_f32 v3, v3
    v_pk_mul_f32 v[218:219], v[166:167], v[166:167]
    v_rcp_f32 v4, v4
    v_pk_mul_f32 v[220:221], v[188:189], v[188:189]
    v_pk_mul_f32 v[222:223], v[190:191], v[190:191]
    v_rcp_f32 v5, v5
    v_pk_fma_f32 v[208:209], v[208:209], v[226:227], v[226:227] op_sel:[0,0,1] op_sel_hi:[1,0,1]
    v_rcp_f32 v6, v6
    v_pk_fma_f32 v[210:211], v[210:211], v[226:227], v[226:227] op_sel:[0,0,1] op_sel_hi:[1,0,1]
    v_pk_fma_f32 v[212:213], v[212:213], v[226:227], v[226:227] op_sel:[0,0,1] op_sel_hi:[1,0,1]
    v_rcp_f32 v7, v7
    v_pk_fma_f32 v[214:215], v[214:215], v[226:227], v[226:227] op_sel:[0,0,1] op_sel_hi:[1,0,1]
    v_rcp_f32 v8, v8
    v_pk_fma_f32 v[216:217], v[216:217], v[226:227], v[226:227] op_sel:[0,0,1] op_sel_hi:[1,0,1]
    v_pk_fma_f32 v[218:219], v[218:219], v[226:227], v[226:227] op_sel:[0,0,1] op_sel_hi:[1,0,1]
    v_rcp_f32 v9, v9
    v_pk_fma_f32 v[220:221], v[220:221], v[226:227], v[226:227] op_sel:[0,0,1] op_sel_hi:[1,0,1]
    v_rcp_f32 v10, v10
    v_pk_fma_f32 v[222:223], v[222:223], v[226:227], v[226:227] op_sel:[0,0,1] op_sel_hi:[1,0,1]
    v_pk_mul_f32 v[208:209], v[208:209], v[160:161]
    v_rcp_f32 v11, v11
    v_pk_mul_f32 v[210:211], v[210:211], v[162:163]
    v_rcp_f32 v12, v12
    v_pk_mul_f32 v[212:213], v[212:213], v[184:185]
    v_pk_mul_f32 v[214:215], v[214:215], v[186:187]
    v_rcp_f32 v13, v13
    v_pk_mul_f32 v[216:217], v[216:217], v[164:165]
    v_rcp_f32 v14, v14
    v_pk_mul_f32 v[218:219], v[218:219], v[166:167]
    v_pk_mul_f32 v[220:221], v[220:221], v[188:189]
    v_rcp_f32 v15, v15
    v_pk_mul_f32 v[222:223], v[222:223], v[190:191]
    v_exp_f32 v208, v208
    v_pk_mul_f32 v[128:129], v[128:129], v[0:1]
    v_pk_mul_f32 v[130:131], v[130:131], v[2:3]
    v_exp_f32 v209, v209
    v_pk_mul_f32 v[152:153], v[152:153], v[4:5]
    v_exp_f32 v210, v210
    v_pk_mul_f32 v[154:155], v[154:155], v[6:7]
    v_exp_f32 v211, v211
    v_pk_mul_f32 v[132:133], v[132:133], v[8:9]
    v_exp_f32 v212, v212
    v_pk_mul_f32 v[134:135], v[134:135], v[10:11]
    v_exp_f32 v213, v213
    v_pk_mul_f32 v[156:157], v[156:157], v[12:13]
    v_pk_mul_f32 v[158:159], v[158:159], v[14:15]
    v_exp_f32 v214, v214
    v_cvt_pk_bf16_f32 v228, v128, v129
    v_exp_f32 v215, v215
    v_cvt_pk_bf16_f32 v229, v130, v131
    v_exp_f32 v216, v216
    v_cvt_pk_bf16_f32 v230, v152, v153
    v_exp_f32 v217, v217
    v_cvt_pk_bf16_f32 v231, v154, v155
    v_exp_f32 v218, v218
    s_add_u32 s42, s41, 4096
L_pad_p1y_12:
    s_cbranch_execz L_pad_p1y_ret
    buffer_store_dwordx4 v[228:231], v224, s[16:19], s42 offen  sc1
    v_exp_f32 v219, v219
    v_cvt_pk_bf16_f32 v232, v132, v133
    v_exp_f32 v220, v220
    v_cvt_pk_bf16_f32 v233, v134, v135
    v_exp_f32 v221, v221
    v_cvt_pk_bf16_f32 v234, v156, v157
    v_exp_f32 v222, v222
    v_cvt_pk_bf16_f32 v235, v158, v159
    v_exp_f32 v223, v223
    buffer_store_dwordx4 v[232:235], v224, s[16:19], s42 offen offset:1024  sc1
    v_pk_add_f32 v[208:209], v[208:209], 1.0 op_sel_hi:[1,0]
    v_pk_add_f32 v[210:211], v[210:211], 1.0 op_sel_hi:[1,0]
    v_pk_add_f32 v[212:213], v[212:213], 1.0 op_sel_hi:[1,0]
    v_pk_add_f32 v[214:215], v[214:215], 1.0 op_sel_hi:[1,0]
    v_pk_add_f32 v[216:217], v[216:217], 1.0 op_sel_hi:[1,0]
    v_pk_add_f32 v[218:219], v[218:219], 1.0 op_sel_hi:[1,0]
    v_pk_add_f32 v[220:221], v[220:221], 1.0 op_sel_hi:[1,0]
    v_pk_add_f32 v[222:223], v[222:223], 1.0 op_sel_hi:[1,0]
    v_rcp_f32 v208, v208
    v_pk_mul_f32 v[0:1], v[168:169], v[168:169]
    v_pk_mul_f32 v[2:3], v[170:171], v[170:171]
    v_rcp_f32 v209, v209
    v_pk_mul_f32 v[4:5], v[192:193], v[192:193]
    v_rcp_f32 v210, v210
    v_pk_mul_f32 v[6:7], v[194:195], v[194:195]
    v_pk_mul_f32 v[8:9], v[172:173], v[172:173]
    v_rcp_f32 v211, v211
    v_pk_mul_f32 v[10:11], v[174:175], v[174:175]
    v_rcp_f32 v212, v212
    v_pk_mul_f32 v[12:13], v[196:197], v[196:197]
    v_pk_mul_f32 v[14:15], v[198:199], v[198:199]
    v_rcp_f32 v213, v213
    v_pk_fma_f32 v[0:1], v[0:1], v[226:227], v[226:227] op_sel:[0,0,1] op_sel_hi:[1,0,1]
    v_rcp_f32 v214, v214
    v_pk_fma_f32 v[2:3], v[2:3], v[226:227], v[226:227] op_sel:[0,0,1] op_sel_hi:[1,0,1]
    v_pk_fma_f32 v[4:5], v[4:5], v[226:227], v[226:227] op_sel:[0,0,1] op_sel_hi:[1,0,1]
    v_rcp_f32 v215, v215
    v_pk_fma_f32 v[6:7], v[6:7], v[226:227], v[226:227] op_sel:[0,0,1] op_sel_hi:[1,0,1]
    v_rcp_f32 v216, v216
    v_pk_fma_f32 v[8:9], v[8:9], v[226:227], v[226:227] op_sel:[0,0,1] op_sel_hi:[1,0,1]
    v_pk_fma_f32 v[10:11], v[10:11], v[226:227], v[226:227] op_sel:[0,0,1] op_sel_hi:[1,0,1]
    v_rcp_f32 v217, v217
    v_pk_fma_f32 v[12:13], v[12:13], v[226:227], v[226:227] op_sel:[0,0,1] op_sel_hi:[1,0,1]
    v_rcp_f32 v218, v218
    v_pk_fma_f32 v[14:15], v[14:15], v[226:227], v[226:227] op_sel:[0,0,1] op_sel_hi:[1,0,1]
    v_pk_mul_f32 v[0:1], v[0:1], v[168:169]
    v_rcp_f32 v219, v219
    v_pk_mul_f32 v[2:3], v[2:3], v[170:171]
    v_rcp_f32 v220, v220
    v_pk_mul_f32 v[4:5], v[4:5], v[192:193]
    v_pk_mul_f32 v[6:7], v[6:7], v[194:195]
    v_rcp_f32 v221, v221
    v_pk_mul_f32 v[8:9], v[8:9], v[172:173]
    v_rcp_f32 v222, v222
    v_pk_mul_f32 v[10:11], v[10:11], v[174:175]
    v_pk_mul_f32 v[12:13], v[12:13], v[196:197]
    v_rcp_f32 v223, v223
    v_pk_mul_f32 v[14:15], v[14:15], v[198:199]
    v_exp_f32 v0, v0
    v_pk_mul_f32 v[160:161], v[160:161], v[208:209]
    v_pk_mul_f32 v[162:163], v[162:163], v[210:211]
    v_exp_f32 v1, v1
    v_pk_mul_f32 v[184:185], v[184:185], v[212:213]
    v_exp_f32 v2, v2
L_pad_p1y_13:
    s_cbranch_execz L_pad_p1y_ret
    v_pk_mul_f32 v[186:187], v[186:187], v[214:215]
    v_exp_f32 v3, v3
    v_pk_mul_f32 v[164:165], v[164:165], v[216:217]
    v_exp_f32 v4, v4
    v_pk_mul_f32 v[166:167], v[166:167], v[218:219]
    v_exp_f32 v5, v5
    v_pk_mul_f32 v[188:189], v[188:189], v[220:221]
    v_pk_mul_f32 v[190:191], v[190:191], v[222:223]
    v_exp_f32 v6, v6
    v_cvt_pk_bf16_f32 v236, v160, v161
    v_exp_f32 v7, v7
    v_cvt_pk_bf16_f32 v237, v162, v163
    v_exp_f32 v8, v8
    v_cvt_pk_bf16_f32 v238, v184, v185
    v_exp_f32 v9, v9
    v_cvt_pk_bf16_f32 v239, v186, v187
    v_exp_f32 v10, v10
    s_add_u32 s41, s41, 114688
    buffer_store_dwordx4 v[236:239], v224, s[16:19], s41 offen  sc1
    v_exp_f32 v11, v11
    v_cvt_pk_bf16_f32 v240, v164, v165
    v_exp_f32 v12, v12
    v_cvt_pk_bf16_f32 v241, v166, v167
    v_exp_f32 v13, v13
    v_cvt_pk_bf16_f32 v242, v188, v189
    v_exp_f32 v14, v14
    v_cvt_pk_bf16_f32 v243, v190, v191
    v_exp_f32 v15, v15
    buffer_store_dwordx4 v[240:243], v224, s[16:19], s41 offen offset:1024  sc1
    v_pk_add_f32 v[0:1], v[0:1], 1.0 op_sel_hi:[1,0]
    v_pk_add_f32 v[2:3], v[2:3], 1.0 op_sel_hi:[1,0]
    v_pk_add_f32 v[4:5], v[4:5], 1.0 op_sel_hi:[1,0]
    v_pk_add_f32 v[6:7], v[6:7], 1.0 op_sel_hi:[1,0]
    v_pk_add_f32 v[8:9], v[8:9], 1.0 op_sel_hi:[1,0]
    v_pk_add_f32 v[10:11], v[10:11], 1.0 op_sel_hi:[1,0]
    v_pk_add_f32 v[12:13], v[12:13], 1.0 op_sel_hi:[1,0]
    v_pk_add_f32 v[14:15], v[14:15], 1.0 op_sel_hi:[1,0]
    v_rcp_f32 v0, v0
    v_pk_mul_f32 v[208:209], v[176:177], v[176:177]
    v_pk_mul_f32 v[210:211], v[178:179], v[178:179]
    v_rcp_f32 v1, v1
    v_pk_mul_f32 v[212:213], v[200:201], v[200:201]
    v_rcp_f32 v2, v2
    v_pk_mul_f32 v[214:215], v[202:203], v[202:203]
    v_pk_mul_f32 v[216:217], v[180:181], v[180:181]
    v_rcp_f32 v3, v3
    v_pk_mul_f32 v[218:219], v[182:183], v[182:183]
    v_rcp_f32 v4, v4
    v_pk_mul_f32 v[220:221], v[204:205], v[204:205]
    v_pk_mul_f32 v[222:223], v[206:207], v[206:207]
    v_rcp_f32 v5, v5
    v_pk_fma_f32 v[208:209], v[208:209], v[226:227], v[226:227] op_sel:[0,0,1] op_sel_hi:[1,0,1]
    v_rcp_f32 v6, v6
    v_pk_fma_f32 v[210:211], v[210:211], v[226:227], v[226:227] op_sel:[0,0,1] op_sel_hi:[1,0,1]
    v_pk_fma_f32 v[212:213], v[212:213], v[226:227], v[226:227] op_sel:[0,0,1] op_sel_hi:[1,0,1]
    v_rcp_f32 v7, v7
    v_pk_fma_f32 v[214:215], v[214:215], v[226:227], v[226:227] op_sel:[0,0,1] op_sel_hi:[1,0,1]
    v_rcp_f32 v8, v8
    v_pk_fma_f32 v[216:217], v[216:217], v[226:227], v[226:227] op_sel:[0,0,1] op_sel_hi:[1,0,1]
    v_pk_fma_f32 v[218:219], v[218:219], v[226:227], v[226:227] op_sel:[0,0,1] op_sel_hi:[1,0,1]
    v_rcp_f32 v9, v9
    v_pk_fma_f32 v[220:221], v[220:221], v[226:227], v[226:227] op_sel:[0,0,1] op_sel_hi:[1,0,1]
    v_rcp_f32 v10, v10
    v_pk_fma_f32 v[222:223], v[222:223], v[226:227], v[226:227] op_sel:[0,0,1] op_sel_hi:[1,0,1]
    v_pk_mul_f32 v[208:209], v[208:209], v[176:177]
L_pad_p1y_14:
    s_cbranch_execz L_pad_p1y_ret
    v_rcp_f32 v11, v11
    v_pk_mul_f32 v[210:211], v[210:211], v[178:179]
    v_rcp_f32 v12, v12
    v_pk_mul_f32 v[212:213], v[212:213], v[200:201]
    v_pk_mul_f32 v[214:215], v[214:215], v[202:203]
    v_rcp_f32 v13, v13
    v_pk_mul_f32 v[216:217], v[216:217], v[180:181]
    v_rcp_f32 v14, v14
    v_pk_mul_f32 v[218:219], v[218:219], v[182:183]
    v_pk_mul_f32 v[220:221], v[220:221], v[204:205]
    v_rcp_f32 v15, v15
    v_pk_mul_f32 v[222:223], v[222:223], v[206:207]
    v_exp_f32 v208, v208
    v_pk_mul_f32 v[168:169], v[168:169], v[0:1]
    v_pk_mul_f32 v[170:171], v[170:171], v[2:3]
    v_exp_f32 v209, v209
    v_pk_mul_f32 v[192:193], v[192:193], v[4:5]
    v_exp_f32 v210, v210
    v_pk_mul_f32 v[194:195], v[194:195], v[6:7]
    v_exp_f32 v211, v211
    v_pk_mul_f32 v[172:173], v[172:173], v[8:9]
    v_exp_f32 v212, v212
    v_pk_mul_f32 v[174:175], v[174:175], v[10:11]
    v_exp_f32 v213, v213
    v_pk_mul_f32 v[196:197], v[196:197], v[12:13]
    v_exp_f32 v214, v214
    v_pk_mul_f32 v[198:199], v[198:199], v[14:15]
    v_exp_f32 v215, v215
    v_cvt_pk_bf16_f32 v228, v168, v169
    v_exp_f32 v216, v216
    v_cvt_pk_bf16_f32 v229, v170, v171
    v_cvt_pk_bf16_f32 v230, v192, v193
    v_exp_f32 v217, v217
    v_cvt_pk_bf16_f32 v231, v194, v195
    v_exp_f32 v218, v218
    buffer_store_dwordx4 v[228:231], v224, s[16:19], s41 offen offset:2048  sc1
    v_exp_f32 v219, v219
    v_cvt_pk_bf16_f32 v232, v172, v173
    v_exp_f32 v220, v220
    v_cvt_pk_bf16_f32 v233, v174, v175
    v_exp_f32 v221, v221
    v_cvt_pk_bf16_f32 v234, v196, v197
    v_exp_f32 v222, v222
    v_cvt_pk_bf16_f32 v235, v198, v199
    v_exp_f32 v223, v223
    buffer_store_dwordx4 v[232:235], v224, s[16:19], s41 offen offset:3072  sc1
    v_pk_add_f32 v[208:209], v[208:209], 1.0 op_sel_hi:[1,0]
    v_pk_add_f32 v[210:211], v[210:211], 1.0 op_sel_hi:[1,0]
    v_pk_add_f32 v[212:213], v[212:213], 1.0 op_sel_hi:[1,0]
    v_pk_add_f32 v[214:215], v[214:215], 1.0 op_sel_hi:[1,0]
    v_pk_add_f32 v[216:217], v[216:217], 1.0 op_sel_hi:[1,0]
    v_pk_add_f32 v[218:219], v[218:219], 1.0 op_sel_hi:[1,0]
    v_pk_add_f32 v[220:221], v[220:221], 1.0 op_sel_hi:[1,0]
    v_pk_add_f32 v[222:223], v[222:223], 1.0 op_sel_hi:[1,0]
    v_rcp_f32 v208, v208
    v_rcp_f32 v209, v209
    v_rcp_f32 v210, v210
    v_rcp_f32 v211, v211
    v_rcp_f32 v212, v212
    v_rcp_f32 v213, v213
    v_rcp_f32 v214, v214
    v_rcp_f32 v215, v215
    v_rcp_f32 v216, v216
    v_rcp_f32 v217, v217
    v_rcp_f32 v218, v218
    v_rcp_f32 v219, v219
    v_rcp_f32 v220, v220
    v_rcp_f32 v221, v221
    v_rcp_f32 v222, v222
    v_rcp_f32 v223, v223
    v_pk_mul_f32 v[176:177], v[176:177], v[208:209]
    v_pk_mul_f32 v[178:179], v[178:179], v[210:211]
L_pad_p1y_15:
    s_cbranch_execz L_pad_p1y_ret
    v_pk_mul_f32 v[200:201], v[200:201], v[212:213]
    v_pk_mul_f32 v[202:203], v[202:203], v[214:215]
    v_pk_mul_f32 v[180:181], v[180:181], v[216:217]
    v_pk_mul_f32 v[182:183], v[182:183], v[218:219]
    v_pk_mul_f32 v[204:205], v[204:205], v[220:221]
    v_pk_mul_f32 v[206:207], v[206:207], v[222:223]
    v_cvt_pk_bf16_f32 v236, v176, v177
    v_cvt_pk_bf16_f32 v237, v178, v179
    v_cvt_pk_bf16_f32 v238, v200, v201
    v_cvt_pk_bf16_f32 v239, v202, v203
    s_add_u32 s42, s41, 4096
    buffer_store_dwordx4 v[236:239], v224, s[16:19], s42 offen  sc1
    v_cvt_pk_bf16_f32 v240, v180, v181
    v_cvt_pk_bf16_f32 v241, v182, v183
    v_cvt_pk_bf16_f32 v242, v204, v205
    v_cvt_pk_bf16_f32 v243, v206, v207
    buffer_store_dwordx4 v[240:243], v224, s[16:19], s42 offen offset:1024  sc1
    v_accvgpr_read_b32 v0, a128
    v_accvgpr_read_b32 v1, a132
    v_accvgpr_read_b32 v2, a136
    v_accvgpr_read_b32 v3, a140
    v_accvgpr_read_b32 v4, a144
    v_accvgpr_read_b32 v5, a148
    v_accvgpr_read_b32 v6, a152
    v_accvgpr_read_b32 v7, a156
    v_mul_f32 v0, 0xbfb8aa3b, v0
    v_mul_f32 v1, 0xbfb8aa3b, v1
    v_mul_f32 v2, 0xbfb8aa3b, v2
    v_mul_f32 v3, 0xbfb8aa3b, v3
    v_mul_f32 v4, 0xbfb8aa3b, v4
    v_mul_f32 v5, 0xbfb8aa3b, v5
    v_mul_f32 v6, 0xbfb8aa3b, v6
    v_mul_f32 v7, 0xbfb8aa3b, v7
    v_exp_f32 v0, v0
    v_exp_f32 v1, v1
    v_exp_f32 v2, v2
    v_exp_f32 v3, v3
    v_exp_f32 v4, v4
    v_exp_f32 v5, v5
    v_exp_f32 v6, v6
    v_exp_f32 v7, v7
    v_add_f32 v0, 1.0, v0
    v_add_f32 v1, 1.0, v1
    v_add_f32 v2, 1.0, v2
    v_add_f32 v3, 1.0, v3
    v_add_f32 v4, 1.0, v4
    v_add_f32 v5, 1.0, v5
    v_add_f32 v6, 1.0, v6
    v_add_f32 v7, 1.0, v7
    v_rcp_f32 v0, v0
    v_rcp_f32 v1, v1
    v_rcp_f32 v2, v2
    v_rcp_f32 v3, v3
    v_rcp_f32 v4, v4
    v_rcp_f32 v5, v5
    v_rcp_f32 v6, v6
    v_rcp_f32 v7, v7
    v_lshlrev_b32 v225, 3, v225
    s_lshl_b32 s41, s50, 7
    s_add_u32 s41, s41, s27
    s_lshl_b32 s41, s41, 2
    s_add_u32 s41, s41, 0x1c00000
    buffer_store_dwordx2 v[0:1], v225, s[16:19], s41 offen  sc1
    buffer_store_dwordx2 v[2:3], v225, s[16:19], s41 offen offset:128  sc1
    buffer_store_dwordx2 v[4:5], v225, s[16:19], s41 offen offset:256  sc1
    buffer_store_dwordx2 v[6:7], v225, s[16:19], s41 offen offset:384  sc1
    s_barrier
    s_branch L_p1_done
L_p1_Z:
    s_max_u32 s41, s41, 2
    s_sub_u32 s41, s41, 2
    s_sub_u32 s26, s43, 4
    s_sub_u32 s26, s26, s41
    s_add_u32 s41, s26, 16
    s_lshl_b32 s41, s41, 2
    s_add_u32 s31, s31, s41
    s_and_b32 s41, s26, 7
    s_sub_u32 s41, s41, 3
    s_cmp_lt_u32 s41, 2
    s_cselect_b32 s41, 7, 0
    s_xor_b32 s55, s26, s41
    s_cmp_ge_u32 s26, 7
    s_addc_u32 s41, s26, 0
    s_mul_i32 s85, s41, 4352
    s_and_b32 s41, s26, 1
    s_lshl_b32 s42, s25, 1
    s_add_u32 s41, s41, s42
    s_lshl_b32 s41, s41, 2
    s_add_u32 s85, s85, s41
    s_add_u32 s85, s85, 0x1c62000
    s_mul_i32 s29, s54, 458752
    s_mov_b32 s16, s78
    s_mov_b32 s17, s79
    s_mov_b32 s18, 0x10000000
    s_mov_b32 s19, 0x20000
    s_mov_b32 s20, s76
    s_mov_b32 s21, s77
    s_mov_b32 s22, 0x100
    s_mov_b32 s23, 0x20000
    s_lshl_b32 s41, s26, 8
    s_add_u32 s41, s41, 3584
    s_movk_i32 s42, 128
    s_lshl_b32 s43, s55, 7
    s_add_u32 s43, s43, 1024
    s_mov_b32 s8, s64
    s_mov_b32 s9, s65
    s_mov_b32 s10, 0x700000
    s_mov_b32 s11, 0x20000
    v_lshrrev_b32 v200, 3, v0
    v_and_b32 v201, 7, v0
    v_and_b32 v202, 2, v200
    v_xor_b32 v201, v201, v202
    v_mul_u32_u24 v200, 7168, v200
    v_lshl_add_u32 v203, v201, 4, v200
    v_xor_b32 v204, 64, v203
    s_mul_i32 s44, s24, 6
    s_add_u32 s45, s44, 0
    s_lshr_b32 s46, s45, 3
    s_and_b32 s45, s45, 7
    s_mul_i32 s47, s46, s42
    s_add_u32 s47, s47, s41
    s_cmp_eq_u32 s46, 2
    s_cselect_b32 s47, s43, s47
    s_mul_i32 s45, s45, 57344
    s_add_u32 s47, s47, s45
    v_add_u32 v233, s47, v203
    s_add_u32 s45, s44, 1
    s_lshr_b32 s46, s45, 3
    s_and_b32 s45, s45, 7
    s_mul_i32 s47, s46, s42
    s_add_u32 s47, s47, s41
    s_cmp_eq_u32 s46, 2
    s_cselect_b32 s47, s43, s47
    s_mul_i32 s45, s45, 57344
    s_add_u32 s47, s47, s45
    s_sub_u32 s47, s47, 1024
    v_add_u32 v234, s47, v204
    s_add_u32 s45, s44, 2
    s_lshr_b32 s46, s45, 3
    s_and_b32 s45, s45, 7
    s_mul_i32 s47, s46, s42
    s_add_u32 s47, s47, s41
    s_cmp_eq_u32 s46, 2
    s_cselect_b32 s47, s43, s47
    s_mul_i32 s45, s45, 57344
    s_add_u32 s47, s47, s45
    s_sub_u32 s47, s47, 2048
    v_add_u32 v235, s47, v203
    s_add_u32 s45, s44, 3
    s_lshr_b32 s46, s45, 3
    s_and_b32 s45, s45, 7
    s_mul_i32 s47, s46, s42
    s_add_u32 s47, s47, s41
    s_cmp_eq_u32 s46, 2
    s_cselect_b32 s47, s43, s47
    s_mul_i32 s45, s45, 57344
    s_add_u32 s47, s47, s45
    s_sub_u32 s47, s47, 3072
    v_add_u32 v236, s47, v204
    s_add_u32 s45, s44, 4
    s_lshr_b32 s46, s45, 3
    s_and_b32 s45, s45, 7
    s_mul_i32 s47, s46, s42
    s_add_u32 s47, s47, s41
    s_cmp_eq_u32 s46, 2
    s_cselect_b32 s47, s43, s47
    s_mul_i32 s45, s45, 57344
    s_add_u32 s47, s47, s45
    v_add_u32 v237, s47, v203
    s_add_u32 s45, s44, 5
    s_lshr_b32 s46, s45, 3
    s_and_b32 s45, s45, 7
    s_mul_i32 s47, s46, s42
    s_add_u32 s47, s47, s41
    s_cmp_eq_u32 s46, 2
    s_cselect_b32 s47, s43, s47
    s_mul_i32 s45, s45, 57344
    s_add_u32 s47, s47, s45
    s_sub_u32 s47, s47, 1024
    v_add_u32 v238, s47, v204
    s_mul_i32 s33, s24, 6144
    s_add_u32 s33, s33, 104448
    s_mov_b32 m0, s33
    s_nop 0
    buffer_load_dwordx4 v233, s[8:11], s29 offen lds
    buffer_load_dwordx4 v234, s[8:11], s29 offen offset:1024 lds
    buffer_load_dwordx4 v235, s[8:11], s29 offen offset:2048 lds
    buffer_load_dwordx4 v236, s[8:11], s29 offen offset:3072 lds
    s_add_u32 m0, s33, 4096
    s_nop 0
    buffer_load_dwordx4 v237, s[8:11], s29 offen lds
    buffer_load_dwordx4 v238, s[8:11], s29 offen offset:1024 lds
    v_mul_u32_u24 v252, 44, v0
    v_and_b32 v206, 15, v0
    v_lshrrev_b32 v207, 4, v0
    v_bfe_u32 v208, v0, 2, 2
    v_and_b32 v209, 3, v0
    v_lshrrev_b32 v200, 1, v206
    v_xor_b32 v200, v207, v200
    v_lshlrev_b32 v200, 4, v200
    v_lshl_add_u32 v200, v206, 7, v200
    s_lshl_b32 s41, s50, 14
    v_add_u32 v240, s41, v200
    v_xor_b32 v241, 64, v240
    v_lshl_add_u32 v200, v207, 3, v208
    v_lshrrev_b32 v201, 1, v208
    v_and_b32 v202, 1, v207
    v_lshl_or_b32 v201, v202, 1, v201
    v_lshlrev_b32 v203, 3, v209
    v_lshl_add_u32 v203, v200, 7, v203
    s_lshl_b32 s41, s51, 2
    s_add_u32 s41, s41, 0
    s_lshr_b32 s42, s41, 2
    s_lshl_b32 s42, s42, 13
    s_add_u32 s42, s42, 104448
    s_and_b32 s41, s41, 3
    v_xor_b32 v204, s41, v201
    v_lshl_add_u32 v204, v204, 5, v203
    v_add_u32 v244, s42, v204
    s_lshl_b32 s41, s51, 2
    s_add_u32 s41, s41, 1
    s_lshr_b32 s42, s41, 2
    s_lshl_b32 s42, s42, 13
    s_add_u32 s42, s42, 104448
    s_and_b32 s41, s41, 3
    v_xor_b32 v204, s41, v201
    v_lshl_add_u32 v204, v204, 5, v203
    v_add_u32 v245, s42, v204
    s_lshl_b32 s41, s51, 2
    s_add_u32 s41, s41, 2
    s_lshr_b32 s42, s41, 2
    s_lshl_b32 s42, s42, 13
    s_add_u32 s42, s42, 104448
    s_and_b32 s41, s41, 3
    v_xor_b32 v204, s41, v201
    v_lshl_add_u32 v204, v204, 5, v203
    v_add_u32 v246, s42, v204
    s_lshl_b32 s41, s51, 2
    s_add_u32 s41, s41, 3
    s_lshr_b32 s42, s41, 2
    s_lshl_b32 s42, s42, 13
    s_add_u32 s42, s42, 104448
    s_and_b32 s41, s41, 3
    v_xor_b32 v204, s41, v201
    v_lshl_add_u32 v204, v204, 5, v203
    v_add_u32 v247, s42, v204
    s_lshl_b32 s41, s51, 1
    s_add_u32 s41, s41, 8
    s_lshr_b32 s42, s41, 2
    s_lshl_b32 s42, s42, 13
    s_add_u32 s42, s42, 104448
    s_and_b32 s41, s41, 3
    v_xor_b32 v204, s41, v201
    v_lshl_add_u32 v204, v204, 5, v203
    v_add_u32 v248, s42, v204
    s_lshl_b32 s41, s51, 1
    s_add_u32 s41, s41, 9
    s_lshr_b32 s42, s41, 2
    s_lshl_b32 s42, s42, 13
    s_add_u32 s42, s42, 104448
    s_and_b32 s41, s41, 3
    v_xor_b32 v204, s41, v201
    v_lshl_add_u32 v204, v204, 5, v203
    v_add_u32 v249, s42, v204
    s_mov_b32 s12, s72
    s_mov_b32 s13, s73
    s_mov_b32 s14, 0x800
    s_mov_b32 s15, 0x20000
    v_mov_b32 v232, 0
    v_mov_b32 v239, 0
    s_mov_b32 s80, s72
    s_mov_b32 s81, s73
    s_mov_b32 s82, 0x800
    s_mov_b32 s83, 0x20000
    s_mov_b32 s36, 0
    s_mov_b32 s37, 34816
    s_mov_b32 s38, 34816
    s_mov_b32 s39, -69632
    s_mov_b32 s40, 28672
    s_mov_b64 exec, 0
    s_cmp_eq_u32 s24, 0
    s_cbranch_scc1 L_pad_p1z_0
    s_cmp_eq_u32 s24, 1
    s_cbranch_scc1 L_pad_p1z_1
    s_cmp_eq_u32 s24, 2
    s_cbranch_scc1 L_pad_p1z_2
    s_branch L_pad_p1z_3
L_pad_p1z_ret:
    s_mov_b64 exec, -1
    s_add_u32 s32, s32, 34816
    s_add_u32 s53, s53, 1
    s_add_u32 s42, s53, s52
    s_and_b32 s42, s42, 3
    s_and_b32 s54, s53, -4
    s_or_b32 s54, s54, s42
    s_lshl_b32 s28, s54, 7
    s_mul_i32 s29, s54, 458752
    s_mov_b32 m0, s32
    s_nop 0
    buffer_load_dwordx4 v224, s[4:7], s28 offen lds
    buffer_load_dwordx4 v225, s[4:7], s28 offen offset:1024 lds
    buffer_load_dwordx4 v226, s[4:7], s28 offen offset:2048 lds
    buffer_load_dwordx4 v227, s[4:7], s28 offen offset:3072 lds
    s_add_u32 m0, s32, 4096
    s_nop 0
    buffer_load_dwordx4 v228, s[4:7], s28 offen lds
    buffer_load_dwordx4 v229, s[4:7], s28 offen offset:1024 lds
    buffer_load_dwordx4 v230, s[4:7], s28 offen offset:2048 lds
    buffer_load_dwordx4 v231, s[4:7], s28 offen offset:3072 lds
    s_add_u32 s33, s33, 28672
    s_mov_b32 m0, s33
    s_nop 0
    buffer_load_dwordx4 v233, s[8:11], s29 offen lds
    buffer_load_dwordx4 v234, s[8:11], s29 offen offset:1024 lds
    buffer_load_dwordx4 v235, s[8:11], s29 offen offset:2048 lds
    buffer_load_dwordx4 v236, s[8:11], s29 offen offset:3072 lds
    s_add_u32 m0, s33, 4096
    s_nop 0
    buffer_load_dwordx4 v237, s[8:11], s29 offen lds
    buffer_load_dwordx4 v238, s[8:11], s29 offen offset:1024 lds
    s_add_u32 s32, s32, 34816
    s_sub_u32 s33, s33, 28672
    s_add_u32 s53, s53, 1
    s_add_u32 s42, s53, s52
    s_and_b32 s42, s42, 3
    s_and_b32 s54, s53, -4
    s_or_b32 s54, s54, s42
    s_lshl_b32 s28, s54, 7
    s_mul_i32 s29, s54, 458752
    s_waitcnt vmcnt(14)
    s_barrier
    ds_read_b128 a[0:3], v240 offset:0
    ds_read_b64_tr_b16 a[36:37], v244 offset:0
    ds_read_b64_tr_b16 a[38:39], v244 offset:512
    ds_read_b64_tr_b16 a[40:41], v245 offset:0
    ds_read_b64_tr_b16 a[42:43], v245 offset:512
    ds_read_b64_tr_b16 a[44:45], v246 offset:0
    ds_read_b64_tr_b16 a[46:47], v246 offset:512
    ds_read_b64_tr_b16 a[48:49], v247 offset:0
    ds_read_b64_tr_b16 a[50:51], v247 offset:512
    ds_read_b64_tr_b16 a[52:53], v248 offset:0
    ds_read_b64_tr_b16 a[54:55], v248 offset:512
    ds_read_b64_tr_b16 a[56:57], v249 offset:0
    ds_read_b64_tr_b16 a[58:59], v249 offset:512
    ds_read_b128 a[4:7], v240 offset:2048
    ds_read_b128 a[8:11], v240 offset:4096
    ds_read_b128 a[12:15], v240 offset:6144
    ds_read_b128 a[16:19], v240 offset:8192
    ds_read_b128 a[20:23], v240 offset:10240
    ds_read_b128 a[24:27], v240 offset:12288
    ds_read_b128 a[28:31], v240 offset:14336
    s_waitcnt lgkmcnt(0)
    v_mfma_f32_16x16x32_bf16 v[16:19], a[36:39], a[0:3], 0
    ds_read_b128 a[64:67], v241 offset:0
    v_mfma_f32_16x16x32_bf16 v[20:23], a[40:43], a[0:3], 0
    s_mov_b32 m0, s32
    v_mfma_f32_16x16x32_bf16 v[24:27], a[44:47], a[0:3], 0
    ds_read_b64_tr_b16 a[100:101], v244 offset:4096
    v_mfma_f32_16x16x32_bf16 v[28:31], a[48:51], a[0:3], 0
    ds_read_b64_tr_b16 a[102:103], v244 offset:4608
    v_mfma_f32_16x16x32_bf16 v[144:147], a[52:55], a[0:3], 0
    buffer_load_dwordx4 v224, s[4:7], s28 offen lds
    v_mfma_f32_16x16x32_bf16 v[148:151], a[56:59], a[0:3], 0
    ds_read_b64_tr_b16 a[104:105], v245 offset:4096
    v_mfma_f32_16x16x32_bf16 v[32:35], a[36:39], a[4:7], 0
    ds_read_b64_tr_b16 a[106:107], v245 offset:4608
    v_mfma_f32_16x16x32_bf16 v[36:39], a[40:43], a[4:7], 0
    ds_read_b64_tr_b16 a[108:109], v246 offset:4096
    v_mfma_f32_16x16x32_bf16 v[40:43], a[44:47], a[4:7], 0
    buffer_load_dwordx4 v225, s[4:7], s28 offen offset:1024 lds
    v_mfma_f32_16x16x32_bf16 v[44:47], a[48:51], a[4:7], 0
    ds_read_b64_tr_b16 a[110:111], v246 offset:4608
    v_mfma_f32_16x16x32_bf16 v[152:155], a[52:55], a[4:7], 0
    ds_read_b64_tr_b16 a[112:113], v247 offset:4096
    v_mfma_f32_16x16x32_bf16 v[156:159], a[56:59], a[4:7], 0
    buffer_load_dwordx4 v226, s[4:7], s28 offen offset:2048 lds
    v_mfma_f32_16x16x32_bf16 v[48:51], a[36:39], a[8:11], 0
    ds_read_b64_tr_b16 a[114:115], v247 offset:4608
    v_mfma_f32_16x16x32_bf16 v[52:55], a[40:43], a[8:11], 0
    ds_read_b64_tr_b16 a[116:117], v248 offset:4096
    v_mfma_f32_16x16x32_bf16 v[56:59], a[44:47], a[8:11], 0
    ds_read_b64_tr_b16 a[118:119], v248 offset:4608
    v_mfma_f32_16x16x32_bf16 v[60:63], a[48:51], a[8:11], 0
    buffer_load_dwordx4 v227, s[4:7], s28 offen offset:3072 lds
    v_mfma_f32_16x16x32_bf16 v[160:163], a[52:55], a[8:11], 0
    ds_read_b64_tr_b16 a[120:121], v249 offset:4096
    v_mfma_f32_16x16x32_bf16 v[164:167], a[56:59], a[8:11], 0
    ds_read_b64_tr_b16 a[122:123], v249 offset:4608
    v_mfma_f32_16x16x32_bf16 v[64:67], a[36:39], a[12:15], 0
    ds_read_b128 a[68:71], v241 offset:2048
    v_mfma_f32_16x16x32_bf16 v[68:71], a[40:43], a[12:15], 0
    s_add_u32 m0, s32, 4096
    v_mfma_f32_16x16x32_bf16 v[72:75], a[44:47], a[12:15], 0
    ds_read_b128 a[72:75], v241 offset:4096
    v_mfma_f32_16x16x32_bf16 v[76:79], a[48:51], a[12:15], 0
    ds_read_b128 a[76:79], v241 offset:6144
    v_mfma_f32_16x16x32_bf16 v[168:171], a[52:55], a[12:15], 0
    buffer_load_dwordx4 v228, s[4:7], s28 offen lds
    v_mfma_f32_16x16x32_bf16 v[172:175], a[56:59], a[12:15], 0
    ds_read_b128 a[80:83], v241 offset:8192
    v_mfma_f32_16x16x32_bf16 v[80:83], a[36:39], a[16:19], 0
    ds_read_b128 a[84:87], v241 offset:10240
    v_mfma_f32_16x16x32_bf16 v[84:87], a[40:43], a[16:19], 0
    ds_read_b128 a[88:91], v241 offset:12288
    v_mfma_f32_16x16x32_bf16 v[88:91], a[44:47], a[16:19], 0
    buffer_load_dwordx4 v229, s[4:7], s28 offen offset:1024 lds
    v_mfma_f32_16x16x32_bf16 v[92:95], a[48:51], a[16:19], 0
    ds_read_b128 a[92:95], v241 offset:14336
    v_mfma_f32_16x16x32_bf16 v[176:179], a[52:55], a[16:19], 0
    v_add_u32 v241, s37, v241
    v_mfma_f32_16x16x32_bf16 v[180:183], a[56:59], a[16:19], 0
    buffer_load_dwordx4 v230, s[4:7], s28 offen offset:2048 lds
    v_mfma_f32_16x16x32_bf16 v[96:99], a[36:39], a[20:23], 0
    v_add_u32 v240, s37, v240
    v_mfma_f32_16x16x32_bf16 v[100:103], a[40:43], a[20:23], 0
    v_add_u32 v244, s40, v244
    v_mfma_f32_16x16x32_bf16 v[104:107], a[44:47], a[20:23], 0
    v_add_u32 v245, s40, v245
    v_mfma_f32_16x16x32_bf16 v[108:111], a[48:51], a[20:23], 0
    buffer_load_dwordx4 v231, s[4:7], s28 offen offset:3072 lds
    v_mfma_f32_16x16x32_bf16 v[184:187], a[52:55], a[20:23], 0
    v_add_u32 v246, s40, v246
    v_mfma_f32_16x16x32_bf16 v[188:191], a[56:59], a[20:23], 0
    v_add_u32 v247, s40, v247
    v_mfma_f32_16x16x32_bf16 v[112:115], a[36:39], a[24:27], 0
    v_add_u32 v248, s40, v248
    v_mfma_f32_16x16x32_bf16 v[116:119], a[40:43], a[24:27], 0
    v_add_u32 v249, s40, v249
    v_mfma_f32_16x16x32_bf16 v[120:123], a[44:47], a[24:27], 0
    v_mfma_f32_16x16x32_bf16 v[124:127], a[48:51], a[24:27], 0
    v_mfma_f32_16x16x32_bf16 v[192:195], a[52:55], a[24:27], 0
    v_mfma_f32_16x16x32_bf16 v[196:199], a[56:59], a[24:27], 0
    v_mfma_f32_16x16x32_bf16 v[128:131], a[36:39], a[28:31], 0
    v_mfma_f32_16x16x32_bf16 v[132:135], a[40:43], a[28:31], 0
    v_mfma_f32_16x16x32_bf16 v[136:139], a[44:47], a[28:31], 0
    v_mfma_f32_16x16x32_bf16 v[140:143], a[48:51], a[28:31], 0
    v_mfma_f32_16x16x32_bf16 v[200:203], a[52:55], a[28:31], 0
    v_mfma_f32_16x16x32_bf16 v[204:207], a[56:59], a[28:31], 0
    s_waitcnt vmcnt(8) lgkmcnt(0)
    s_barrier
    v_mfma_f32_16x16x32_bf16 v[16:19], a[100:103], a[64:67], v[16:19]
    s_mov_b32 m0, s33
    v_mfma_f32_16x16x32_bf16 v[20:23], a[104:107], a[64:67], v[20:23]
    ds_read_b128 a[0:3], v240 offset:0
    v_mfma_f32_16x16x32_bf16 v[24:27], a[108:111], a[64:67], v[24:27]
    ds_read_b64_tr_b16 a[36:37], v244 offset:0
    v_mfma_f32_16x16x32_bf16 v[28:31], a[112:115], a[64:67], v[28:31]
    buffer_load_dwordx4 v233, s[8:11], s29 offen lds
    v_mfma_f32_16x16x32_bf16 v[144:147], a[116:119], a[64:67], v[144:147]
    ds_read_b64_tr_b16 a[38:39], v244 offset:512
    v_mfma_f32_16x16x32_bf16 v[148:151], a[120:123], a[64:67], v[148:151]
    ds_read_b64_tr_b16 a[40:41], v245 offset:0
    v_mfma_f32_16x16x32_bf16 v[32:35], a[100:103], a[68:71], v[32:35]
    ds_read_b64_tr_b16 a[42:43], v245 offset:512
    v_mfma_f32_16x16x32_bf16 v[36:39], a[104:107], a[68:71], v[36:39]
    buffer_load_dwordx4 v234, s[8:11], s29 offen offset:1024 lds
    v_mfma_f32_16x16x32_bf16 v[40:43], a[108:111], a[68:71], v[40:43]
    ds_read_b64_tr_b16 a[44:45], v246 offset:0
    v_mfma_f32_16x16x32_bf16 v[44:47], a[112:115], a[68:71], v[44:47]
    ds_read_b64_tr_b16 a[46:47], v246 offset:512
    v_mfma_f32_16x16x32_bf16 v[152:155], a[116:119], a[68:71], v[152:155]
    buffer_load_dwordx4 v235, s[8:11], s29 offen offset:2048 lds
    v_mfma_f32_16x16x32_bf16 v[156:159], a[120:123], a[68:71], v[156:159]
    ds_read_b64_tr_b16 a[48:49], v247 offset:0
    v_mfma_f32_16x16x32_bf16 v[48:51], a[100:103], a[72:75], v[48:51]
    ds_read_b64_tr_b16 a[50:51], v247 offset:512
    v_mfma_f32_16x16x32_bf16 v[52:55], a[104:107], a[72:75], v[52:55]
    ds_read_b64_tr_b16 a[52:53], v248 offset:0
    v_mfma_f32_16x16x32_bf16 v[56:59], a[108:111], a[72:75], v[56:59]
    buffer_load_dwordx4 v236, s[8:11], s29 offen offset:3072 lds
    v_mfma_f32_16x16x32_bf16 v[60:63], a[112:115], a[72:75], v[60:63]
    ds_read_b64_tr_b16 a[54:55], v248 offset:512
    v_mfma_f32_16x16x32_bf16 v[160:163], a[116:119], a[72:75], v[160:163]
    ds_read_b64_tr_b16 a[56:57], v249 offset:0
    v_mfma_f32_16x16x32_bf16 v[164:167], a[120:123], a[72:75], v[164:167]
    ds_read_b64_tr_b16 a[58:59], v249 offset:512
    v_mfma_f32_16x16x32_bf16 v[64:67], a[100:103], a[76:79], v[64:67]
    s_add_u32 m0, s33, 4096
    v_mfma_f32_16x16x32_bf16 v[68:71], a[104:107], a[76:79], v[68:71]
    ds_read_b128 a[4:7], v240 offset:2048
    v_mfma_f32_16x16x32_bf16 v[72:75], a[108:111], a[76:79], v[72:75]
    ds_read_b128 a[8:11], v240 offset:4096
    v_mfma_f32_16x16x32_bf16 v[76:79], a[112:115], a[76:79], v[76:79]
    buffer_load_dwordx4 v237, s[8:11], s29 offen lds
    v_mfma_f32_16x16x32_bf16 v[168:171], a[116:119], a[76:79], v[168:171]
    ds_read_b128 a[12:15], v240 offset:6144
    v_mfma_f32_16x16x32_bf16 v[172:175], a[120:123], a[76:79], v[172:175]
    ds_read_b128 a[16:19], v240 offset:8192
    v_mfma_f32_16x16x32_bf16 v[80:83], a[100:103], a[80:83], v[80:83]
    ds_read_b128 a[20:23], v240 offset:10240
    v_mfma_f32_16x16x32_bf16 v[84:87], a[104:107], a[80:83], v[84:87]
    buffer_load_dwordx4 v238, s[8:11], s29 offen offset:1024 lds
    v_mfma_f32_16x16x32_bf16 v[88:91], a[108:111], a[80:83], v[88:91]
    ds_read_b128 a[24:27], v240 offset:12288
    v_mfma_f32_16x16x32_bf16 v[92:95], a[112:115], a[80:83], v[92:95]
    ds_read_b128 a[28:31], v240 offset:14336
    v_mfma_f32_16x16x32_bf16 v[176:179], a[116:119], a[80:83], v[176:179]
    s_add_u32 s32, s32, s39
    v_mfma_f32_16x16x32_bf16 v[180:183], a[120:123], a[80:83], v[180:183]
    s_add_u32 s33, s33, s40
    v_mfma_f32_16x16x32_bf16 v[96:99], a[100:103], a[84:87], v[96:99]
    s_add_u32 s53, s53, 1
    v_mfma_f32_16x16x32_bf16 v[100:103], a[104:107], a[84:87], v[100:103]
    s_add_u32 s42, s53, s52
    v_mfma_f32_16x16x32_bf16 v[104:107], a[108:111], a[84:87], v[104:107]
    s_and_b32 s42, s42, 3
    v_mfma_f32_16x16x32_bf16 v[108:111], a[112:115], a[84:87], v[108:111]
    s_and_b32 s54, s53, -4
    v_mfma_f32_16x16x32_bf16 v[184:187], a[116:119], a[84:87], v[184:187]
    s_or_b32 s54, s54, s42
    v_mfma_f32_16x16x32_bf16 v[188:191], a[120:123], a[84:87], v[188:191]
    s_lshl_b32 s28, s54, 7
    v_mfma_f32_16x16x32_bf16 v[112:115], a[100:103], a[88:91], v[112:115]
    s_mul_i32 s29, s54, 458752
    v_mfma_f32_16x16x32_bf16 v[116:119], a[104:107], a[88:91], v[116:119]
    s_sub_u32 s40, 0, s40
    v_mfma_f32_16x16x32_bf16 v[120:123], a[108:111], a[88:91], v[120:123]
    s_mov_b32 s41, s37
    v_mfma_f32_16x16x32_bf16 v[124:127], a[112:115], a[88:91], v[124:127]
    s_mov_b32 s37, s38
    v_mfma_f32_16x16x32_bf16 v[192:195], a[116:119], a[88:91], v[192:195]
    s_mov_b32 s38, s39
    v_mfma_f32_16x16x32_bf16 v[196:199], a[120:123], a[88:91], v[196:199]
    s_mov_b32 s39, s41
    v_mfma_f32_16x16x32_bf16 v[128:131], a[100:103], a[92:95], v[128:131]
    v_mfma_f32_16x16x32_bf16 v[132:135], a[104:107], a[92:95], v[132:135]
    v_mfma_f32_16x16x32_bf16 v[136:139], a[108:111], a[92:95], v[136:139]
    v_mfma_f32_16x16x32_bf16 v[140:143], a[112:115], a[92:95], v[140:143]
    v_mfma_f32_16x16x32_bf16 v[200:203], a[116:119], a[92:95], v[200:203]
    v_mfma_f32_16x16x32_bf16 v[204:207], a[120:123], a[92:95], v[204:207]
    s_waitcnt lgkmcnt(0)
L_p1z_loop:
    v_mfma_f32_16x16x32_bf16 v[16:19], a[36:39], a[0:3], v[16:19]
    ds_read_b128 a[64:67], v241 offset:0
    v_mfma_f32_16x16x32_bf16 v[20:23], a[40:43], a[0:3], v[20:23]
    s_mov_b32 m0, s32
    v_mfma_f32_16x16x32_bf16 v[24:27], a[44:47], a[0:3], v[24:27]
    ds_read_b64_tr_b16 a[100:101], v244 offset:4096
    v_mfma_f32_16x16x32_bf16 v[28:31], a[48:51], a[0:3], v[28:31]
    ds_read_b64_tr_b16 a[102:103], v244 offset:4608
    v_mfma_f32_16x16x32_bf16 v[144:147], a[52:55], a[0:3], v[144:147]
    buffer_load_dwordx4 v224, s[4:7], s28 offen lds
    v_mfma_f32_16x16x32_bf16 v[148:151], a[56:59], a[0:3], v[148:151]
    ds_read_b64_tr_b16 a[104:105], v245 offset:4096
    v_mfma_f32_16x16x32_bf16 v[32:35], a[36:39], a[4:7], v[32:35]
    ds_read_b64_tr_b16 a[106:107], v245 offset:4608
    v_mfma_f32_16x16x32_bf16 v[36:39], a[40:43], a[4:7], v[36:39]
    ds_read_b64_tr_b16 a[108:109], v246 offset:4096
    v_mfma_f32_16x16x32_bf16 v[40:43], a[44:47], a[4:7], v[40:43]
    buffer_load_dwordx4 v225, s[4:7], s28 offen offset:1024 lds
    v_mfma_f32_16x16x32_bf16 v[44:47], a[48:51], a[4:7], v[44:47]
    ds_read_b64_tr_b16 a[110:111], v246 offset:4608
    v_mfma_f32_16x16x32_bf16 v[152:155], a[52:55], a[4:7], v[152:155]
    ds_read_b64_tr_b16 a[112:113], v247 offset:4096
    v_mfma_f32_16x16x32_bf16 v[156:159], a[56:59], a[4:7], v[156:159]
    buffer_load_dwordx4 v226, s[4:7], s28 offen offset:2048 lds
    v_mfma_f32_16x16x32_bf16 v[48:51], a[36:39], a[8:11], v[48:51]
    ds_read_b64_tr_b16 a[114:115], v247 offset:4608
    v_mfma_f32_16x16x32_bf16 v[52:55], a[40:43], a[8:11], v[52:55]
    ds_read_b64_tr_b16 a[116:117], v248 offset:4096
    v_mfma_f32_16x16x32_bf16 v[56:59], a[44:47], a[8:11], v[56:59]
    ds_read_b64_tr_b16 a[118:119], v248 offset:4608
    v_mfma_f32_16x16x32_bf16 v[60:63], a[48:51], a[8:11], v[60:63]
    buffer_load_dwordx4 v227, s[4:7], s28 offen offset:3072 lds
    v_mfma_f32_16x16x32_bf16 v[160:163], a[52:55], a[8:11], v[160:163]
    ds_read_b64_tr_b16 a[120:121], v249 offset:4096
    v_mfma_f32_16x16x32_bf16 v[164:167], a[56:59], a[8:11], v[164:167]
    ds_read_b64_tr_b16 a[122:123], v249 offset:4608
    v_mfma_f32_16x16x32_bf16 v[64:67], a[36:39], a[12:15], v[64:67]
    ds_read_b128 a[68:71], v241 offset:2048
    v_mfma_f32_16x16x32_bf16 v[68:71], a[40:43], a[12:15], v[68:71]
    s_add_u32 m0, s32, 4096
    v_mfma_f32_16x16x32_bf16 v[72:75], a[44:47], a[12:15], v[72:75]
    ds_read_b128 a[72:75], v241 offset:4096
    v_mfma_f32_16x16x32_bf16 v[76:79], a[48:51], a[12:15], v[76:79]
    ds_read_b128 a[76:79], v241 offset:6144
    v_mfma_f32_16x16x32_bf16 v[168:171], a[52:55], a[12:15], v[168:171]
    buffer_load_dwordx4 v228, s[4:7], s28 offen lds
    v_mfma_f32_16x16x32_bf16 v[172:175], a[56:59], a[12:15], v[172:175]
    ds_read_b128 a[80:83], v241 offset:8192
    v_mfma_f32_16x16x32_bf16 v[80:83], a[36:39], a[16:19], v[80:83]
    ds_read_b128 a[84:87], v241 offset:10240
    v_mfma_f32_16x16x32_bf16 v[84:87], a[40:43], a[16:19], v[84:87]
    ds_read_b128 a[88:91], v241 offset:12288
    v_mfma_f32_16x16x32_bf16 v[88:91], a[44:47], a[16:19], v[88:91]
    buffer_load_dwordx4 v229, s[4:7], s28 offen offset:1024 lds
    v_mfma_f32_16x16x32_bf16 v[92:95], a[48:51], a[16:19], v[92:95]
    ds_read_b128 a[92:95], v241 offset:14336
    v_mfma_f32_16x16x32_bf16 v[176:179], a[52:55], a[16:19], v[176:179]
    v_add_u32 v241, s37, v241
    v_mfma_f32_16x16x32_bf16 v[180:183], a[56:59], a[16:19], v[180:183]
    buffer_load_dwordx4 v230, s[4:7], s28 offen offset:2048 lds
    v_mfma_f32_16x16x32_bf16 v[96:99], a[36:39], a[20:23], v[96:99]
    v_add_u32 v240, s37, v240
    v_mfma_f32_16x16x32_bf16 v[100:103], a[40:43], a[20:23], v[100:103]
    v_add_u32 v244, s40, v244
    v_mfma_f32_16x16x32_bf16 v[104:107], a[44:47], a[20:23], v[104:107]
    v_add_u32 v245, s40, v245
    v_mfma_f32_16x16x32_bf16 v[108:111], a[48:51], a[20:23], v[108:111]
    buffer_load_dwordx4 v231, s[4:7], s28 offen offset:3072 lds
    v_mfma_f32_16x16x32_bf16 v[184:187], a[52:55], a[20:23], v[184:187]
    v_add_u32 v246, s40, v246
    v_mfma_f32_16x16x32_bf16 v[188:191], a[56:59], a[20:23], v[188:191]
    v_add_u32 v247, s40, v247
    v_mfma_f32_16x16x32_bf16 v[112:115], a[36:39], a[24:27], v[112:115]
    v_add_u32 v248, s40, v248
    v_mfma_f32_16x16x32_bf16 v[116:119], a[40:43], a[24:27], v[116:119]
    v_add_u32 v249, s40, v249
    v_mfma_f32_16x16x32_bf16 v[120:123], a[44:47], a[24:27], v[120:123]
    v_mfma_f32_16x16x32_bf16 v[124:127], a[48:51], a[24:27], v[124:127]
    v_mfma_f32_16x16x32_bf16 v[192:195], a[52:55], a[24:27], v[192:195]
    v_mfma_f32_16x16x32_bf16 v[196:199], a[56:59], a[24:27], v[196:199]
    v_mfma_f32_16x16x32_bf16 v[128:131], a[36:39], a[28:31], v[128:131]
    v_mfma_f32_16x16x32_bf16 v[132:135], a[40:43], a[28:31], v[132:135]
    v_mfma_f32_16x16x32_bf16 v[136:139], a[44:47], a[28:31], v[136:139]
    v_mfma_f32_16x16x32_bf16 v[140:143], a[48:51], a[28:31], v[140:143]
    v_mfma_f32_16x16x32_bf16 v[200:203], a[52:55], a[28:31], v[200:203]
    v_mfma_f32_16x16x32_bf16 v[204:207], a[56:59], a[28:31], v[204:207]
    s_waitcnt vmcnt(8) lgkmcnt(0)
    s_barrier
    v_mfma_f32_16x16x32_bf16 v[16:19], a[100:103], a[64:67], v[16:19]
    s_mov_b32 m0, s33
    v_mfma_f32_16x16x32_bf16 v[20:23], a[104:107], a[64:67], v[20:23]
    ds_read_b128 a[0:3], v240 offset:0
    v_mfma_f32_16x16x32_bf16 v[24:27], a[108:111], a[64:67], v[24:27]
    ds_read_b64_tr_b16 a[36:37], v244 offset:0
    v_mfma_f32_16x16x32_bf16 v[28:31], a[112:115], a[64:67], v[28:31]
    buffer_load_dwordx4 v233, s[8:11], s29 offen lds
    v_mfma_f32_16x16x32_bf16 v[144:147], a[116:119], a[64:67], v[144:147]
    ds_read_b64_tr_b16 a[38:39], v244 offset:512
    v_mfma_f32_16x16x32_bf16 v[148:151], a[120:123], a[64:67], v[148:151]
    ds_read_b64_tr_b16 a[40:41], v245 offset:0
    v_mfma_f32_16x16x32_bf16 v[32:35], a[100:103], a[68:71], v[32:35]
    ds_read_b64_tr_b16 a[42:43], v245 offset:512
    v_mfma_f32_16x16x32_bf16 v[36:39], a[104:107], a[68:71], v[36:39]
    buffer_load_dwordx4 v234, s[8:11], s29 offen offset:1024 lds
    v_mfma_f32_16x16x32_bf16 v[40:43], a[108:111], a[68:71], v[40:43]
    ds_read_b64_tr_b16 a[44:45], v246 offset:0
    v_mfma_f32_16x16x32_bf16 v[44:47], a[112:115], a[68:71], v[44:47]
    ds_read_b64_tr_b16 a[46:47], v246 offset:512
    v_mfma_f32_16x16x32_bf16 v[152:155], a[116:119], a[68:71], v[152:155]
    buffer_load_dwordx4 v235, s[8:11], s29 offen offset:2048 lds
    v_mfma_f32_16x16x32_bf16 v[156:159], a[120:123], a[68:71], v[156:159]
    ds_read_b64_tr_b16 a[48:49], v247 offset:0
    v_mfma_f32_16x16x32_bf16 v[48:51], a[100:103], a[72:75], v[48:51]
    ds_read_b64_tr_b16 a[50:51], v247 offset:512
    v_mfma_f32_16x16x32_bf16 v[52:55], a[104:107], a[72:75], v[52:55]
    ds_read_b64_tr_b16 a[52:53], v248 offset:0
    v_mfma_f32_16x16x32_bf16 v[56:59], a[108:111], a[72:75], v[56:59]
    buffer_load_dwordx4 v236, s[8:11], s29 offen offset:3072 lds
    v_mfma_f32_16x16x32_bf16 v[60:63], a[112:115], a[72:75], v[60:63]
    ds_read_b64_tr_b16 a[54:55], v248 offset:512
    v_mfma_f32_16x16x32_bf16 v[160:163], a[116:119], a[72:75], v[160:163]
    ds_read_b64_tr_b16 a[56:57], v249 offset:0
    v_mfma_f32_16x16x32_bf16 v[164:167], a[120:123], a[72:75], v[164:167]
    ds_read_b64_tr_b16 a[58:59], v249 offset:512
    v_mfma_f32_16x16x32_bf16 v[64:67], a[100:103], a[76:79], v[64:67]
    s_add_u32 m0, s33, 4096
    v_mfma_f32_16x16x32_bf16 v[68:71], a[104:107], a[76:79], v[68:71]
    ds_read_b128 a[4:7], v240 offset:2048
    v_mfma_f32_16x16x32_bf16 v[72:75], a[108:111], a[76:79], v[72:75]
    ds_read_b128 a[8:11], v240 offset:4096
    v_mfma_f32_16x16x32_bf16 v[76:79], a[112:115], a[76:79], v[76:79]
    buffer_load_dwordx4 v237, s[8:11], s29 offen lds
    v_mfma_f32_16x16x32_bf16 v[168:171], a[116:119], a[76:79], v[168:171]
    ds_read_b128 a[12:15], v240 offset:6144
    v_mfma_f32_16x16x32_bf16 v[172:175], a[120:123], a[76:79], v[172:175]
    ds_read_b128 a[16:19], v240 offset:8192
    v_mfma_f32_16x16x32_bf16 v[80:83], a[100:103], a[80:83], v[80:83]
    ds_read_b128 a[20:23], v240 offset:10240
    v_mfma_f32_16x16x32_bf16 v[84:87], a[104:107], a[80:83], v[84:87]
    buffer_load_dwordx4 v238, s[8:11], s29 offen offset:1024 lds
    v_mfma_f32_16x16x32_bf16 v[88:91], a[108:111], a[80:83], v[88:91]
    ds_read_b128 a[24:27], v240 offset:12288
    v_mfma_f32_16x16x32_bf16 v[92:95], a[112:115], a[80:83], v[92:95]
    ds_read_b128 a[28:31], v240 offset:14336
    v_mfma_f32_16x16x32_bf16 v[176:179], a[116:119], a[80:83], v[176:179]
    s_add_u32 s32, s32, s39
    v_mfma_f32_16x16x32_bf16 v[180:183], a[120:123], a[80:83], v[180:183]
    s_add_u32 s33, s33, s40
    v_mfma_f32_16x16x32_bf16 v[96:99], a[100:103], a[84:87], v[96:99]
    s_add_u32 s53, s53, 1
    v_mfma_f32_16x16x32_bf16 v[100:103], a[104:107], a[84:87], v[100:103]
    s_add_u32 s42, s53, s52
    v_mfma_f32_16x16x32_bf16 v[104:107], a[108:111], a[84:87], v[104:107]
    s_and_b32 s42, s42, 3
    v_mfma_f32_16x16x32_bf16 v[108:111], a[112:115], a[84:87], v[108:111]
    s_and_b32 s54, s53, -4
    v_mfma_f32_16x16x32_bf16 v[184:187], a[116:119], a[84:87], v[184:187]
    s_or_b32 s54, s54, s42
    v_mfma_f32_16x16x32_bf16 v[188:191], a[120:123], a[84:87], v[188:191]
    s_lshl_b32 s28, s54, 7
    v_mfma_f32_16x16x32_bf16 v[112:115], a[100:103], a[88:91], v[112:115]
    s_mul_i32 s29, s54, 458752
    v_mfma_f32_16x16x32_bf16 v[116:119], a[104:107], a[88:91], v[116:119]
    s_sub_u32 s40, 0, s40
    v_mfma_f32_16x16x32_bf16 v[120:123], a[108:111], a[88:91], v[120:123]
    s_mov_b32 s41, s37
    v_mfma_f32_16x16x32_bf16 v[124:127], a[112:115], a[88:91], v[124:127]
    s_mov_b32 s37, s38
    v_mfma_f32_16x16x32_bf16 v[192:195], a[116:119], a[88:91], v[192:195]
    s_mov_b32 s38, s39
    v_mfma_f32_16x16x32_bf16 v[196:199], a[120:123], a[88:91], v[196:199]
    s_mov_b32 s39, s41
    v_mfma_f32_16x16x32_bf16 v[128:131], a[100:103], a[92:95], v[128:131]
    s_add_u32 s36, s36, 1
    v_mfma_f32_16x16x32_bf16 v[132:135], a[104:107], a[92:95], v[132:135]
    v_mfma_f32_16x16x32_bf16 v[136:139], a[108:111], a[92:95], v[136:139]
    v_mfma_f32_16x16x32_bf16 v[140:143], a[112:115], a[92:95], v[140:143]
    v_mfma_f32_16x16x32_bf16 v[200:203], a[116:119], a[92:95], v[200:203]
    v_mfma_f32_16x16x32_bf16 v[204:207], a[120:123], a[92:95], v[204:207]
    s_waitcnt lgkmcnt(0)
    s_cmp_lt_u32 s36, 13
    s_cbranch_scc1 L_p1z_loop
    v_mfma_f32_16x16x32_bf16 v[16:19], a[36:39], a[0:3], v[16:19]
    ds_read_b128 a[64:67], v241 offset:0
    v_mfma_f32_16x16x32_bf16 v[20:23], a[40:43], a[0:3], v[20:23]
    ds_read_b64_tr_b16 a[100:101], v244 offset:4096
    v_mfma_f32_16x16x32_bf16 v[24:27], a[44:47], a[0:3], v[24:27]
    ds_read_b64_tr_b16 a[102:103], v244 offset:4608
    v_mfma_f32_16x16x32_bf16 v[28:31], a[48:51], a[0:3], v[28:31]
    ds_read_b64_tr_b16 a[104:105], v245 offset:4096
    v_mfma_f32_16x16x32_bf16 v[144:147], a[52:55], a[0:3], v[144:147]
    ds_read_b64_tr_b16 a[106:107], v245 offset:4608
    v_mfma_f32_16x16x32_bf16 v[148:151], a[56:59], a[0:3], v[148:151]
    ds_read_b64_tr_b16 a[108:109], v246 offset:4096
    v_mfma_f32_16x16x32_bf16 v[32:35], a[36:39], a[4:7], v[32:35]
    ds_read_b64_tr_b16 a[110:111], v246 offset:4608
    v_mfma_f32_16x16x32_bf16 v[36:39], a[40:43], a[4:7], v[36:39]
    ds_read_b64_tr_b16 a[112:113], v247 offset:4096
    v_mfma_f32_16x16x32_bf16 v[40:43], a[44:47], a[4:7], v[40:43]
    ds_read_b64_tr_b16 a[114:115], v247 offset:4608
    v_mfma_f32_16x16x32_bf16 v[44:47], a[48:51], a[4:7], v[44:47]
    ds_read_b64_tr_b16 a[116:117], v248 offset:4096
    v_mfma_f32_16x16x32_bf16 v[152:155], a[52:55], a[4:7], v[152:155]
    ds_read_b64_tr_b16 a[118:119], v248 offset:4608
    v_mfma_f32_16x16x32_bf16 v[156:159], a[56:59], a[4:7], v[156:159]
    ds_read_b64_tr_b16 a[120:121], v249 offset:4096
    v_mfma_f32_16x16x32_bf16 v[48:51], a[36:39], a[8:11], v[48:51]
    ds_read_b64_tr_b16 a[122:123], v249 offset:4608
    v_mfma_f32_16x16x32_bf16 v[52:55], a[40:43], a[8:11], v[52:55]
    ds_read_b128 a[68:71], v241 offset:2048
    v_mfma_f32_16x16x32_bf16 v[56:59], a[44:47], a[8:11], v[56:59]
    ds_read_b128 a[72:75], v241 offset:4096
    v_mfma_f32_16x16x32_bf16 v[60:63], a[48:51], a[8:11], v[60:63]
    ds_read_b128 a[76:79], v241 offset:6144
    v_mfma_f32_16x16x32_bf16 v[160:163], a[52:55], a[8:11], v[160:163]
    ds_read_b128 a[80:83], v241 offset:8192
    v_mfma_f32_16x16x32_bf16 v[164:167], a[56:59], a[8:11], v[164:167]
    ds_read_b128 a[84:87], v241 offset:10240
    v_mfma_f32_16x16x32_bf16 v[64:67], a[36:39], a[12:15], v[64:67]
    ds_read_b128 a[88:91], v241 offset:12288
    v_mfma_f32_16x16x32_bf16 v[68:71], a[40:43], a[12:15], v[68:71]
    ds_read_b128 a[92:95], v241 offset:14336
    v_mfma_f32_16x16x32_bf16 v[72:75], a[44:47], a[12:15], v[72:75]
    v_add_u32 v241, s37, v241
    v_mfma_f32_16x16x32_bf16 v[76:79], a[48:51], a[12:15], v[76:79]
    v_add_u32 v240, s37, v240
    v_mfma_f32_16x16x32_bf16 v[168:171], a[52:55], a[12:15], v[168:171]
    v_add_u32 v244, s40, v244
    v_mfma_f32_16x16x32_bf16 v[172:175], a[56:59], a[12:15], v[172:175]
    v_add_u32 v245, s40, v245
    v_mfma_f32_16x16x32_bf16 v[80:83], a[36:39], a[16:19], v[80:83]
    v_add_u32 v246, s40, v246
    v_mfma_f32_16x16x32_bf16 v[84:87], a[40:43], a[16:19], v[84:87]
    v_add_u32 v247, s40, v247
    v_mfma_f32_16x16x32_bf16 v[88:91], a[44:47], a[16:19], v[88:91]
    v_add_u32 v248, s40, v248
    v_mfma_f32_16x16x32_bf16 v[92:95], a[48:51], a[16:19], v[92:95]
    v_add_u32 v249, s40, v249
    v_mfma_f32_16x16x32_bf16 v[176:179], a[52:55], a[16:19], v[176:179]
    v_mfma_f32_16x16x32_bf16 v[180:183], a[56:59], a[16:19], v[180:183]
    v_mfma_f32_16x16x32_bf16 v[96:99], a[36:39], a[20:23], v[96:99]
    v_mfma_f32_16x16x32_bf16 v[100:103], a[40:43], a[20:23], v[100:103]
    v_mfma_f32_16x16x32_bf16 v[104:107], a[44:47], a[20:23], v[104:107]
    v_mfma_f32_16x16x32_bf16 v[108:111], a[48:51], a[20:23], v[108:111]
    v_mfma_f32_16x16x32_bf16 v[184:187], a[52:55], a[20:23], v[184:187]
    v_mfma_f32_16x16x32_bf16 v[188:191], a[56:59], a[20:23], v[188:191]
    v_mfma_f32_16x16x32_bf16 v[112:115], a[36:39], a[24:27], v[112:115]
    v_mfma_f32_16x16x32_bf16 v[116:119], a[40:43], a[24:27], v[116:119]
    v_mfma_f32_16x16x32_bf16 v[120:123], a[44:47], a[24:27], v[120:123]
    v_mfma_f32_16x16x32_bf16 v[124:127], a[48:51], a[24:27], v[124:127]
    v_mfma_f32_16x16x32_bf16 v[192:195], a[52:55], a[24:27], v[192:195]
    v_mfma_f32_16x16x32_bf16 v[196:199], a[56:59], a[24:27], v[196:199]
    v_mfma_f32_16x16x32_bf16 v[128:131], a[36:39], a[28:31], v[128:131]
    v_mfma_f32_16x16x32_bf16 v[132:135], a[40:43], a[28:31], v[132:135]
    v_mfma_f32_16x16x32_bf16 v[136:139], a[44:47], a[28:31], v[136:139]
    v_mfma_f32_16x16x32_bf16 v[140:143], a[48:51], a[28:31], v[140:143]
    v_mfma_f32_16x16x32_bf16 v[200:203], a[52:55], a[28:31], v[200:203]
    v_mfma_f32_16x16x32_bf16 v[204:207], a[56:59], a[28:31], v[204:207]
    s_waitcnt vmcnt(0) lgkmcnt(0)
    s_barrier
    v_mfma_f32_16x16x32_bf16 v[16:19], a[100:103], a[64:67], v[16:19]
    ds_read_b128 a[0:3], v240 offset:0
    v_mfma_f32_16x16x32_bf16 v[20:23], a[104:107], a[64:67], v[20:23]
    ds_read_b64_tr_b16 a[36:37], v244 offset:0
    v_mfma_f32_16x16x32_bf16 v[24:27], a[108:111], a[64:67], v[24:27]
    ds_read_b64_tr_b16 a[38:39], v244 offset:512
    v_mfma_f32_16x16x32_bf16 v[28:31], a[112:115], a[64:67], v[28:31]
    ds_read_b64_tr_b16 a[40:41], v245 offset:0
    v_mfma_f32_16x16x32_bf16 v[144:147], a[116:119], a[64:67], v[144:147]
    ds_read_b64_tr_b16 a[42:43], v245 offset:512
    v_mfma_f32_16x16x32_bf16 v[148:151], a[120:123], a[64:67], v[148:151]
    ds_read_b64_tr_b16 a[44:45], v246 offset:0
    v_mfma_f32_16x16x32_bf16 v[32:35], a[100:103], a[68:71], v[32:35]
    ds_read_b64_tr_b16 a[46:47], v246 offset:512
    v_mfma_f32_16x16x32_bf16 v[36:39], a[104:107], a[68:71], v[36:39]
    ds_read_b64_tr_b16 a[48:49], v247 offset:0
    v_mfma_f32_16x16x32_bf16 v[40:43], a[108:111], a[68:71], v[40:43]
    ds_read_b64_tr_b16 a[50:51], v247 offset:512
    v_mfma_f32_16x16x32_bf16 v[44:47], a[112:115], a[68:71], v[44:47]
    ds_read_b64_tr_b16 a[52:53], v248 offset:0
    v_mfma_f32_16x16x32_bf16 v[152:155], a[116:119], a[68:71], v[152:155]
    ds_read_b64_tr_b16 a[54:55], v248 offset:512
    v_mfma_f32_16x16x32_bf16 v[156:159], a[120:123], a[68:71], v[156:159]
    ds_read_b64_tr_b16 a[56:57], v249 offset:0
    v_mfma_f32_16x16x32_bf16 v[48:51], a[100:103], a[72:75], v[48:51]
    ds_read_b64_tr_b16 a[58:59], v249 offset:512
    v_mfma_f32_16x16x32_bf16 v[52:55], a[104:107], a[72:75], v[52:55]
    ds_read_b128 a[4:7], v240 offset:2048
    v_mfma_f32_16x16x32_bf16 v[56:59], a[108:111], a[72:75], v[56:59]
    ds_read_b128 a[8:11], v240 offset:4096
    v_mfma_f32_16x16x32_bf16 v[60:63], a[112:115], a[72:75], v[60:63]
    ds_read_b128 a[12:15], v240 offset:6144
    v_mfma_f32_16x16x32_bf16 v[160:163], a[116:119], a[72:75], v[160:163]
    ds_read_b128 a[16:19], v240 offset:8192
    v_mfma_f32_16x16x32_bf16 v[164:167], a[120:123], a[72:75], v[164:167]
    ds_read_b128 a[20:23], v240 offset:10240
    v_mfma_f32_16x16x32_bf16 v[64:67], a[100:103], a[76:79], v[64:67]
    ds_read_b128 a[24:27], v240 offset:12288
    v_mfma_f32_16x16x32_bf16 v[68:71], a[104:107], a[76:79], v[68:71]
    ds_read_b128 a[28:31], v240 offset:14336
    v_mfma_f32_16x16x32_bf16 v[72:75], a[108:111], a[76:79], v[72:75]
    s_sub_u32 s40, 0, s40
    v_mfma_f32_16x16x32_bf16 v[76:79], a[112:115], a[76:79], v[76:79]
    s_mov_b32 s41, s37
    v_mfma_f32_16x16x32_bf16 v[168:171], a[116:119], a[76:79], v[168:171]
    s_mov_b32 s37, s38
    v_mfma_f32_16x16x32_bf16 v[172:175], a[120:123], a[76:79], v[172:175]
    s_mov_b32 s38, s39
    v_mfma_f32_16x16x32_bf16 v[80:83], a[100:103], a[80:83], v[80:83]
    s_mov_b32 s39, s41
    v_mfma_f32_16x16x32_bf16 v[84:87], a[104:107], a[80:83], v[84:87]
    v_mov_b32 v226, 0
    v_mfma_f32_16x16x32_bf16 v[88:91], a[108:111], a[80:83], v[88:91]
    buffer_load_dword v251, v226, s[20:23], 0 offen sc1
    v_mfma_f32_16x16x32_bf16 v[92:95], a[112:115], a[80:83], v[92:95]
    v_mfma_f32_16x16x32_bf16 v[176:179], a[116:119], a[80:83], v[176:179]
    v_mfma_f32_16x16x32_bf16 v[180:183], a[120:123], a[80:83], v[180:183]
    v_mfma_f32_16x16x32_bf16 v[96:99], a[100:103], a[84:87], v[96:99]
    v_mfma_f32_16x16x32_bf16 v[100:103], a[104:107], a[84:87], v[100:103]
    v_mfma_f32_16x16x32_bf16 v[104:107], a[108:111], a[84:87], v[104:107]
    v_mfma_f32_16x16x32_bf16 v[108:111], a[112:115], a[84:87], v[108:111]
    v_mfma_f32_16x16x32_bf16 v[184:187], a[116:119], a[84:87], v[184:187]
    v_mfma_f32_16x16x32_bf16 v[188:191], a[120:123], a[84:87], v[188:191]
    v_mfma_f32_16x16x32_bf16 v[112:115], a[100:103], a[88:91], v[112:115]
    v_mfma_f32_16x16x32_bf16 v[116:119], a[104:107], a[88:91], v[116:119]
    v_mfma_f32_16x16x32_bf16 v[120:123], a[108:111], a[88:91], v[120:123]
    v_mfma_f32_16x16x32_bf16 v[124:127], a[112:115], a[88:91], v[124:127]
    v_mfma_f32_16x16x32_bf16 v[192:195], a[116:119], a[88:91], v[192:195]
    v_mfma_f32_16x16x32_bf16 v[196:199], a[120:123], a[88:91], v[196:199]
    v_mfma_f32_16x16x32_bf16 v[128:131], a[100:103], a[92:95], v[128:131]
    v_mfma_f32_16x16x32_bf16 v[132:135], a[104:107], a[92:95], v[132:135]
    v_mfma_f32_16x16x32_bf16 v[136:139], a[108:111], a[92:95], v[136:139]
    v_mfma_f32_16x16x32_bf16 v[140:143], a[112:115], a[92:95], v[140:143]
    v_mfma_f32_16x16x32_bf16 v[200:203], a[116:119], a[92:95], v[200:203]
    v_mfma_f32_16x16x32_bf16 v[204:207], a[120:123], a[92:95], v[204:207]
    s_waitcnt lgkmcnt(0)
    v_mfma_f32_16x16x32_bf16 v[16:19], a[36:39], a[0:3], v[16:19]
    ds_read_b128 a[64:67], v241 offset:0
    v_mfma_f32_16x16x32_bf16 v[20:23], a[40:43], a[0:3], v[20:23]
    ds_read_b64_tr_b16 a[100:101], v244 offset:4096
    v_mfma_f32_16x16x32_bf16 v[24:27], a[44:47], a[0:3], v[24:27]
    ds_read_b64_tr_b16 a[102:103], v244 offset:4608
    v_mfma_f32_16x16x32_bf16 v[28:31], a[48:51], a[0:3], v[28:31]
    ds_read_b64_tr_b16 a[104:105], v245 offset:4096
    v_mfma_f32_16x16x32_bf16 v[144:147], a[52:55], a[0:3], v[144:147]
    ds_read_b64_tr_b16 a[106:107], v245 offset:4608
    v_mfma_f32_16x16x32_bf16 v[148:151], a[56:59], a[0:3], v[148:151]
    ds_read_b64_tr_b16 a[108:109], v246 offset:4096
    v_mfma_f32_16x16x32_bf16 v[32:35], a[36:39], a[4:7], v[32:35]
    ds_read_b64_tr_b16 a[110:111], v246 offset:4608
    v_mfma_f32_16x16x32_bf16 v[36:39], a[40:43], a[4:7], v[36:39]
    ds_read_b64_tr_b16 a[112:113], v247 offset:4096
    v_mfma_f32_16x16x32_bf16 v[40:43], a[44:47], a[4:7], v[40:43]
    ds_read_b64_tr_b16 a[114:115], v247 offset:4608
    v_mfma_f32_16x16x32_bf16 v[44:47], a[48:51], a[4:7], v[44:47]
    ds_read_b64_tr_b16 a[116:117], v248 offset:4096
    v_mfma_f32_16x16x32_bf16 v[152:155], a[52:55], a[4:7], v[152:155]
    ds_read_b64_tr_b16 a[118:119], v248 offset:4608
    v_mfma_f32_16x16x32_bf16 v[156:159], a[56:59], a[4:7], v[156:159]
    ds_read_b64_tr_b16 a[120:121], v249 offset:4096
    v_mfma_f32_16x16x32_bf16 v[48:51], a[36:39], a[8:11], v[48:51]
    ds_read_b64_tr_b16 a[122:123], v249 offset:4608
    v_mfma_f32_16x16x32_bf16 v[52:55], a[40:43], a[8:11], v[52:55]
    ds_read_b128 a[68:71], v241 offset:2048
    v_mfma_f32_16x16x32_bf16 v[56:59], a[44:47], a[8:11], v[56:59]
    ds_read_b128 a[72:75], v241 offset:4096
    v_mfma_f32_16x16x32_bf16 v[60:63], a[48:51], a[8:11], v[60:63]
    ds_read_b128 a[76:79], v241 offset:6144
    v_mfma_f32_16x16x32_bf16 v[160:163], a[52:55], a[8:11], v[160:163]
    ds_read_b128 a[80:83], v241 offset:8192
    v_mfma_f32_16x16x32_bf16 v[164:167], a[56:59], a[8:11], v[164:167]
    ds_read_b128 a[84:87], v241 offset:10240
    v_mfma_f32_16x16x32_bf16 v[64:67], a[36:39], a[12:15], v[64:67]
    ds_read_b128 a[88:91], v241 offset:12288
    v_mfma_f32_16x16x32_bf16 v[68:71], a[40:43], a[12:15], v[68:71]
    ds_read_b128 a[92:95], v241 offset:14336
    v_mfma_f32_16x16x32_bf16 v[72:75], a[44:47], a[12:15], v[72:75]
    v_mfma_f32_16x16x32_bf16 v[76:79], a[48:51], a[12:15], v[76:79]
    v_mfma_f32_16x16x32_bf16 v[168:171], a[52:55], a[12:15], v[168:171]
    v_mfma_f32_16x16x32_bf16 v[172:175], a[56:59], a[12:15], v[172:175]
    v_mfma_f32_16x16x32_bf16 v[80:83], a[36:39], a[16:19], v[80:83]
    v_mfma_f32_16x16x32_bf16 v[84:87], a[40:43], a[16:19], v[84:87]
    v_mfma_f32_16x16x32_bf16 v[88:91], a[44:47], a[16:19], v[88:91]
    v_mfma_f32_16x16x32_bf16 v[92:95], a[48:51], a[16:19], v[92:95]
    v_mfma_f32_16x16x32_bf16 v[176:179], a[52:55], a[16:19], v[176:179]
    v_mfma_f32_16x16x32_bf16 v[180:183], a[56:59], a[16:19], v[180:183]
    v_mfma_f32_16x16x32_bf16 v[96:99], a[36:39], a[20:23], v[96:99]
    v_mfma_f32_16x16x32_bf16 v[100:103], a[40:43], a[20:23], v[100:103]
    v_mfma_f32_16x16x32_bf16 v[104:107], a[44:47], a[20:23], v[104:107]
    v_mfma_f32_16x16x32_bf16 v[108:111], a[48:51], a[20:23], v[108:111]
    v_mfma_f32_16x16x32_bf16 v[184:187], a[52:55], a[20:23], v[184:187]
    v_mfma_f32_16x16x32_bf16 v[188:191], a[56:59], a[20:23], v[188:191]
    v_mfma_f32_16x16x32_bf16 v[112:115], a[36:39], a[24:27], v[112:115]
    v_mfma_f32_16x16x32_bf16 v[116:119], a[40:43], a[24:27], v[116:119]
    v_mfma_f32_16x16x32_bf16 v[120:123], a[44:47], a[24:27], v[120:123]
    v_mfma_f32_16x16x32_bf16 v[124:127], a[48:51], a[24:27], v[124:127]
    v_mfma_f32_16x16x32_bf16 v[192:195], a[52:55], a[24:27], v[192:195]
    v_mfma_f32_16x16x32_bf16 v[196:199], a[56:59], a[24:27], v[196:199]
    v_mfma_f32_16x16x32_bf16 v[128:131], a[36:39], a[28:31], v[128:131]
    v_mfma_f32_16x16x32_bf16 v[132:135], a[40:43], a[28:31], v[132:135]
    v_mfma_f32_16x16x32_bf16 v[136:139], a[44:47], a[28:31], v[136:139]
    v_mfma_f32_16x16x32_bf16 v[140:143], a[48:51], a[28:31], v[140:143]
    v_mfma_f32_16x16x32_bf16 v[200:203], a[52:55], a[28:31], v[200:203]
    v_mfma_f32_16x16x32_bf16 v[204:207], a[56:59], a[28:31], v[204:207]
    s_waitcnt lgkmcnt(0)
    v_mfma_f32_16x16x32_bf16 v[16:19], a[100:103], a[64:67], v[16:19]
    v_mfma_f32_16x16x32_bf16 v[20:23], a[104:107], a[64:67], v[20:23]
    v_mfma_f32_16x16x32_bf16 v[24:27], a[108:111], a[64:67], v[24:27]
    v_mfma_f32_16x16x32_bf16 v[28:31], a[112:115], a[64:67], v[28:31]
    v_mfma_f32_16x16x32_bf16 v[144:147], a[116:119], a[64:67], v[144:147]
    v_mfma_f32_16x16x32_bf16 v[148:151], a[120:123], a[64:67], v[148:151]
    v_mfma_f32_16x16x32_bf16 v[32:35], a[100:103], a[68:71], v[32:35]
    v_mfma_f32_16x16x32_bf16 v[36:39], a[104:107], a[68:71], v[36:39]
    v_mfma_f32_16x16x32_bf16 v[40:43], a[108:111], a[68:71], v[40:43]
    v_mfma_f32_16x16x32_bf16 v[44:47], a[112:115], a[68:71], v[44:47]
    v_mfma_f32_16x16x32_bf16 v[152:155], a[116:119], a[68:71], v[152:155]
    v_mfma_f32_16x16x32_bf16 v[156:159], a[120:123], a[68:71], v[156:159]
    v_mfma_f32_16x16x32_bf16 v[48:51], a[100:103], a[72:75], v[48:51]
    v_mfma_f32_16x16x32_bf16 v[52:55], a[104:107], a[72:75], v[52:55]
    v_mfma_f32_16x16x32_bf16 v[56:59], a[108:111], a[72:75], v[56:59]
    v_mfma_f32_16x16x32_bf16 v[60:63], a[112:115], a[72:75], v[60:63]
    v_mfma_f32_16x16x32_bf16 v[160:163], a[116:119], a[72:75], v[160:163]
    v_mfma_f32_16x16x32_bf16 v[164:167], a[120:123], a[72:75], v[164:167]
    v_mfma_f32_16x16x32_bf16 v[64:67], a[100:103], a[76:79], v[64:67]
    v_mfma_f32_16x16x32_bf16 v[68:71], a[104:107], a[76:79], v[68:71]
    v_mfma_f32_16x16x32_bf16 v[72:75], a[108:111], a[76:79], v[72:75]
    v_mfma_f32_16x16x32_bf16 v[76:79], a[112:115], a[76:79], v[76:79]
    v_mfma_f32_16x16x32_bf16 v[168:171], a[116:119], a[76:79], v[168:171]
    v_mfma_f32_16x16x32_bf16 v[172:175], a[120:123], a[76:79], v[172:175]
    v_mfma_f32_16x16x32_bf16 v[80:83], a[100:103], a[80:83], v[80:83]
    v_mfma_f32_16x16x32_bf16 v[84:87], a[104:107], a[80:83], v[84:87]
    v_mfma_f32_16x16x32_bf16 v[88:91], a[108:111], a[80:83], v[88:91]
    v_mfma_f32_16x16x32_bf16 v[92:95], a[112:115], a[80:83], v[92:95]
    v_mfma_f32_16x16x32_bf16 v[176:179], a[116:119], a[80:83], v[176:179]
    v_mfma_f32_16x16x32_bf16 v[180:183], a[120:123], a[80:83], v[180:183]
    v_mfma_f32_16x16x32_bf16 v[96:99], a[100:103], a[84:87], v[96:99]
    v_mfma_f32_16x16x32_bf16 v[100:103], a[104:107], a[84:87], v[100:103]
    v_mfma_f32_16x16x32_bf16 v[104:107], a[108:111], a[84:87], v[104:107]
    v_mfma_f32_16x16x32_bf16 v[108:111], a[112:115], a[84:87], v[108:111]
    v_mfma_f32_16x16x32_bf16 v[184:187], a[116:119], a[84:87], v[184:187]
    v_mfma_f32_16x16x32_bf16 v[188:191], a[120:123], a[84:87], v[188:191]
    v_mfma_f32_16x16x32_bf16 v[112:115], a[100:103], a[88:91], v[112:115]
    v_mfma_f32_16x16x32_bf16 v[116:119], a[104:107], a[88:91], v[116:119]
    v_mfma_f32_16x16x32_bf16 v[120:123], a[108:111], a[88:91], v[120:123]
    v_mfma_f32_16x16x32_bf16 v[124:127], a[112:115], a[88:91], v[124:127]
    v_mfma_f32_16x16x32_bf16 v[192:195], a[116:119], a[88:91], v[192:195]
    v_mfma_f32_16x16x32_bf16 v[196:199], a[120:123], a[88:91], v[196:199]
    v_mfma_f32_16x16x32_bf16 v[128:131], a[100:103], a[92:95], v[128:131]
    v_mfma_f32_16x16x32_bf16 v[132:135], a[104:107], a[92:95], v[132:135]
    v_mfma_f32_16x16x32_bf16 v[136:139], a[108:111], a[92:95], v[136:139]
    v_mfma_f32_16x16x32_bf16 v[140:143], a[112:115], a[92:95], v[140:143]
    v_mfma_f32_16x16x32_bf16 v[200:203], a[116:119], a[92:95], v[200:203]
    v_mfma_f32_16x16x32_bf16 v[204:207], a[120:123], a[92:95], v[204:207]
    v_mov_b32 v226, 0xbdd2d3e8
    v_mov_b32 v227, 0xc0135761
    v_pk_mul_f32 v[228:229], v[16:17], v[16:17]
    v_pk_mul_f32 v[230:231], v[18:19], v[18:19]
    v_pk_mul_f32 v[232:233], v[20:21], v[20:21]
    v_pk_mul_f32 v[234:235], v[22:23], v[22:23]
    v_pk_mul_f32 v[236:237], v[24:25], v[24:25]
    v_pk_mul_f32 v[238:239], v[26:27], v[26:27]
    v_pk_mul_f32 v[240:241], v[28:29], v[28:29]
    v_pk_mul_f32 v[242:243], v[30:31], v[30:31]
    v_pk_fma_f32 v[228:229], v[228:229], v[226:227], v[226:227] op_sel:[0,0,1] op_sel_hi:[1,0,1]
    v_pk_fma_f32 v[230:231], v[230:231], v[226:227], v[226:227] op_sel:[0,0,1] op_sel_hi:[1,0,1]
    v_pk_fma_f32 v[232:233], v[232:233], v[226:227], v[226:227] op_sel:[0,0,1] op_sel_hi:[1,0,1]
    v_pk_fma_f32 v[234:235], v[234:235], v[226:227], v[226:227] op_sel:[0,0,1] op_sel_hi:[1,0,1]
    v_pk_fma_f32 v[236:237], v[236:237], v[226:227], v[226:227] op_sel:[0,0,1] op_sel_hi:[1,0,1]
    v_pk_fma_f32 v[238:239], v[238:239], v[226:227], v[226:227] op_sel:[0,0,1] op_sel_hi:[1,0,1]
    v_pk_fma_f32 v[240:241], v[240:241], v[226:227], v[226:227] op_sel:[0,0,1] op_sel_hi:[1,0,1]
    v_pk_fma_f32 v[242:243], v[242:243], v[226:227], v[226:227] op_sel:[0,0,1] op_sel_hi:[1,0,1]
    v_pk_mul_f32 v[228:229], v[228:229], v[16:17]
    v_pk_mul_f32 v[230:231], v[230:231], v[18:19]
    v_pk_mul_f32 v[232:233], v[232:233], v[20:21]
    v_pk_mul_f32 v[234:235], v[234:235], v[22:23]
    v_pk_mul_f32 v[236:237], v[236:237], v[24:25]
    v_pk_mul_f32 v[238:239], v[238:239], v[26:27]
    v_pk_mul_f32 v[240:241], v[240:241], v[28:29]
    v_pk_mul_f32 v[242:243], v[242:243], v[30:31]
    v_exp_f32 v228, v228
    v_exp_f32 v229, v229
    v_exp_f32 v230, v230
    v_exp_f32 v231, v231
    v_exp_f32 v232, v232
    v_exp_f32 v233, v233
    v_exp_f32 v234, v234
    v_exp_f32 v235, v235
    v_exp_f32 v236, v236
    v_exp_f32 v237, v237
    v_exp_f32 v238, v238
    v_exp_f32 v239, v239
    v_exp_f32 v240, v240
    v_exp_f32 v241, v241
    v_exp_f32 v242, v242
    v_exp_f32 v243, v243
    v_pk_add_f32 v[228:229], v[228:229], 1.0 op_sel_hi:[1,0]
    v_pk_add_f32 v[230:231], v[230:231], 1.0 op_sel_hi:[1,0]
    v_pk_add_f32 v[232:233], v[232:233], 1.0 op_sel_hi:[1,0]
    v_pk_add_f32 v[234:235], v[234:235], 1.0 op_sel_hi:[1,0]
    v_pk_add_f32 v[236:237], v[236:237], 1.0 op_sel_hi:[1,0]
    v_pk_add_f32 v[238:239], v[238:239], 1.0 op_sel_hi:[1,0]
    v_pk_add_f32 v[240:241], v[240:241], 1.0 op_sel_hi:[1,0]
    v_pk_add_f32 v[242:243], v[242:243], 1.0 op_sel_hi:[1,0]
    v_rcp_f32 v228, v228
    v_pk_mul_f32 v[0:1], v[32:33], v[32:33]
    v_pk_mul_f32 v[2:3], v[34:35], v[34:35]
    v_rcp_f32 v229, v229
    v_pk_mul_f32 v[4:5], v[36:37], v[36:37]
    v_rcp_f32 v230, v230
    v_pk_mul_f32 v[6:7], v[38:39], v[38:39]
    v_pk_mul_f32 v[8:9], v[40:41], v[40:41]
    v_rcp_f32 v231, v231
    v_pk_mul_f32 v[10:11], v[42:43], v[42:43]
    v_rcp_f32 v232, v232
    v_pk_mul_f32 v[12:13], v[44:45], v[44:45]
    v_pk_mul_f32 v[14:15], v[46:47], v[46:47]
    v_rcp_f32 v233, v233
    v_pk_fma_f32 v[0:1], v[0:1], v[226:227], v[226:227] op_sel:[0,0,1] op_sel_hi:[1,0,1]
    v_rcp_f32 v234, v234
    v_pk_fma_f32 v[2:3], v[2:3], v[226:227], v[226:227] op_sel:[0,0,1] op_sel_hi:[1,0,1]
    v_pk_fma_f32 v[4:5], v[4:5], v[226:227], v[226:227] op_sel:[0,0,1] op_sel_hi:[1,0,1]
    v_rcp_f32 v235, v235
    v_pk_fma_f32 v[6:7], v[6:7], v[226:227], v[226:227] op_sel:[0,0,1] op_sel_hi:[1,0,1]
    v_rcp_f32 v236, v236
    v_pk_fma_f32 v[8:9], v[8:9], v[226:227], v[226:227] op_sel:[0,0,1] op_sel_hi:[1,0,1]
    v_pk_fma_f32 v[10:11], v[10:11], v[226:227], v[226:227] op_sel:[0,0,1] op_sel_hi:[1,0,1]
    v_rcp_f32 v237, v237
    v_pk_fma_f32 v[12:13], v[12:13], v[226:227], v[226:227] op_sel:[0,0,1] op_sel_hi:[1,0,1]
    v_rcp_f32 v238, v238
    v_pk_fma_f32 v[14:15], v[14:15], v[226:227], v[226:227] op_sel:[0,0,1] op_sel_hi:[1,0,1]
    v_pk_mul_f32 v[0:1], v[0:1], v[32:33]
    v_rcp_f32 v239, v239
    v_pk_mul_f32 v[2:3], v[2:3], v[34:35]
    v_rcp_f32 v240, v240
    v_pk_mul_f32 v[4:5], v[4:5], v[36:37]
    v_pk_mul_f32 v[6:7], v[6:7], v[38:39]
    v_rcp_f32 v241, v241
    v_pk_mul_f32 v[8:9], v[8:9], v[40:41]
    v_rcp_f32 v242, v242
    v_pk_mul_f32 v[10:11], v[10:11], v[42:43]
    v_pk_mul_f32 v[12:13], v[12:13], v[44:45]
    v_rcp_f32 v243, v243
    v_pk_mul_f32 v[14:15], v[14:15], v[46:47]
    v_exp_f32 v0, v0
    v_pk_mul_f32 v[16:17], v[16:17], v[228:229]
    v_pk_mul_f32 v[18:19], v[18:19], v[230:231]
    v_exp_f32 v1, v1
    v_pk_mul_f32 v[20:21], v[20:21], v[232:233]
    v_pk_mul_f32 v[22:23], v[22:23], v[234:235]
    v_exp_f32 v2, v2
    v_pk_mul_f32 v[24:25], v[24:25], v[236:237]
    v_exp_f32 v3, v3
    v_pk_mul_f32 v[26:27], v[26:27], v[238:239]
    v_pk_mul_f32 v[28:29], v[28:29], v[240:241]
    v_exp_f32 v4, v4
    v_pk_mul_f32 v[30:31], v[30:31], v[242:243]
    v_exp_f32 v5, v5
    v_pk_add_f32 v[244:245], v[16:17], v[18:19]
    v_pk_mul_f32 v[246:247], v[16:17], v[16:17]
    v_exp_f32 v6, v6
    v_pk_fma_f32 v[246:247], v[18:19], v[18:19], v[246:247]
    v_exp_f32 v7, v7
    v_pk_add_f32 v[244:245], v[244:245], v[20:21]
    v_pk_fma_f32 v[246:247], v[20:21], v[20:21], v[246:247]
    v_exp_f32 v8, v8
    v_pk_add_f32 v[244:245], v[244:245], v[22:23]
    v_pk_fma_f32 v[246:247], v[22:23], v[22:23], v[246:247]
    v_exp_f32 v9, v9
    v_pk_add_f32 v[244:245], v[244:245], v[24:25]
    v_exp_f32 v10, v10
    v_pk_fma_f32 v[246:247], v[24:25], v[24:25], v[246:247]
    v_pk_add_f32 v[244:245], v[244:245], v[26:27]
    v_exp_f32 v11, v11
    v_pk_fma_f32 v[246:247], v[26:27], v[26:27], v[246:247]
    v_exp_f32 v12, v12
    v_pk_add_f32 v[244:245], v[244:245], v[28:29]
    v_pk_fma_f32 v[246:247], v[28:29], v[28:29], v[246:247]
    v_exp_f32 v13, v13
    v_pk_add_f32 v[244:245], v[244:245], v[30:31]
    v_exp_f32 v14, v14
    v_pk_fma_f32 v[246:247], v[30:31], v[30:31], v[246:247]
    v_add_f32 v208, v244, v245
    v_exp_f32 v15, v15
    v_add_f32 v216, v246, v247
    v_pk_add_f32 v[0:1], v[0:1], 1.0 op_sel_hi:[1,0]
    v_pk_add_f32 v[2:3], v[2:3], 1.0 op_sel_hi:[1,0]
    v_pk_add_f32 v[4:5], v[4:5], 1.0 op_sel_hi:[1,0]
    v_pk_add_f32 v[6:7], v[6:7], 1.0 op_sel_hi:[1,0]
    v_pk_add_f32 v[8:9], v[8:9], 1.0 op_sel_hi:[1,0]
    v_pk_add_f32 v[10:11], v[10:11], 1.0 op_sel_hi:[1,0]
    v_pk_add_f32 v[12:13], v[12:13], 1.0 op_sel_hi:[1,0]
    v_pk_add_f32 v[14:15], v[14:15], 1.0 op_sel_hi:[1,0]
    v_rcp_f32 v0, v0
    v_pk_mul_f32 v[228:229], v[48:49], v[48:49]
    v_pk_mul_f32 v[230:231], v[50:51], v[50:51]
    v_rcp_f32 v1, v1
    v_pk_mul_f32 v[232:233], v[52:53], v[52:53]
    v_rcp_f32 v2, v2
    v_pk_mul_f32 v[234:235], v[54:55], v[54:55]
    v_pk_mul_f32 v[236:237], v[56:57], v[56:57]
    v_rcp_f32 v3, v3
    v_pk_mul_f32 v[238:239], v[58:59], v[58:59]
    v_rcp_f32 v4, v4
    v_pk_mul_f32 v[240:241], v[60:61], v[60:61]
    v_pk_mul_f32 v[242:243], v[62:63], v[62:63]
    v_rcp_f32 v5, v5
    v_pk_fma_f32 v[228:229], v[228:229], v[226:227], v[226:227] op_sel:[0,0,1] op_sel_hi:[1,0,1]
    v_rcp_f32 v6, v6
    v_pk_fma_f32 v[230:231], v[230:231], v[226:227], v[226:227] op_sel:[0,0,1] op_sel_hi:[1,0,1]
    v_pk_fma_f32 v[232:233], v[232:233], v[226:227], v[226:227] op_sel:[0,0,1] op_sel_hi:[1,0,1]
    v_rcp_f32 v7, v7
    v_pk_fma_f32 v[234:235], v[234:235], v[226:227], v[226:227] op_sel:[0,0,1] op_sel_hi:[1,0,1]
    v_rcp_f32 v8, v8
    v_pk_fma_f32 v[236:237], v[236:237], v[226:227], v[226:227] op_sel:[0,0,1] op_sel_hi:[1,0,1]
    v_pk_fma_f32 v[238:239], v[238:239], v[226:227], v[226:227] op_sel:[0,0,1] op_sel_hi:[1,0,1]
    v_rcp_f32 v9, v9
    v_pk_fma_f32 v[240:241], v[240:241], v[226:227], v[226:227] op_sel:[0,0,1] op_sel_hi:[1,0,1]
    v_rcp_f32 v10, v10
    v_pk_fma_f32 v[242:243], v[242:243], v[226:227], v[226:227] op_sel:[0,0,1] op_sel_hi:[1,0,1]
    v_pk_mul_f32 v[228:229], v[228:229], v[48:49]
    v_rcp_f32 v11, v11
    v_pk_mul_f32 v[230:231], v[230:231], v[50:51]
    v_rcp_f32 v12, v12
    v_pk_mul_f32 v[232:233], v[232:233], v[52:53]
    v_pk_mul_f32 v[234:235], v[234:235], v[54:55]
    v_rcp_f32 v13, v13
    v_pk_mul_f32 v[236:237], v[236:237], v[56:57]
    v_rcp_f32 v14, v14
    v_pk_mul_f32 v[238:239], v[238:239], v[58:59]
    v_pk_mul_f32 v[240:241], v[240:241], v[60:61]
    v_rcp_f32 v15, v15
    v_pk_mul_f32 v[242:243], v[242:243], v[62:63]
    v_exp_f32 v228, v228
    v_pk_mul_f32 v[32:33], v[32:33], v[0:1]
    v_pk_mul_f32 v[34:35], v[34:35], v[2:3]
    v_exp_f32 v229, v229
    v_pk_mul_f32 v[36:37], v[36:37], v[4:5]
    v_pk_mul_f32 v[38:39], v[38:39], v[6:7]
    v_exp_f32 v230, v230
    v_pk_mul_f32 v[40:41], v[40:41], v[8:9]
    v_exp_f32 v231, v231
    v_pk_mul_f32 v[42:43], v[42:43], v[10:11]
    v_pk_mul_f32 v[44:45], v[44:45], v[12:13]
    v_exp_f32 v232, v232
    v_pk_mul_f32 v[46:47], v[46:47], v[14:15]
    v_exp_f32 v233, v233
    v_pk_add_f32 v[244:245], v[32:33], v[34:35]
    v_pk_mul_f32 v[246:247], v[32:33], v[32:33]
    v_exp_f32 v234, v234
    v_pk_fma_f32 v[246:247], v[34:35], v[34:35], v[246:247]
    v_exp_f32 v235, v235
    v_pk_add_f32 v[244:245], v[244:245], v[36:37]
    v_pk_fma_f32 v[246:247], v[36:37], v[36:37], v[246:247]
    v_exp_f32 v236, v236
    v_pk_add_f32 v[244:245], v[244:245], v[38:39]
    v_pk_fma_f32 v[246:247], v[38:39], v[38:39], v[246:247]
    v_exp_f32 v237, v237
    v_pk_add_f32 v[244:245], v[244:245], v[40:41]
    v_exp_f32 v238, v238
    v_pk_fma_f32 v[246:247], v[40:41], v[40:41], v[246:247]
    v_pk_add_f32 v[244:245], v[244:245], v[42:43]
    v_exp_f32 v239, v239
    v_pk_fma_f32 v[246:247], v[42:43], v[42:43], v[246:247]
    v_exp_f32 v240, v240
    v_pk_add_f32 v[244:245], v[244:245], v[44:45]
    v_pk_fma_f32 v[246:247], v[44:45], v[44:45], v[246:247]
    v_exp_f32 v241, v241
    v_pk_add_f32 v[244:245], v[244:245], v[46:47]
    v_exp_f32 v242, v242
    v_pk_fma_f32 v[246:247], v[46:47], v[46:47], v[246:247]
    v_add_f32 v209, v244, v245
    v_exp_f32 v243, v243
    v_add_f32 v217, v246, v247
    v_pk_add_f32 v[228:229], v[228:229], 1.0 op_sel_hi:[1,0]
    v_pk_add_f32 v[230:231], v[230:231], 1.0 op_sel_hi:[1,0]
    v_pk_add_f32 v[232:233], v[232:233], 1.0 op_sel_hi:[1,0]
    v_pk_add_f32 v[234:235], v[234:235], 1.0 op_sel_hi:[1,0]
    v_pk_add_f32 v[236:237], v[236:237], 1.0 op_sel_hi:[1,0]
    v_pk_add_f32 v[238:239], v[238:239], 1.0 op_sel_hi:[1,0]
    v_pk_add_f32 v[240:241], v[240:241], 1.0 op_sel_hi:[1,0]
    v_pk_add_f32 v[242:243], v[242:243], 1.0 op_sel_hi:[1,0]
    v_rcp_f32 v228, v228
    v_pk_mul_f32 v[0:1], v[64:65], v[64:65]
    v_pk_mul_f32 v[2:3], v[66:67], v[66:67]
    v_rcp_f32 v229, v229
    v_pk_mul_f32 v[4:5], v[68:69], v[68:69]
    v_rcp_f32 v230, v230
    v_pk_mul_f32 v[6:7], v[70:71], v[70:71]
    v_pk_mul_f32 v[8:9], v[72:73], v[72:73]
    v_rcp_f32 v231, v231
    v_pk_mul_f32 v[10:11], v[74:75], v[74:75]
    v_rcp_f32 v232, v232
    v_pk_mul_f32 v[12:13], v[76:77], v[76:77]
    v_pk_mul_f32 v[14:15], v[78:79], v[78:79]
    v_rcp_f32 v233, v233
    v_pk_fma_f32 v[0:1], v[0:1], v[226:227], v[226:227] op_sel:[0,0,1] op_sel_hi:[1,0,1]
    v_rcp_f32 v234, v234
    v_pk_fma_f32 v[2:3], v[2:3], v[226:227], v[226:227] op_sel:[0,0,1] op_sel_hi:[1,0,1]
    v_pk_fma_f32 v[4:5], v[4:5], v[226:227], v[226:227] op_sel:[0,0,1] op_sel_hi:[1,0,1]
    v_rcp_f32 v235, v235
    v_pk_fma_f32 v[6:7], v[6:7], v[226:227], v[226:227] op_sel:[0,0,1] op_sel_hi:[1,0,1]
    v_rcp_f32 v236, v236
    v_pk_fma_f32 v[8:9], v[8:9], v[226:227], v[226:227] op_sel:[0,0,1] op_sel_hi:[1,0,1]
    v_pk_fma_f32 v[10:11], v[10:11], v[226:227], v[226:227] op_sel:[0,0,1] op_sel_hi:[1,0,1]
    v_rcp_f32 v237, v237
    v_pk_fma_f32 v[12:13], v[12:13], v[226:227], v[226:227] op_sel:[0,0,1] op_sel_hi:[1,0,1]
    v_rcp_f32 v238, v238
    v_pk_fma_f32 v[14:15], v[14:15], v[226:227], v[226:227] op_sel:[0,0,1] op_sel_hi:[1,0,1]
    v_pk_mul_f32 v[0:1], v[0:1], v[64:65]
    v_rcp_f32 v239, v239
    v_pk_mul_f32 v[2:3], v[2:3], v[66:67]
    v_rcp_f32 v240, v240
    v_pk_mul_f32 v[4:5], v[4:5], v[68:69]
    v_pk_mul_f32 v[6:7], v[6:7], v[70:71]
    v_rcp_f32 v241, v241
    v_pk_mul_f32 v[8:9], v[8:9], v[72:73]
    v_rcp_f32 v242, v242
    v_pk_mul_f32 v[10:11], v[10:11], v[74:75]
    v_pk_mul_f32 v[12:13], v[12:13], v[76:77]
    v_rcp_f32 v243, v243
    v_pk_mul_f32 v[14:15], v[14:15], v[78:79]
    v_exp_f32 v0, v0
    v_pk_mul_f32 v[48:49], v[48:49], v[228:229]
    v_pk_mul_f32 v[50:51], v[50:51], v[230:231]
    v_exp_f32 v1, v1
    v_pk_mul_f32 v[52:53], v[52:53], v[232:233]
    v_pk_mul_f32 v[54:55], v[54:55], v[234:235]
    v_exp_f32 v2, v2
    v_pk_mul_f32 v[56:57], v[56:57], v[236:237]
    v_exp_f32 v3, v3
    v_pk_mul_f32 v[58:59], v[58:59], v[238:239]
    v_pk_mul_f32 v[60:61], v[60:61], v[240:241]
    v_exp_f32 v4, v4
    v_pk_mul_f32 v[62:63], v[62:63], v[242:243]
    v_exp_f32 v5, v5
    v_pk_add_f32 v[244:245], v[48:49], v[50:51]
    v_pk_mul_f32 v[246:247], v[48:49], v[48:49]
    v_exp_f32 v6, v6
    v_pk_fma_f32 v[246:247], v[50:51], v[50:51], v[246:247]
    v_exp_f32 v7, v7
    v_pk_add_f32 v[244:245], v[244:245], v[52:53]
    v_pk_fma_f32 v[246:247], v[52:53], v[52:53], v[246:247]
    v_exp_f32 v8, v8
    v_pk_add_f32 v[244:245], v[244:245], v[54:55]
    v_pk_fma_f32 v[246:247], v[54:55], v[54:55], v[246:247]
    v_exp_f32 v9, v9
    v_pk_add_f32 v[244:245], v[244:245], v[56:57]
    v_exp_f32 v10, v10
    v_pk_fma_f32 v[246:247], v[56:57], v[56:57], v[246:247]
    v_pk_add_f32 v[244:245], v[244:245], v[58:59]
    v_exp_f32 v11, v11
    v_pk_fma_f32 v[246:247], v[58:59], v[58:59], v[246:247]
    v_exp_f32 v12, v12
    v_pk_add_f32 v[244:245], v[244:245], v[60:61]
    v_pk_fma_f32 v[246:247], v[60:61], v[60:61], v[246:247]
    v_exp_f32 v13, v13
    v_pk_add_f32 v[244:245], v[244:245], v[62:63]
    v_exp_f32 v14, v14
    v_pk_fma_f32 v[246:247], v[62:63], v[62:63], v[246:247]
    v_add_f32 v210, v244, v245
    v_exp_f32 v15, v15
    v_add_f32 v218, v246, v247
    v_pk_add_f32 v[0:1], v[0:1], 1.0 op_sel_hi:[1,0]
    v_pk_add_f32 v[2:3], v[2:3], 1.0 op_sel_hi:[1,0]
    v_pk_add_f32 v[4:5], v[4:5], 1.0 op_sel_hi:[1,0]
    v_pk_add_f32 v[6:7], v[6:7], 1.0 op_sel_hi:[1,0]
    v_pk_add_f32 v[8:9], v[8:9], 1.0 op_sel_hi:[1,0]
    v_pk_add_f32 v[10:11], v[10:11], 1.0 op_sel_hi:[1,0]
    v_pk_add_f32 v[12:13], v[12:13], 1.0 op_sel_hi:[1,0]
    v_pk_add_f32 v[14:15], v[14:15], 1.0 op_sel_hi:[1,0]
    v_rcp_f32 v0, v0
    v_pk_mul_f32 v[228:229], v[80:81], v[80:81]
    v_pk_mul_f32 v[230:231], v[82:83], v[82:83]
    v_rcp_f32 v1, v1
    v_pk_mul_f32 v[232:233], v[84:85], v[84:85]
    v_rcp_f32 v2, v2
    v_pk_mul_f32 v[234:235], v[86:87], v[86:87]
    v_pk_mul_f32 v[236:237], v[88:89], v[88:89]
    v_rcp_f32 v3, v3
    v_pk_mul_f32 v[238:239], v[90:91], v[90:91]
    v_rcp_f32 v4, v4
    v_pk_mul_f32 v[240:241], v[92:93], v[92:93]
    v_pk_mul_f32 v[242:243], v[94:95], v[94:95]
    v_rcp_f32 v5, v5
    v_pk_fma_f32 v[228:229], v[228:229], v[226:227], v[226:227] op_sel:[0,0,1] op_sel_hi:[1,0,1]
    v_rcp_f32 v6, v6
    v_pk_fma_f32 v[230:231], v[230:231], v[226:227], v[226:227] op_sel:[0,0,1] op_sel_hi:[1,0,1]
    v_pk_fma_f32 v[232:233], v[232:233], v[226:227], v[226:227] op_sel:[0,0,1] op_sel_hi:[1,0,1]
    v_rcp_f32 v7, v7
    v_pk_fma_f32 v[234:235], v[234:235], v[226:227], v[226:227] op_sel:[0,0,1] op_sel_hi:[1,0,1]
    v_rcp_f32 v8, v8
    v_pk_fma_f32 v[236:237], v[236:237], v[226:227], v[226:227] op_sel:[0,0,1] op_sel_hi:[1,0,1]
    v_pk_fma_f32 v[238:239], v[238:239], v[226:227], v[226:227] op_sel:[0,0,1] op_sel_hi:[1,0,1]
    v_rcp_f32 v9, v9
    v_pk_fma_f32 v[240:241], v[240:241], v[226:227], v[226:227] op_sel:[0,0,1] op_sel_hi:[1,0,1]
    v_rcp_f32 v10, v10
    v_pk_fma_f32 v[242:243], v[242:243], v[226:227], v[226:227] op_sel:[0,0,1] op_sel_hi:[1,0,1]
    v_pk_mul_f32 v[228:229], v[228:229], v[80:81]
    v_rcp_f32 v11, v11
    v_pk_mul_f32 v[230:231], v[230:231], v[82:83]
    v_rcp_f32 v12, v12
    v_pk_mul_f32 v[232:233], v[232:233], v[84:85]
    v_pk_mul_f32 v[234:235], v[234:235], v[86:87]
    v_rcp_f32 v13, v13
    v_pk_mul_f32 v[236:237], v[236:237], v[88:89]
    v_rcp_f32 v14, v14
    v_pk_mul_f32 v[238:239], v[238:239], v[90:91]
    v_pk_mul_f32 v[240:241], v[240:241], v[92:93]
    v_rcp_f32 v15, v15
    v_pk_mul_f32 v[242:243], v[242:243], v[94:95]
    v_exp_f32 v228, v228
    v_pk_mul_f32 v[64:65], v[64:65], v[0:1]
    v_pk_mul_f32 v[66:67], v[66:67], v[2:3]
    v_exp_f32 v229, v229
    v_pk_mul_f32 v[68:69], v[68:69], v[4:5]
    v_pk_mul_f32 v[70:71], v[70:71], v[6:7]
    v_exp_f32 v230, v230
    v_pk_mul_f32 v[72:73], v[72:73], v[8:9]
    v_exp_f32 v231, v231
    v_pk_mul_f32 v[74:75], v[74:75], v[10:11]
    v_pk_mul_f32 v[76:77], v[76:77], v[12:13]
    v_exp_f32 v232, v232
    v_pk_mul_f32 v[78:79], v[78:79], v[14:15]
    v_exp_f32 v233, v233
    v_pk_add_f32 v[244:245], v[64:65], v[66:67]
    v_pk_mul_f32 v[246:247], v[64:65], v[64:65]
    v_exp_f32 v234, v234
    v_pk_fma_f32 v[246:247], v[66:67], v[66:67], v[246:247]
    v_exp_f32 v235, v235
    v_pk_add_f32 v[244:245], v[244:245], v[68:69]
    v_pk_fma_f32 v[246:247], v[68:69], v[68:69], v[246:247]
    v_exp_f32 v236, v236
    v_pk_add_f32 v[244:245], v[244:245], v[70:71]
    v_pk_fma_f32 v[246:247], v[70:71], v[70:71], v[246:247]
    v_exp_f32 v237, v237
    v_pk_add_f32 v[244:245], v[244:245], v[72:73]
    v_exp_f32 v238, v238
    v_pk_fma_f32 v[246:247], v[72:73], v[72:73], v[246:247]
    v_pk_add_f32 v[244:245], v[244:245], v[74:75]
    v_exp_f32 v239, v239
    v_pk_fma_f32 v[246:247], v[74:75], v[74:75], v[246:247]
    v_exp_f32 v240, v240
    v_pk_add_f32 v[244:245], v[244:245], v[76:77]
    v_pk_fma_f32 v[246:247], v[76:77], v[76:77], v[246:247]
    v_exp_f32 v241, v241
    v_pk_add_f32 v[244:245], v[244:245], v[78:79]
    v_exp_f32 v242, v242
    v_pk_fma_f32 v[246:247], v[78:79], v[78:79], v[246:247]
    v_add_f32 v211, v244, v245
    v_exp_f32 v243, v243
    v_add_f32 v219, v246, v247
    v_pk_add_f32 v[228:229], v[228:229], 1.0 op_sel_hi:[1,0]
    v_pk_add_f32 v[230:231], v[230:231], 1.0 op_sel_hi:[1,0]
    v_pk_add_f32 v[232:233], v[232:233], 1.0 op_sel_hi:[1,0]
    v_pk_add_f32 v[234:235], v[234:235], 1.0 op_sel_hi:[1,0]
    v_pk_add_f32 v[236:237], v[236:237], 1.0 op_sel_hi:[1,0]
    v_pk_add_f32 v[238:239], v[238:239], 1.0 op_sel_hi:[1,0]
    v_pk_add_f32 v[240:241], v[240:241], 1.0 op_sel_hi:[1,0]
    v_pk_add_f32 v[242:243], v[242:243], 1.0 op_sel_hi:[1,0]
    v_rcp_f32 v228, v228
    v_pk_mul_f32 v[0:1], v[96:97], v[96:97]
    v_pk_mul_f32 v[2:3], v[98:99], v[98:99]
    v_rcp_f32 v229, v229
    v_pk_mul_f32 v[4:5], v[100:101], v[100:101]
    v_rcp_f32 v230, v230
    v_pk_mul_f32 v[6:7], v[102:103], v[102:103]
    v_pk_mul_f32 v[8:9], v[104:105], v[104:105]
    v_rcp_f32 v231, v231
    v_pk_mul_f32 v[10:11], v[106:107], v[106:107]
    v_rcp_f32 v232, v232
    v_pk_mul_f32 v[12:13], v[108:109], v[108:109]
    v_pk_mul_f32 v[14:15], v[110:111], v[110:111]
    v_rcp_f32 v233, v233
    v_pk_fma_f32 v[0:1], v[0:1], v[226:227], v[226:227] op_sel:[0,0,1] op_sel_hi:[1,0,1]
    v_rcp_f32 v234, v234
    v_pk_fma_f32 v[2:3], v[2:3], v[226:227], v[226:227] op_sel:[0,0,1] op_sel_hi:[1,0,1]
    v_pk_fma_f32 v[4:5], v[4:5], v[226:227], v[226:227] op_sel:[0,0,1] op_sel_hi:[1,0,1]
    v_rcp_f32 v235, v235
    v_pk_fma_f32 v[6:7], v[6:7], v[226:227], v[226:227] op_sel:[0,0,1] op_sel_hi:[1,0,1]
    v_rcp_f32 v236, v236
    v_pk_fma_f32 v[8:9], v[8:9], v[226:227], v[226:227] op_sel:[0,0,1] op_sel_hi:[1,0,1]
    v_pk_fma_f32 v[10:11], v[10:11], v[226:227], v[226:227] op_sel:[0,0,1] op_sel_hi:[1,0,1]
    v_rcp_f32 v237, v237
    v_pk_fma_f32 v[12:13], v[12:13], v[226:227], v[226:227] op_sel:[0,0,1] op_sel_hi:[1,0,1]
    v_rcp_f32 v238, v238
    v_pk_fma_f32 v[14:15], v[14:15], v[226:227], v[226:227] op_sel:[0,0,1] op_sel_hi:[1,0,1]
    v_pk_mul_f32 v[0:1], v[0:1], v[96:97]
    v_rcp_f32 v239, v239
    v_pk_mul_f32 v[2:3], v[2:3], v[98:99]
    v_rcp_f32 v240, v240
    v_pk_mul_f32 v[4:5], v[4:5], v[100:101]
    v_pk_mul_f32 v[6:7], v[6:7], v[102:103]
    v_rcp_f32 v241, v241
    v_pk_mul_f32 v[8:9], v[8:9], v[104:105]
    v_rcp_f32 v242, v242
    v_pk_mul_f32 v[10:11], v[10:11], v[106:107]
    v_pk_mul_f32 v[12:13], v[12:13], v[108:109]
    v_rcp_f32 v243, v243
    v_pk_mul_f32 v[14:15], v[14:15], v[110:111]
    v_exp_f32 v0, v0
    v_pk_mul_f32 v[80:81], v[80:81], v[228:229]
    v_pk_mul_f32 v[82:83], v[82:83], v[230:231]
    v_exp_f32 v1, v1
    v_pk_mul_f32 v[84:85], v[84:85], v[232:233]
    v_pk_mul_f32 v[86:87], v[86:87], v[234:235]
    v_exp_f32 v2, v2
    v_pk_mul_f32 v[88:89], v[88:89], v[236:237]
    v_exp_f32 v3, v3
    v_pk_mul_f32 v[90:91], v[90:91], v[238:239]
    v_pk_mul_f32 v[92:93], v[92:93], v[240:241]
    v_exp_f32 v4, v4
    v_pk_mul_f32 v[94:95], v[94:95], v[242:243]
    v_exp_f32 v5, v5
    v_pk_add_f32 v[244:245], v[80:81], v[82:83]
    v_pk_mul_f32 v[246:247], v[80:81], v[80:81]
    v_exp_f32 v6, v6
    v_pk_fma_f32 v[246:247], v[82:83], v[82:83], v[246:247]
    v_exp_f32 v7, v7
    v_pk_add_f32 v[244:245], v[244:245], v[84:85]
    v_pk_fma_f32 v[246:247], v[84:85], v[84:85], v[246:247]
    v_exp_f32 v8, v8
    v_pk_add_f32 v[244:245], v[244:245], v[86:87]
    v_pk_fma_f32 v[246:247], v[86:87], v[86:87], v[246:247]
    v_exp_f32 v9, v9
    v_pk_add_f32 v[244:245], v[244:245], v[88:89]
    v_exp_f32 v10, v10
    v_pk_fma_f32 v[246:247], v[88:89], v[88:89], v[246:247]
    v_pk_add_f32 v[244:245], v[244:245], v[90:91]
    v_exp_f32 v11, v11
    v_pk_fma_f32 v[246:247], v[90:91], v[90:91], v[246:247]
    v_exp_f32 v12, v12
    v_pk_add_f32 v[244:245], v[244:245], v[92:93]
    v_pk_fma_f32 v[246:247], v[92:93], v[92:93], v[246:247]
    v_exp_f32 v13, v13
    v_pk_add_f32 v[244:245], v[244:245], v[94:95]
    v_exp_f32 v14, v14
    v_pk_fma_f32 v[246:247], v[94:95], v[94:95], v[246:247]
    v_add_f32 v212, v244, v245
    v_exp_f32 v15, v15
    v_add_f32 v220, v246, v247
    v_pk_add_f32 v[0:1], v[0:1], 1.0 op_sel_hi:[1,0]
    v_pk_add_f32 v[2:3], v[2:3], 1.0 op_sel_hi:[1,0]
    v_pk_add_f32 v[4:5], v[4:5], 1.0 op_sel_hi:[1,0]
    v_pk_add_f32 v[6:7], v[6:7], 1.0 op_sel_hi:[1,0]
    v_pk_add_f32 v[8:9], v[8:9], 1.0 op_sel_hi:[1,0]
    v_pk_add_f32 v[10:11], v[10:11], 1.0 op_sel_hi:[1,0]
    v_pk_add_f32 v[12:13], v[12:13], 1.0 op_sel_hi:[1,0]
    v_pk_add_f32 v[14:15], v[14:15], 1.0 op_sel_hi:[1,0]
    v_rcp_f32 v0, v0
    v_pk_mul_f32 v[228:229], v[112:113], v[112:113]
    v_pk_mul_f32 v[230:231], v[114:115], v[114:115]
    v_rcp_f32 v1, v1
    v_pk_mul_f32 v[232:233], v[116:117], v[116:117]
    v_rcp_f32 v2, v2
    v_pk_mul_f32 v[234:235], v[118:119], v[118:119]
    v_pk_mul_f32 v[236:237], v[120:121], v[120:121]
    v_rcp_f32 v3, v3
    v_pk_mul_f32 v[238:239], v[122:123], v[122:123]
    v_rcp_f32 v4, v4
    v_pk_mul_f32 v[240:241], v[124:125], v[124:125]
    v_pk_mul_f32 v[242:243], v[126:127], v[126:127]
    v_rcp_f32 v5, v5
    v_pk_fma_f32 v[228:229], v[228:229], v[226:227], v[226:227] op_sel:[0,0,1] op_sel_hi:[1,0,1]
    v_rcp_f32 v6, v6
    v_pk_fma_f32 v[230:231], v[230:231], v[226:227], v[226:227] op_sel:[0,0,1] op_sel_hi:[1,0,1]
    v_pk_fma_f32 v[232:233], v[232:233], v[226:227], v[226:227] op_sel:[0,0,1] op_sel_hi:[1,0,1]
    v_rcp_f32 v7, v7
    v_pk_fma_f32 v[234:235], v[234:235], v[226:227], v[226:227] op_sel:[0,0,1] op_sel_hi:[1,0,1]
    v_rcp_f32 v8, v8
    v_pk_fma_f32 v[236:237], v[236:237], v[226:227], v[226:227] op_sel:[0,0,1] op_sel_hi:[1,0,1]
    v_pk_fma_f32 v[238:239], v[238:239], v[226:227], v[226:227] op_sel:[0,0,1] op_sel_hi:[1,0,1]
    v_rcp_f32 v9, v9
    v_pk_fma_f32 v[240:241], v[240:241], v[226:227], v[226:227] op_sel:[0,0,1] op_sel_hi:[1,0,1]
    v_rcp_f32 v10, v10
    v_pk_fma_f32 v[242:243], v[242:243], v[226:227], v[226:227] op_sel:[0,0,1] op_sel_hi:[1,0,1]
    v_pk_mul_f32 v[228:229], v[228:229], v[112:113]
    v_rcp_f32 v11, v11
    v_pk_mul_f32 v[230:231], v[230:231], v[114:115]
    v_rcp_f32 v12, v12
    v_pk_mul_f32 v[232:233], v[232:233], v[116:117]
    v_pk_mul_f32 v[234:235], v[234:235], v[118:119]
    v_rcp_f32 v13, v13
    v_pk_mul_f32 v[236:237], v[236:237], v[120:121]
    v_rcp_f32 v14, v14
    v_pk_mul_f32 v[238:239], v[238:239], v[122:123]
    v_pk_mul_f32 v[240:241], v[240:241], v[124:125]
    v_rcp_f32 v15, v15
    v_pk_mul_f32 v[242:243], v[242:243], v[126:127]
    v_exp_f32 v228, v228
    v_pk_mul_f32 v[96:97], v[96:97], v[0:1]
    v_pk_mul_f32 v[98:99], v[98:99], v[2:3]
    v_exp_f32 v229, v229
    v_pk_mul_f32 v[100:101], v[100:101], v[4:5]
    v_pk_mul_f32 v[102:103], v[102:103], v[6:7]
    v_exp_f32 v230, v230
    v_pk_mul_f32 v[104:105], v[104:105], v[8:9]
    v_exp_f32 v231, v231
    v_pk_mul_f32 v[106:107], v[106:107], v[10:11]
    v_pk_mul_f32 v[108:109], v[108:109], v[12:13]
    v_exp_f32 v232, v232
    v_pk_mul_f32 v[110:111], v[110:111], v[14:15]
    v_exp_f32 v233, v233
    v_pk_add_f32 v[244:245], v[96:97], v[98:99]
    v_pk_mul_f32 v[246:247], v[96:97], v[96:97]
    v_exp_f32 v234, v234
    v_pk_fma_f32 v[246:247], v[98:99], v[98:99], v[246:247]
    v_exp_f32 v235, v235
    v_pk_add_f32 v[244:245], v[244:245], v[100:101]
    v_pk_fma_f32 v[246:247], v[100:101], v[100:101], v[246:247]
    v_exp_f32 v236, v236
    v_pk_add_f32 v[244:245], v[244:245], v[102:103]
    v_pk_fma_f32 v[246:247], v[102:103], v[102:103], v[246:247]
    v_exp_f32 v237, v237
    v_pk_add_f32 v[244:245], v[244:245], v[104:105]
    v_exp_f32 v238, v238
    v_pk_fma_f32 v[246:247], v[104:105], v[104:105], v[246:247]
    v_pk_add_f32 v[244:245], v[244:245], v[106:107]
    v_exp_f32 v239, v239
    v_pk_fma_f32 v[246:247], v[106:107], v[106:107], v[246:247]
    v_exp_f32 v240, v240
    v_pk_add_f32 v[244:245], v[244:245], v[108:109]
    v_pk_fma_f32 v[246:247], v[108:109], v[108:109], v[246:247]
    v_exp_f32 v241, v241
    v_pk_add_f32 v[244:245], v[244:245], v[110:111]
    v_exp_f32 v242, v242
    v_pk_fma_f32 v[246:247], v[110:111], v[110:111], v[246:247]
    v_add_f32 v213, v244, v245
    v_exp_f32 v243, v243
    v_add_f32 v221, v246, v247
    v_pk_add_f32 v[228:229], v[228:229], 1.0 op_sel_hi:[1,0]
    v_pk_add_f32 v[230:231], v[230:231], 1.0 op_sel_hi:[1,0]
    v_pk_add_f32 v[232:233], v[232:233], 1.0 op_sel_hi:[1,0]
    v_pk_add_f32 v[234:235], v[234:235], 1.0 op_sel_hi:[1,0]
    v_pk_add_f32 v[236:237], v[236:237], 1.0 op_sel_hi:[1,0]
    v_pk_add_f32 v[238:239], v[238:239], 1.0 op_sel_hi:[1,0]
    v_pk_add_f32 v[240:241], v[240:241], 1.0 op_sel_hi:[1,0]
    v_pk_add_f32 v[242:243], v[242:243], 1.0 op_sel_hi:[1,0]
    v_rcp_f32 v228, v228
    v_pk_mul_f32 v[0:1], v[128:129], v[128:129]
    v_pk_mul_f32 v[2:3], v[130:131], v[130:131]
    v_rcp_f32 v229, v229
    v_pk_mul_f32 v[4:5], v[132:133], v[132:133]
    v_rcp_f32 v230, v230
    v_pk_mul_f32 v[6:7], v[134:135], v[134:135]
    v_pk_mul_f32 v[8:9], v[136:137], v[136:137]
    v_rcp_f32 v231, v231
    v_pk_mul_f32 v[10:11], v[138:139], v[138:139]
    v_rcp_f32 v232, v232
    v_pk_mul_f32 v[12:13], v[140:141], v[140:141]
    v_pk_mul_f32 v[14:15], v[142:143], v[142:143]
    v_rcp_f32 v233, v233
    v_pk_fma_f32 v[0:1], v[0:1], v[226:227], v[226:227] op_sel:[0,0,1] op_sel_hi:[1,0,1]
    v_rcp_f32 v234, v234
    v_pk_fma_f32 v[2:3], v[2:3], v[226:227], v[226:227] op_sel:[0,0,1] op_sel_hi:[1,0,1]
    v_pk_fma_f32 v[4:5], v[4:5], v[226:227], v[226:227] op_sel:[0,0,1] op_sel_hi:[1,0,1]
    v_rcp_f32 v235, v235
    v_pk_fma_f32 v[6:7], v[6:7], v[226:227], v[226:227] op_sel:[0,0,1] op_sel_hi:[1,0,1]
    v_rcp_f32 v236, v236
    v_pk_fma_f32 v[8:9], v[8:9], v[226:227], v[226:227] op_sel:[0,0,1] op_sel_hi:[1,0,1]
    v_pk_fma_f32 v[10:11], v[10:11], v[226:227], v[226:227] op_sel:[0,0,1] op_sel_hi:[1,0,1]
    v_rcp_f32 v237, v237
    v_pk_fma_f32 v[12:13], v[12:13], v[226:227], v[226:227] op_sel:[0,0,1] op_sel_hi:[1,0,1]
    v_rcp_f32 v238, v238
    v_pk_fma_f32 v[14:15], v[14:15], v[226:227], v[226:227] op_sel:[0,0,1] op_sel_hi:[1,0,1]
    v_pk_mul_f32 v[0:1], v[0:1], v[128:129]
    v_rcp_f32 v239, v239
    v_pk_mul_f32 v[2:3], v[2:3], v[130:131]
    v_rcp_f32 v240, v240
    v_pk_mul_f32 v[4:5], v[4:5], v[132:133]
    v_pk_mul_f32 v[6:7], v[6:7], v[134:135]
    v_rcp_f32 v241, v241
    v_pk_mul_f32 v[8:9], v[8:9], v[136:137]
    v_rcp_f32 v242, v242
    v_pk_mul_f32 v[10:11], v[10:11], v[138:139]
    v_pk_mul_f32 v[12:13], v[12:13], v[140:141]
    v_rcp_f32 v243, v243
    v_pk_mul_f32 v[14:15], v[14:15], v[142:143]
    v_exp_f32 v0, v0
    v_pk_mul_f32 v[112:113], v[112:113], v[228:229]
    v_pk_mul_f32 v[114:115], v[114:115], v[230:231]
    v_exp_f32 v1, v1
    v_pk_mul_f32 v[116:117], v[116:117], v[232:233]
    v_pk_mul_f32 v[118:119], v[118:119], v[234:235]
    v_exp_f32 v2, v2
    v_pk_mul_f32 v[120:121], v[120:121], v[236:237]
    v_exp_f32 v3, v3
    v_pk_mul_f32 v[122:123], v[122:123], v[238:239]
    v_pk_mul_f32 v[124:125], v[124:125], v[240:241]
    v_exp_f32 v4, v4
    v_pk_mul_f32 v[126:127], v[126:127], v[242:243]
    v_exp_f32 v5, v5
    v_pk_add_f32 v[244:245], v[112:113], v[114:115]
    v_pk_mul_f32 v[246:247], v[112:113], v[112:113]
    v_exp_f32 v6, v6
    v_pk_fma_f32 v[246:247], v[114:115], v[114:115], v[246:247]
    v_exp_f32 v7, v7
    v_pk_add_f32 v[244:245], v[244:245], v[116:117]
    v_pk_fma_f32 v[246:247], v[116:117], v[116:117], v[246:247]
    v_exp_f32 v8, v8
    v_pk_add_f32 v[244:245], v[244:245], v[118:119]
    v_pk_fma_f32 v[246:247], v[118:119], v[118:119], v[246:247]
    v_exp_f32 v9, v9
    v_pk_add_f32 v[244:245], v[244:245], v[120:121]
    v_exp_f32 v10, v10
    v_pk_fma_f32 v[246:247], v[120:121], v[120:121], v[246:247]
    v_pk_add_f32 v[244:245], v[244:245], v[122:123]
    v_exp_f32 v11, v11
    v_pk_fma_f32 v[246:247], v[122:123], v[122:123], v[246:247]
    v_exp_f32 v12, v12
    v_pk_add_f32 v[244:245], v[244:245], v[124:125]
    v_pk_fma_f32 v[246:247], v[124:125], v[124:125], v[246:247]
    v_exp_f32 v13, v13
    v_pk_add_f32 v[244:245], v[244:245], v[126:127]
    v_exp_f32 v14, v14
    v_pk_fma_f32 v[246:247], v[126:127], v[126:127], v[246:247]
    v_add_f32 v214, v244, v245
    v_exp_f32 v15, v15
    v_add_f32 v222, v246, v247
    v_pk_add_f32 v[0:1], v[0:1], 1.0 op_sel_hi:[1,0]
    v_pk_add_f32 v[2:3], v[2:3], 1.0 op_sel_hi:[1,0]
    v_pk_add_f32 v[4:5], v[4:5], 1.0 op_sel_hi:[1,0]
    v_pk_add_f32 v[6:7], v[6:7], 1.0 op_sel_hi:[1,0]
    v_pk_add_f32 v[8:9], v[8:9], 1.0 op_sel_hi:[1,0]
    v_pk_add_f32 v[10:11], v[10:11], 1.0 op_sel_hi:[1,0]
    v_pk_add_f32 v[12:13], v[12:13], 1.0 op_sel_hi:[1,0]
    v_pk_add_f32 v[14:15], v[14:15], 1.0 op_sel_hi:[1,0]
    v_rcp_f32 v0, v0
    v_rcp_f32 v1, v1
    v_rcp_f32 v2, v2
    v_rcp_f32 v3, v3
    v_rcp_f32 v4, v4
    v_rcp_f32 v5, v5
    v_rcp_f32 v6, v6
    v_rcp_f32 v7, v7
    v_rcp_f32 v8, v8
    v_rcp_f32 v9, v9
    v_rcp_f32 v10, v10
    v_rcp_f32 v11, v11
    v_rcp_f32 v12, v12
    v_rcp_f32 v13, v13
    v_rcp_f32 v14, v14
    v_rcp_f32 v15, v15
    v_pk_mul_f32 v[128:129], v[128:129], v[0:1]
    v_pk_mul_f32 v[130:131], v[130:131], v[2:3]
    v_pk_mul_f32 v[132:133], v[132:133], v[4:5]
    v_pk_mul_f32 v[134:135], v[134:135], v[6:7]
    v_pk_mul_f32 v[136:137], v[136:137], v[8:9]
    v_pk_mul_f32 v[138:139], v[138:139], v[10:11]
    v_pk_mul_f32 v[140:141], v[140:141], v[12:13]
    v_pk_mul_f32 v[142:143], v[142:143], v[14:15]
    v_pk_add_f32 v[244:245], v[128:129], v[130:131]
    v_pk_mul_f32 v[246:247], v[128:129], v[128:129]
    v_pk_fma_f32 v[246:247], v[130:131], v[130:131], v[246:247]
    v_pk_add_f32 v[244:245], v[244:245], v[132:133]
    v_pk_fma_f32 v[246:247], v[132:133], v[132:133], v[246:247]
    v_pk_add_f32 v[244:245], v[244:245], v[134:135]
    v_pk_fma_f32 v[246:247], v[134:135], v[134:135], v[246:247]
    v_pk_add_f32 v[244:245], v[244:245], v[136:137]
    v_pk_fma_f32 v[246:247], v[136:137], v[136:137], v[246:247]
    v_pk_add_f32 v[244:245], v[244:245], v[138:139]
    v_pk_fma_f32 v[246:247], v[138:139], v[138:139], v[246:247]
    v_pk_add_f32 v[244:245], v[244:245], v[140:141]
    v_pk_fma_f32 v[246:247], v[140:141], v[140:141], v[246:247]
    v_pk_add_f32 v[244:245], v[244:245], v[142:143]
    v_pk_fma_f32 v[246:247], v[142:143], v[142:143], v[246:247]
    v_add_f32 v215, v244, v245
    v_add_f32 v223, v246, v247
    s_waitcnt vmcnt(0)
    v_readfirstlane_b32 s97, v251
    s_nop 0
    s_cmp_ge_u32 s97, 64
    s_cbranch_scc1 L_p1z_c0_out
    v_mov_b32 v225, 0
    s_mov_b32 s96, 0
L_p1z_c0:
    buffer_load_dword v251, v225, s[20:23], 0 offen sc1
    s_waitcnt vmcnt(0)
    v_readfirstlane_b32 s97, v251
    s_nop 0
    s_cmp_ge_u32 s97, 64
    s_cbranch_scc1 L_p1z_c0_out
    s_add_u32 s96, s96, 1
    s_cmp_lt_u32 s96, 0x40000
    s_cbranch_scc1 L_p1z_c0
L_p1z_c0_out:
    v_mbcnt_lo_u32_b32 v224, -1, 0
    v_mbcnt_hi_u32_b32 v224, -1, v224
    v_permlane32_swap_b32 v208, v216
    v_permlane32_swap_b32 v209, v217
    v_permlane32_swap_b32 v210, v218
    v_permlane32_swap_b32 v211, v219
    v_permlane32_swap_b32 v212, v220
    v_permlane32_swap_b32 v213, v221
    v_permlane32_swap_b32 v214, v222
    v_permlane32_swap_b32 v215, v223
    v_add_f32 v208, v208, v216
    v_add_f32 v209, v209, v217
    v_add_f32 v210, v210, v218
    v_add_f32 v211, v211, v219
    v_add_f32 v212, v212, v220
    v_add_f32 v213, v213, v221
    v_add_f32 v214, v214, v222
    v_add_f32 v215, v215, v223
    v_permlane16_swap_b32 v208, v212
    v_permlane16_swap_b32 v209, v213
    v_permlane16_swap_b32 v210, v214
    v_permlane16_swap_b32 v211, v215
    v_add_f32 v208, v208, v212
    v_add_f32 v209, v209, v213
    v_add_f32 v210, v210, v214
    v_add_f32 v211, v211, v215
    v_lshlrev_b32 v225, 4, v224
    s_lshl_b32 s41, s24, 10
    s_add_u32 s41, s41, 34816
    v_add_u32 v228, s41, v225
    ds_write_b128 v228, v[208:211]
    v_xor_b32 v229, 0x400, v228
    s_lshl_b32 s48, s25, 1
    s_add_u32 s48, s48, s50
    s_lshl_b32 s48, s48, 14
    s_add_u32 s48, s48, 0x1c10000
    s_lshl_b32 s46, s26, 10
    s_add_u32 s46, s46, s48
    s_waitcnt lgkmcnt(0)
    s_barrier
    ds_read_b128 v[212:215], v229
    s_waitcnt lgkmcnt(0)
    v_pk_add_f32 v[208:209], v[208:209], v[212:213]
    v_pk_add_f32 v[210:211], v[210:211], v[214:215]
    s_cmp_eq_u32 s51, 0
    s_cbranch_scc0 L_p1z_nopub
    buffer_store_dwordx4 v[208:211], v225, s[16:19], s46 offen sc1
L_p1z_nopub:
    s_lshl_b32 s49, s55, 2
    s_lshl_b32 s45, s51, 1
    s_add_u32 s49, s49, s45
    s_add_u32 s49, s49, 32
    s_lshl_b32 s41, s25, 3
    s_lshl_b32 s42, s50, 2
    s_add_u32 s41, s41, s42
    s_mul_i32 s41, s41, 112
    s_add_u32 s41, s41, s49
    s_lshl_b32 s41, s41, 10
    s_add_u32 s41, s41, 0xc00000
    v_pk_mul_f32 v[0:1], v[144:145], v[144:145]
    v_pk_mul_f32 v[2:3], v[146:147], v[146:147]
    v_pk_mul_f32 v[4:5], v[152:153], v[152:153]
    v_pk_mul_f32 v[6:7], v[154:155], v[154:155]
    v_pk_mul_f32 v[8:9], v[148:149], v[148:149]
    v_pk_mul_f32 v[10:11], v[150:151], v[150:151]
    v_pk_mul_f32 v[12:13], v[156:157], v[156:157]
    v_pk_mul_f32 v[14:15], v[158:159], v[158:159]
    v_pk_fma_f32 v[0:1], v[0:1], v[226:227], v[226:227] op_sel:[0,0,1] op_sel_hi:[1,0,1]
    v_pk_fma_f32 v[2:3], v[2:3], v[226:227], v[226:227] op_sel:[0,0,1] op_sel_hi:[1,0,1]
    v_pk_fma_f32 v[4:5], v[4:5], v[226:227], v[226:227] op_sel:[0,0,1] op_sel_hi:[1,0,1]
    v_pk_fma_f32 v[6:7], v[6:7], v[226:227], v[226:227] op_sel:[0,0,1] op_sel_hi:[1,0,1]
    v_pk_fma_f32 v[8:9], v[8:9], v[226:227], v[226:227] op_sel:[0,0,1] op_sel_hi:[1,0,1]
    v_pk_fma_f32 v[10:11], v[10:11], v[226:227], v[226:227] op_sel:[0,0,1] op_sel_hi:[1,0,1]
    v_pk_fma_f32 v[12:13], v[12:13], v[226:227], v[226:227] op_sel:[0,0,1] op_sel_hi:[1,0,1]
    v_pk_fma_f32 v[14:15], v[14:15], v[226:227], v[226:227] op_sel:[0,0,1] op_sel_hi:[1,0,1]
    v_pk_mul_f32 v[0:1], v[0:1], v[144:145]
    v_pk_mul_f32 v[2:3], v[2:3], v[146:147]
    v_pk_mul_f32 v[4:5], v[4:5], v[152:153]
    v_pk_mul_f32 v[6:7], v[6:7], v[154:155]
    v_pk_mul_f32 v[8:9], v[8:9], v[148:149]
    v_pk_mul_f32 v[10:11], v[10:11], v[150:151]
    v_pk_mul_f32 v[12:13], v[12:13], v[156:157]
    v_pk_mul_f32 v[14:15], v[14:15], v[158:159]
    v_exp_f32 v0, v0
    v_exp_f32 v1, v1
    v_exp_f32 v2, v2
    v_exp_f32 v3, v3
    v_exp_f32 v4, v4
    v_exp_f32 v5, v5
    v_exp_f32 v6, v6
    v_exp_f32 v7, v7
    v_exp_f32 v8, v8
    v_exp_f32 v9, v9
    v_exp_f32 v10, v10
    v_exp_f32 v11, v11
    v_exp_f32 v12, v12
    v_exp_f32 v13, v13
    v_exp_f32 v14, v14
    v_exp_f32 v15, v15
    v_pk_add_f32 v[0:1], v[0:1], 1.0 op_sel_hi:[1,0]
    v_pk_add_f32 v[2:3], v[2:3], 1.0 op_sel_hi:[1,0]
    v_pk_add_f32 v[4:5], v[4:5], 1.0 op_sel_hi:[1,0]
    v_pk_add_f32 v[6:7], v[6:7], 1.0 op_sel_hi:[1,0]
    v_pk_add_f32 v[8:9], v[8:9], 1.0 op_sel_hi:[1,0]
    v_pk_add_f32 v[10:11], v[10:11], 1.0 op_sel_hi:[1,0]
    v_pk_add_f32 v[12:13], v[12:13], 1.0 op_sel_hi:[1,0]
    v_pk_add_f32 v[14:15], v[14:15], 1.0 op_sel_hi:[1,0]
    v_rcp_f32 v0, v0
    v_pk_mul_f32 v[208:209], v[160:161], v[160:161]
    v_pk_mul_f32 v[210:211], v[162:163], v[162:163]
    v_rcp_f32 v1, v1
    v_pk_mul_f32 v[212:213], v[168:169], v[168:169]
    v_rcp_f32 v2, v2
    v_pk_mul_f32 v[214:215], v[170:171], v[170:171]
    v_pk_mul_f32 v[216:217], v[164:165], v[164:165]
    v_rcp_f32 v3, v3
    v_pk_mul_f32 v[218:219], v[166:167], v[166:167]
    v_rcp_f32 v4, v4
    v_pk_mul_f32 v[220:221], v[172:173], v[172:173]
    v_pk_mul_f32 v[222:223], v[174:175], v[174:175]
    v_rcp_f32 v5, v5
    v_pk_fma_f32 v[208:209], v[208:209], v[226:227], v[226:227] op_sel:[0,0,1] op_sel_hi:[1,0,1]
    v_rcp_f32 v6, v6
    v_pk_fma_f32 v[210:211], v[210:211], v[226:227], v[226:227] op_sel:[0,0,1] op_sel_hi:[1,0,1]
    v_pk_fma_f32 v[212:213], v[212:213], v[226:227], v[226:227] op_sel:[0,0,1] op_sel_hi:[1,0,1]
    v_rcp_f32 v7, v7
    v_pk_fma_f32 v[214:215], v[214:215], v[226:227], v[226:227] op_sel:[0,0,1] op_sel_hi:[1,0,1]
    v_rcp_f32 v8, v8
    v_pk_fma_f32 v[216:217], v[216:217], v[226:227], v[226:227] op_sel:[0,0,1] op_sel_hi:[1,0,1]
    v_pk_fma_f32 v[218:219], v[218:219], v[226:227], v[226:227] op_sel:[0,0,1] op_sel_hi:[1,0,1]
    v_rcp_f32 v9, v9
    v_pk_fma_f32 v[220:221], v[220:221], v[226:227], v[226:227] op_sel:[0,0,1] op_sel_hi:[1,0,1]
    v_rcp_f32 v10, v10
    v_pk_fma_f32 v[222:223], v[222:223], v[226:227], v[226:227] op_sel:[0,0,1] op_sel_hi:[1,0,1]
    v_pk_mul_f32 v[208:209], v[208:209], v[160:161]
    v_rcp_f32 v11, v11
    v_pk_mul_f32 v[210:211], v[210:211], v[162:163]
    v_rcp_f32 v12, v12
    v_pk_mul_f32 v[212:213], v[212:213], v[168:169]
    v_pk_mul_f32 v[214:215], v[214:215], v[170:171]
    v_rcp_f32 v13, v13
    v_pk_mul_f32 v[216:217], v[216:217], v[164:165]
    v_rcp_f32 v14, v14
    v_pk_mul_f32 v[218:219], v[218:219], v[166:167]
    v_pk_mul_f32 v[220:221], v[220:221], v[172:173]
    v_rcp_f32 v15, v15
    v_pk_mul_f32 v[222:223], v[222:223], v[174:175]
    v_exp_f32 v208, v208
    v_pk_mul_f32 v[144:145], v[144:145], v[0:1]
    v_pk_mul_f32 v[146:147], v[146:147], v[2:3]
    v_exp_f32 v209, v209
    v_pk_mul_f32 v[152:153], v[152:153], v[4:5]
    v_exp_f32 v210, v210
    v_pk_mul_f32 v[154:155], v[154:155], v[6:7]
    v_exp_f32 v211, v211
    v_pk_mul_f32 v[148:149], v[148:149], v[8:9]
    v_exp_f32 v212, v212
    v_pk_mul_f32 v[150:151], v[150:151], v[10:11]
    v_exp_f32 v213, v213
    v_pk_mul_f32 v[156:157], v[156:157], v[12:13]
    v_exp_f32 v214, v214
    v_pk_mul_f32 v[158:159], v[158:159], v[14:15]
    v_exp_f32 v215, v215
    v_cvt_pk_bf16_f32 v232, v144, v145
    v_exp_f32 v216, v216
    v_cvt_pk_bf16_f32 v233, v146, v147
    v_cvt_pk_bf16_f32 v234, v152, v153
    v_exp_f32 v217, v217
    v_cvt_pk_bf16_f32 v235, v154, v155
    v_exp_f32 v218, v218
    buffer_store_dwordx4 v[232:235], v225, s[16:19], s41 offen  sc1
    v_exp_f32 v219, v219
    v_cvt_pk_bf16_f32 v236, v148, v149
    v_exp_f32 v220, v220
    v_cvt_pk_bf16_f32 v237, v150, v151
    v_exp_f32 v221, v221
    v_cvt_pk_bf16_f32 v238, v156, v157
    v_exp_f32 v222, v222
    v_cvt_pk_bf16_f32 v239, v158, v159
    v_exp_f32 v223, v223
    buffer_store_dwordx4 v[236:239], v225, s[16:19], s41 offen offset:1024  sc1
    v_pk_add_f32 v[208:209], v[208:209], 1.0 op_sel_hi:[1,0]
    v_pk_add_f32 v[210:211], v[210:211], 1.0 op_sel_hi:[1,0]
    v_pk_add_f32 v[212:213], v[212:213], 1.0 op_sel_hi:[1,0]
    v_pk_add_f32 v[214:215], v[214:215], 1.0 op_sel_hi:[1,0]
    v_pk_add_f32 v[216:217], v[216:217], 1.0 op_sel_hi:[1,0]
    v_pk_add_f32 v[218:219], v[218:219], 1.0 op_sel_hi:[1,0]
    v_pk_add_f32 v[220:221], v[220:221], 1.0 op_sel_hi:[1,0]
    v_pk_add_f32 v[222:223], v[222:223], 1.0 op_sel_hi:[1,0]
    v_rcp_f32 v208, v208
    v_pk_mul_f32 v[0:1], v[176:177], v[176:177]
    v_pk_mul_f32 v[2:3], v[178:179], v[178:179]
    v_rcp_f32 v209, v209
    v_pk_mul_f32 v[4:5], v[184:185], v[184:185]
    v_rcp_f32 v210, v210
    v_pk_mul_f32 v[6:7], v[186:187], v[186:187]
    v_pk_mul_f32 v[8:9], v[180:181], v[180:181]
    v_rcp_f32 v211, v211
    v_pk_mul_f32 v[10:11], v[182:183], v[182:183]
    v_rcp_f32 v212, v212
    v_pk_mul_f32 v[12:13], v[188:189], v[188:189]
    v_pk_mul_f32 v[14:15], v[190:191], v[190:191]
    v_rcp_f32 v213, v213
    v_pk_fma_f32 v[0:1], v[0:1], v[226:227], v[226:227] op_sel:[0,0,1] op_sel_hi:[1,0,1]
    v_rcp_f32 v214, v214
    v_pk_fma_f32 v[2:3], v[2:3], v[226:227], v[226:227] op_sel:[0,0,1] op_sel_hi:[1,0,1]
    v_pk_fma_f32 v[4:5], v[4:5], v[226:227], v[226:227] op_sel:[0,0,1] op_sel_hi:[1,0,1]
    v_rcp_f32 v215, v215
    v_pk_fma_f32 v[6:7], v[6:7], v[226:227], v[226:227] op_sel:[0,0,1] op_sel_hi:[1,0,1]
    v_rcp_f32 v216, v216
    v_pk_fma_f32 v[8:9], v[8:9], v[226:227], v[226:227] op_sel:[0,0,1] op_sel_hi:[1,0,1]
    v_pk_fma_f32 v[10:11], v[10:11], v[226:227], v[226:227] op_sel:[0,0,1] op_sel_hi:[1,0,1]
    v_rcp_f32 v217, v217
    v_pk_fma_f32 v[12:13], v[12:13], v[226:227], v[226:227] op_sel:[0,0,1] op_sel_hi:[1,0,1]
    v_rcp_f32 v218, v218
    v_pk_fma_f32 v[14:15], v[14:15], v[226:227], v[226:227] op_sel:[0,0,1] op_sel_hi:[1,0,1]
    v_pk_mul_f32 v[0:1], v[0:1], v[176:177]
    v_rcp_f32 v219, v219
    v_pk_mul_f32 v[2:3], v[2:3], v[178:179]
    v_rcp_f32 v220, v220
    v_pk_mul_f32 v[4:5], v[4:5], v[184:185]
    v_pk_mul_f32 v[6:7], v[6:7], v[186:187]
    v_rcp_f32 v221, v221
    v_pk_mul_f32 v[8:9], v[8:9], v[180:181]
    v_rcp_f32 v222, v222
    v_pk_mul_f32 v[10:11], v[10:11], v[182:183]
    v_pk_mul_f32 v[12:13], v[12:13], v[188:189]
    v_rcp_f32 v223, v223
    v_pk_mul_f32 v[14:15], v[14:15], v[190:191]
    v_exp_f32 v0, v0
    v_pk_mul_f32 v[160:161], v[160:161], v[208:209]
    v_pk_mul_f32 v[162:163], v[162:163], v[210:211]
    v_exp_f32 v1, v1
    v_pk_mul_f32 v[168:169], v[168:169], v[212:213]
    v_exp_f32 v2, v2
    v_pk_mul_f32 v[170:171], v[170:171], v[214:215]
    v_exp_f32 v3, v3
    v_pk_mul_f32 v[164:165], v[164:165], v[216:217]
    v_exp_f32 v4, v4
    v_pk_mul_f32 v[166:167], v[166:167], v[218:219]
    v_exp_f32 v5, v5
    v_pk_mul_f32 v[172:173], v[172:173], v[220:221]
    v_pk_mul_f32 v[174:175], v[174:175], v[222:223]
    v_exp_f32 v6, v6
    v_cvt_pk_bf16_f32 v240, v160, v161
    v_exp_f32 v7, v7
    v_cvt_pk_bf16_f32 v241, v162, v163
    v_exp_f32 v8, v8
    v_cvt_pk_bf16_f32 v242, v168, v169
    v_exp_f32 v9, v9
    v_cvt_pk_bf16_f32 v243, v170, v171
    v_exp_f32 v10, v10
    s_add_u32 s41, s41, 114688
    buffer_store_dwordx4 v[240:243], v225, s[16:19], s41 offen  sc1
    v_exp_f32 v11, v11
    v_cvt_pk_bf16_f32 v244, v164, v165
    v_exp_f32 v12, v12
    v_cvt_pk_bf16_f32 v245, v166, v167
    v_exp_f32 v13, v13
    v_cvt_pk_bf16_f32 v246, v172, v173
    v_exp_f32 v14, v14
    v_cvt_pk_bf16_f32 v247, v174, v175
    v_exp_f32 v15, v15
    buffer_store_dwordx4 v[244:247], v225, s[16:19], s41 offen offset:1024  sc1
    v_pk_add_f32 v[0:1], v[0:1], 1.0 op_sel_hi:[1,0]
    v_pk_add_f32 v[2:3], v[2:3], 1.0 op_sel_hi:[1,0]
    v_pk_add_f32 v[4:5], v[4:5], 1.0 op_sel_hi:[1,0]
    v_pk_add_f32 v[6:7], v[6:7], 1.0 op_sel_hi:[1,0]
    v_pk_add_f32 v[8:9], v[8:9], 1.0 op_sel_hi:[1,0]
    v_pk_add_f32 v[10:11], v[10:11], 1.0 op_sel_hi:[1,0]
    v_pk_add_f32 v[12:13], v[12:13], 1.0 op_sel_hi:[1,0]
    v_pk_add_f32 v[14:15], v[14:15], 1.0 op_sel_hi:[1,0]
    v_rcp_f32 v0, v0
    v_pk_mul_f32 v[208:209], v[192:193], v[192:193]
    v_pk_mul_f32 v[210:211], v[194:195], v[194:195]
    v_rcp_f32 v1, v1
    v_pk_mul_f32 v[212:213], v[200:201], v[200:201]
    v_rcp_f32 v2, v2
    v_pk_mul_f32 v[214:215], v[202:203], v[202:203]
    v_pk_mul_f32 v[216:217], v[196:197], v[196:197]
    v_rcp_f32 v3, v3
    v_pk_mul_f32 v[218:219], v[198:199], v[198:199]
    v_rcp_f32 v4, v4
    v_pk_mul_f32 v[220:221], v[204:205], v[204:205]
    v_pk_mul_f32 v[222:223], v[206:207], v[206:207]
    v_rcp_f32 v5, v5
    v_pk_fma_f32 v[208:209], v[208:209], v[226:227], v[226:227] op_sel:[0,0,1] op_sel_hi:[1,0,1]
    v_rcp_f32 v6, v6
    v_pk_fma_f32 v[210:211], v[210:211], v[226:227], v[226:227] op_sel:[0,0,1] op_sel_hi:[1,0,1]
    v_pk_fma_f32 v[212:213], v[212:213], v[226:227], v[226:227] op_sel:[0,0,1] op_sel_hi:[1,0,1]
    v_rcp_f32 v7, v7
    v_pk_fma_f32 v[214:215], v[214:215], v[226:227], v[226:227] op_sel:[0,0,1] op_sel_hi:[1,0,1]
    v_rcp_f32 v8, v8
    v_pk_fma_f32 v[216:217], v[216:217], v[226:227], v[226:227] op_sel:[0,0,1] op_sel_hi:[1,0,1]
    v_pk_fma_f32 v[218:219], v[218:219], v[226:227], v[226:227] op_sel:[0,0,1] op_sel_hi:[1,0,1]
    v_rcp_f32 v9, v9
    v_pk_fma_f32 v[220:221], v[220:221], v[226:227], v[226:227] op_sel:[0,0,1] op_sel_hi:[1,0,1]
    v_rcp_f32 v10, v10
    v_pk_fma_f32 v[222:223], v[222:223], v[226:227], v[226:227] op_sel:[0,0,1] op_sel_hi:[1,0,1]
    v_pk_mul_f32 v[208:209], v[208:209], v[192:193]
    v_rcp_f32 v11, v11
    v_pk_mul_f32 v[210:211], v[210:211], v[194:195]
    v_rcp_f32 v12, v12
    v_pk_mul_f32 v[212:213], v[212:213], v[200:201]
    v_pk_mul_f32 v[214:215], v[214:215], v[202:203]
    v_rcp_f32 v13, v13
    v_pk_mul_f32 v[216:217], v[216:217], v[196:197]
    v_rcp_f32 v14, v14
    v_pk_mul_f32 v[218:219], v[218:219], v[198:199]
    v_pk_mul_f32 v[220:221], v[220:221], v[204:205]
    v_rcp_f32 v15, v15
    v_pk_mul_f32 v[222:223], v[222:223], v[206:207]
    v_exp_f32 v208, v208
    v_pk_mul_f32 v[176:177], v[176:177], v[0:1]
    v_pk_mul_f32 v[178:179], v[178:179], v[2:3]
    v_exp_f32 v209, v209
    v_pk_mul_f32 v[184:185], v[184:185], v[4:5]
    v_exp_f32 v210, v210
    v_pk_mul_f32 v[186:187], v[186:187], v[6:7]
    v_exp_f32 v211, v211
    v_pk_mul_f32 v[180:181], v[180:181], v[8:9]
    v_exp_f32 v212, v212
    v_pk_mul_f32 v[182:183], v[182:183], v[10:11]
    v_exp_f32 v213, v213
    v_pk_mul_f32 v[188:189], v[188:189], v[12:13]
    v_pk_mul_f32 v[190:191], v[190:191], v[14:15]
    v_exp_f32 v214, v214
    v_cvt_pk_bf16_f32 v232, v176, v177
    v_exp_f32 v215, v215
    v_cvt_pk_bf16_f32 v233, v178, v179
    v_exp_f32 v216, v216
    v_cvt_pk_bf16_f32 v234, v184, v185
    v_exp_f32 v217, v217
    v_cvt_pk_bf16_f32 v235, v186, v187
    v_exp_f32 v218, v218
    s_add_u32 s41, s41, 114688
    buffer_store_dwordx4 v[232:235], v225, s[16:19], s41 offen  sc1
    v_exp_f32 v219, v219
    v_cvt_pk_bf16_f32 v236, v180, v181
    v_exp_f32 v220, v220
    v_cvt_pk_bf16_f32 v237, v182, v183
    v_exp_f32 v221, v221
    v_cvt_pk_bf16_f32 v238, v188, v189
    v_exp_f32 v222, v222
    v_cvt_pk_bf16_f32 v239, v190, v191
    v_exp_f32 v223, v223
    buffer_store_dwordx4 v[236:239], v225, s[16:19], s41 offen offset:1024  sc1
    v_pk_add_f32 v[208:209], v[208:209], 1.0 op_sel_hi:[1,0]
    v_pk_add_f32 v[210:211], v[210:211], 1.0 op_sel_hi:[1,0]
    v_pk_add_f32 v[212:213], v[212:213], 1.0 op_sel_hi:[1,0]
    v_pk_add_f32 v[214:215], v[214:215], 1.0 op_sel_hi:[1,0]
    v_pk_add_f32 v[216:217], v[216:217], 1.0 op_sel_hi:[1,0]
    v_pk_add_f32 v[218:219], v[218:219], 1.0 op_sel_hi:[1,0]
    v_pk_add_f32 v[220:221], v[220:221], 1.0 op_sel_hi:[1,0]
    v_pk_add_f32 v[222:223], v[222:223], 1.0 op_sel_hi:[1,0]
    v_rcp_f32 v208, v208
    v_rcp_f32 v209, v209
    v_rcp_f32 v210, v210
    v_rcp_f32 v211, v211
    v_rcp_f32 v212, v212
    v_rcp_f32 v213, v213
    v_rcp_f32 v214, v214
    v_rcp_f32 v215, v215
    v_rcp_f32 v216, v216
    v_rcp_f32 v217, v217
    v_rcp_f32 v218, v218
    v_rcp_f32 v219, v219
    v_rcp_f32 v220, v220
    v_rcp_f32 v221, v221
    v_rcp_f32 v222, v222
    v_rcp_f32 v223, v223
    v_pk_mul_f32 v[192:193], v[192:193], v[208:209]
    v_pk_mul_f32 v[194:195], v[194:195], v[210:211]
    v_pk_mul_f32 v[200:201], v[200:201], v[212:213]
    v_pk_mul_f32 v[202:203], v[202:203], v[214:215]
    v_pk_mul_f32 v[196:197], v[196:197], v[216:217]
    v_pk_mul_f32 v[198:199], v[198:199], v[218:219]
    v_pk_mul_f32 v[204:205], v[204:205], v[220:221]
    v_pk_mul_f32 v[206:207], v[206:207], v[222:223]
    v_cvt_pk_bf16_f32 v240, v192, v193
    v_cvt_pk_bf16_f32 v241, v194, v195
    v_cvt_pk_bf16_f32 v242, v200, v201
    v_cvt_pk_bf16_f32 v243, v202, v203
    s_add_u32 s41, s41, 114688
    buffer_store_dwordx4 v[240:243], v225, s[16:19], s41 offen  sc1
    v_cvt_pk_bf16_f32 v244, v196, v197
    v_cvt_pk_bf16_f32 v245, v198, v199
    v_cvt_pk_bf16_f32 v246, v204, v205
    v_cvt_pk_bf16_f32 v247, v206, v207
    buffer_store_dwordx4 v[244:247], v225, s[16:19], s41 offen offset:1024  sc1
    s_mul_i32 s41, s51, 7168
    s_add_u32 s47, s48, s41
    s_add_u32 s46, s47, 4096
    s_mov_b32 s96, 0
L_p1z_gather:
    buffer_load_dwordx4 v[0:3], v225, s[16:19], s47 offen sc1
    buffer_load_dwordx4 v[4:7], v225, s[16:19], s47 offen offset:1024 sc1
    buffer_load_dwordx4 v[8:11], v225, s[16:19], s47 offen offset:2048 sc1
    buffer_load_dwordx4 v[12:15], v225, s[16:19], s47 offen offset:3072 sc1
    buffer_load_dwordx4 v[208:211], v225, s[16:19], s46 offen sc1
    buffer_load_dwordx4 v[212:215], v225, s[16:19], s46 offen offset:1024 sc1
    buffer_load_dwordx4 v[216:219], v225, s[16:19], s46 offen offset:2048 sc1
    s_waitcnt vmcnt(0)
    v_max3_u32 v229, v0, v1, v2
    v_max3_u32 v229, v229, v3, v4
    v_max3_u32 v229, v229, v5, v6
    v_max3_u32 v229, v229, v7, v8
    v_max3_u32 v229, v229, v9, v10
    v_max3_u32 v229, v229, v11, v12
    v_max3_u32 v229, v229, v13, v14
    v_max3_u32 v229, v229, v15, v208
    v_max3_u32 v229, v229, v209, v210
    v_max3_u32 v229, v229, v211, v212
    v_max3_u32 v229, v229, v213, v214
    v_max3_u32 v229, v229, v215, v216
    v_max3_u32 v229, v229, v217, v218
    v_max_u32 v229, v229, v219
    v_cmp_eq_u32 vcc, -1, v229
    s_nop 0
    s_cmp_eq_u64 vcc, 0
    s_cbranch_scc1 L_p1z_gather_out
    s_add_u32 s96, s96, 1
    s_cmp_lt_u32 s96, 0x40000
    s_cbranch_scc1 L_p1z_gather
L_p1z_gather_out:
L_pad_p1z_0:
    s_cbranch_execz L_pad_p1z_4
    v_pk_add_f32 v[0:1], v[0:1], v[4:5]
    v_pk_add_f32 v[2:3], v[2:3], v[6:7]
    v_pk_add_f32 v[0:1], v[0:1], v[8:9]
    v_pk_add_f32 v[2:3], v[2:3], v[10:11]
    v_pk_add_f32 v[0:1], v[0:1], v[12:13]
    v_pk_add_f32 v[2:3], v[2:3], v[14:15]
    v_pk_add_f32 v[0:1], v[0:1], v[208:209]
    v_pk_add_f32 v[2:3], v[2:3], v[210:211]
    v_pk_add_f32 v[0:1], v[0:1], v[212:213]
    v_pk_add_f32 v[2:3], v[2:3], v[214:215]
    v_pk_add_f32 v[0:1], v[0:1], v[216:217]
    v_pk_add_f32 v[2:3], v[2:3], v[218:219]
    ds_write_b128 v228, v[0:3] offset:4096
    v_and_b32 v229, 15, v224
    v_lshlrev_b32 v228, 4, v229
    s_lshl_b32 s41, s50, 11
    s_add_u32 s41, s41, 38912
    v_add_u32 v228, s41, v228
    s_waitcnt lgkmcnt(0)
    s_barrier
    ds_read_b128 v[0:3], v228 offset:0
    ds_read_b128 v[4:7], v228 offset:256
    ds_read_b128 v[8:11], v228 offset:512
    ds_read_b128 v[12:15], v228 offset:768
    ds_read_b128 v[208:211], v228 offset:1024
    ds_read_b128 v[212:215], v228 offset:1280
    ds_read_b128 v[216:219], v228 offset:1536
    ds_read_b128 v[220:223], v228 offset:1792
    v_bfe_u32 v230, v224, 4, 1
    v_and_b32 v231, 1, v229
    v_lshl_or_b32 v230, v231, 1, v230
    v_bfe_u32 v231, v229, 2, 1
    v_lshl_or_b32 v230, v231, 2, v230
    v_bfe_u32 v231, v229, 1, 1
    v_lshl_or_b32 v230, v231, 3, v230
    v_lshrrev_b32 v231, 3, v229
    v_lshl_or_b32 v230, v231, 4, v230
    v_lshlrev_b32 v230, 5, v230
    v_lshrrev_b32 v231, 5, v224
    v_lshl_or_b32 v230, v231, 4, v230
    s_lshl_b32 s41, s26, 3
    s_lshl_b32 s42, s51, 2
    s_add_u32 s41, s41, s42
    s_lshl_b32 s41, s41, 16
    s_lshl_b32 s42, s50, 7
    s_add_u32 s42, s42, s27
    s_lshl_b32 s42, s42, 5
    s_add_u32 s41, s41, s42
    s_add_u32 s41, s41, 0x1400000
    s_waitcnt lgkmcnt(0)
    v_pk_add_f32 v[0:1], v[0:1], v[208:209]
    v_pk_add_f32 v[2:3], v[2:3], v[210:211]
    v_pk_add_f32 v[4:5], v[4:5], v[212:213]
    v_pk_add_f32 v[6:7], v[6:7], v[214:215]
    v_pk_add_f32 v[8:9], v[8:9], v[216:217]
    v_pk_add_f32 v[10:11], v[10:11], v[218:219]
    v_pk_add_f32 v[12:13], v[12:13], v[220:221]
    v_pk_add_f32 v[14:15], v[14:15], v[222:223]
    s_mov_b32 s44, 0x3a124925
    s_mov_b32 s45, 0x3a124925
    v_pk_mul_f32 v[0:1], v[0:1], s[44:45]
    v_pk_mul_f32 v[2:3], v[2:3], s[44:45]
    v_pk_mul_f32 v[4:5], v[4:5], s[44:45]
L_pad_p1z_1:
    s_cbranch_execz L_pad_p1z_5
    v_pk_mul_f32 v[6:7], v[6:7], s[44:45]
    v_pk_mul_f32 v[8:9], v[8:9], s[44:45]
    v_pk_mul_f32 v[10:11], v[10:11], s[44:45]
    v_pk_mul_f32 v[12:13], v[12:13], s[44:45]
    v_pk_mul_f32 v[14:15], v[14:15], s[44:45]
    v_fma_f32 v8, -v0, v0, v8
    v_fma_f32 v9, -v1, v1, v9
    v_fma_f32 v10, -v2, v2, v10
    v_fma_f32 v11, -v3, v3, v11
    v_fma_f32 v12, -v4, v4, v12
    v_fma_f32 v13, -v5, v5, v13
    v_fma_f32 v14, -v6, v6, v14
    v_fma_f32 v15, -v7, v7, v15
    v_max_f32 v8, 0, v8
    v_max_f32 v9, 0, v9
    v_max_f32 v10, 0, v10
    v_max_f32 v11, 0, v11
    v_max_f32 v12, 0, v12
    v_max_f32 v13, 0, v13
    v_max_f32 v14, 0, v14
    v_max_f32 v15, 0, v15
    v_add_f32 v8, 0x3727c5ac, v8
    v_add_f32 v9, 0x3727c5ac, v9
    v_add_f32 v10, 0x3727c5ac, v10
    v_add_f32 v11, 0x3727c5ac, v11
    v_add_f32 v12, 0x3727c5ac, v12
    v_add_f32 v13, 0x3727c5ac, v13
    v_add_f32 v14, 0x3727c5ac, v14
    v_add_f32 v15, 0x3727c5ac, v15
    v_rsq_f32 v208, v8
    v_rsq_f32 v210, v9
    v_rsq_f32 v212, v10
    v_rsq_f32 v214, v11
    v_rsq_f32 v216, v12
    v_rsq_f32 v218, v13
    v_rsq_f32 v220, v14
    v_rsq_f32 v222, v15
    v_mul_f32 v209, v0, v208
    v_mul_f32 v211, v1, v210
    v_mul_f32 v213, v2, v212
    v_mul_f32 v215, v3, v214
    v_mul_f32 v217, v4, v216
    v_mul_f32 v219, v5, v218
    v_mul_f32 v221, v6, v220
    v_mul_f32 v223, v7, v222
    v_pk_fma_f32 v[16:17], v[16:17], v[208:209], v[208:209] op_sel:[0,0,1] op_sel_hi:[1,0,1] neg_lo:[0,0,1] neg_hi:[0,0,1]
    v_pk_fma_f32 v[18:19], v[18:19], v[208:209], v[208:209] op_sel:[0,0,1] op_sel_hi:[1,0,1] neg_lo:[0,0,1] neg_hi:[0,0,1]
    v_pk_fma_f32 v[32:33], v[32:33], v[210:211], v[210:211] op_sel:[0,0,1] op_sel_hi:[1,0,1] neg_lo:[0,0,1] neg_hi:[0,0,1]
    v_pk_fma_f32 v[34:35], v[34:35], v[210:211], v[210:211] op_sel:[0,0,1] op_sel_hi:[1,0,1] neg_lo:[0,0,1] neg_hi:[0,0,1]
    v_cvt_pk_bf16_f32 v232, v16, v17
    v_cvt_pk_bf16_f32 v233, v18, v19
    v_cvt_pk_bf16_f32 v234, v32, v33
    v_cvt_pk_bf16_f32 v235, v34, v35
    s_nop 0
    v_permlane16_swap_b32 v232, v234
    v_permlane16_swap_b32 v233, v235
    buffer_store_dwordx4 v[232:235], v230, s[16:19], s41 offen  sc1
    v_pk_fma_f32 v[48:49], v[48:49], v[212:213], v[212:213] op_sel:[0,0,1] op_sel_hi:[1,0,1] neg_lo:[0,0,1] neg_hi:[0,0,1]
    v_pk_fma_f32 v[50:51], v[50:51], v[212:213], v[212:213] op_sel:[0,0,1] op_sel_hi:[1,0,1] neg_lo:[0,0,1] neg_hi:[0,0,1]
    v_pk_fma_f32 v[64:65], v[64:65], v[214:215], v[214:215] op_sel:[0,0,1] op_sel_hi:[1,0,1] neg_lo:[0,0,1] neg_hi:[0,0,1]
    v_pk_fma_f32 v[66:67], v[66:67], v[214:215], v[214:215] op_sel:[0,0,1] op_sel_hi:[1,0,1] neg_lo:[0,0,1] neg_hi:[0,0,1]
    v_cvt_pk_bf16_f32 v236, v48, v49
    v_cvt_pk_bf16_f32 v237, v50, v51
    v_cvt_pk_bf16_f32 v238, v64, v65
    v_cvt_pk_bf16_f32 v239, v66, v67
    s_nop 0
    v_permlane16_swap_b32 v236, v238
L_pad_p1z_2:
    s_cbranch_execz L_pad_p1z_6
    v_permlane16_swap_b32 v237, v239
    buffer_store_dwordx4 v[236:239], v230, s[16:19], s41 offen offset:1024  sc1
    v_pk_fma_f32 v[80:81], v[80:81], v[216:217], v[216:217] op_sel:[0,0,1] op_sel_hi:[1,0,1] neg_lo:[0,0,1] neg_hi:[0,0,1]
    v_pk_fma_f32 v[82:83], v[82:83], v[216:217], v[216:217] op_sel:[0,0,1] op_sel_hi:[1,0,1] neg_lo:[0,0,1] neg_hi:[0,0,1]
    v_pk_fma_f32 v[96:97], v[96:97], v[218:219], v[218:219] op_sel:[0,0,1] op_sel_hi:[1,0,1] neg_lo:[0,0,1] neg_hi:[0,0,1]
    v_pk_fma_f32 v[98:99], v[98:99], v[218:219], v[218:219] op_sel:[0,0,1] op_sel_hi:[1,0,1] neg_lo:[0,0,1] neg_hi:[0,0,1]
    v_cvt_pk_bf16_f32 v240, v80, v81
    v_cvt_pk_bf16_f32 v241, v82, v83
    v_cvt_pk_bf16_f32 v242, v96, v97
    v_cvt_pk_bf16_f32 v243, v98, v99
    s_nop 0
    v_permlane16_swap_b32 v240, v242
    v_permlane16_swap_b32 v241, v243
    buffer_store_dwordx4 v[240:243], v230, s[16:19], s41 offen offset:2048  sc1
    v_pk_fma_f32 v[112:113], v[112:113], v[220:221], v[220:221] op_sel:[0,0,1] op_sel_hi:[1,0,1] neg_lo:[0,0,1] neg_hi:[0,0,1]
    v_pk_fma_f32 v[114:115], v[114:115], v[220:221], v[220:221] op_sel:[0,0,1] op_sel_hi:[1,0,1] neg_lo:[0,0,1] neg_hi:[0,0,1]
    v_pk_fma_f32 v[128:129], v[128:129], v[222:223], v[222:223] op_sel:[0,0,1] op_sel_hi:[1,0,1] neg_lo:[0,0,1] neg_hi:[0,0,1]
    v_pk_fma_f32 v[130:131], v[130:131], v[222:223], v[222:223] op_sel:[0,0,1] op_sel_hi:[1,0,1] neg_lo:[0,0,1] neg_hi:[0,0,1]
    v_cvt_pk_bf16_f32 v244, v112, v113
    v_cvt_pk_bf16_f32 v245, v114, v115
    v_cvt_pk_bf16_f32 v246, v128, v129
    v_cvt_pk_bf16_f32 v247, v130, v131
    s_nop 0
    v_permlane16_swap_b32 v244, v246
    v_permlane16_swap_b32 v245, v247
    buffer_store_dwordx4 v[244:247], v230, s[16:19], s41 offen offset:3072  sc1
    s_add_u32 s41, s41, 65536
    v_pk_fma_f32 v[20:21], v[20:21], v[208:209], v[208:209] op_sel:[0,0,1] op_sel_hi:[1,0,1] neg_lo:[0,0,1] neg_hi:[0,0,1]
    v_pk_fma_f32 v[22:23], v[22:23], v[208:209], v[208:209] op_sel:[0,0,1] op_sel_hi:[1,0,1] neg_lo:[0,0,1] neg_hi:[0,0,1]
    v_pk_fma_f32 v[36:37], v[36:37], v[210:211], v[210:211] op_sel:[0,0,1] op_sel_hi:[1,0,1] neg_lo:[0,0,1] neg_hi:[0,0,1]
    v_pk_fma_f32 v[38:39], v[38:39], v[210:211], v[210:211] op_sel:[0,0,1] op_sel_hi:[1,0,1] neg_lo:[0,0,1] neg_hi:[0,0,1]
    v_cvt_pk_bf16_f32 v248, v20, v21
    v_cvt_pk_bf16_f32 v249, v22, v23
    v_cvt_pk_bf16_f32 v250, v36, v37
    v_cvt_pk_bf16_f32 v251, v38, v39
    s_nop 0
    v_permlane16_swap_b32 v248, v250
    v_permlane16_swap_b32 v249, v251
    buffer_store_dwordx4 v[248:251], v230, s[16:19], s41 offen  sc1
    v_pk_fma_f32 v[52:53], v[52:53], v[212:213], v[212:213] op_sel:[0,0,1] op_sel_hi:[1,0,1] neg_lo:[0,0,1] neg_hi:[0,0,1]
    v_pk_fma_f32 v[54:55], v[54:55], v[212:213], v[212:213] op_sel:[0,0,1] op_sel_hi:[1,0,1] neg_lo:[0,0,1] neg_hi:[0,0,1]
    v_pk_fma_f32 v[68:69], v[68:69], v[214:215], v[214:215] op_sel:[0,0,1] op_sel_hi:[1,0,1] neg_lo:[0,0,1] neg_hi:[0,0,1]
    v_pk_fma_f32 v[70:71], v[70:71], v[214:215], v[214:215] op_sel:[0,0,1] op_sel_hi:[1,0,1] neg_lo:[0,0,1] neg_hi:[0,0,1]
    v_cvt_pk_bf16_f32 v232, v52, v53
    v_cvt_pk_bf16_f32 v233, v54, v55
    v_cvt_pk_bf16_f32 v234, v68, v69
    v_cvt_pk_bf16_f32 v235, v70, v71
    s_nop 0
    v_permlane16_swap_b32 v232, v234
    v_permlane16_swap_b32 v233, v235
    buffer_store_dwordx4 v[232:235], v230, s[16:19], s41 offen offset:1024  sc1
    v_pk_fma_f32 v[84:85], v[84:85], v[216:217], v[216:217] op_sel:[0,0,1] op_sel_hi:[1,0,1] neg_lo:[0,0,1] neg_hi:[0,0,1]
    v_pk_fma_f32 v[86:87], v[86:87], v[216:217], v[216:217] op_sel:[0,0,1] op_sel_hi:[1,0,1] neg_lo:[0,0,1] neg_hi:[0,0,1]
    v_pk_fma_f32 v[100:101], v[100:101], v[218:219], v[218:219] op_sel:[0,0,1] op_sel_hi:[1,0,1] neg_lo:[0,0,1] neg_hi:[0,0,1]
    v_pk_fma_f32 v[102:103], v[102:103], v[218:219], v[218:219] op_sel:[0,0,1] op_sel_hi:[1,0,1] neg_lo:[0,0,1] neg_hi:[0,0,1]
    v_cvt_pk_bf16_f32 v236, v84, v85
    v_cvt_pk_bf16_f32 v237, v86, v87
    v_cvt_pk_bf16_f32 v238, v100, v101
    v_cvt_pk_bf16_f32 v239, v102, v103
L_pad_p1z_3:
    s_cbranch_execz L_pad_p1z_7
    s_nop 0
    v_permlane16_swap_b32 v236, v238
    v_permlane16_swap_b32 v237, v239
    buffer_store_dwordx4 v[236:239], v230, s[16:19], s41 offen offset:2048  sc1
    v_pk_fma_f32 v[116:117], v[116:117], v[220:221], v[220:221] op_sel:[0,0,1] op_sel_hi:[1,0,1] neg_lo:[0,0,1] neg_hi:[0,0,1]
    v_pk_fma_f32 v[118:119], v[118:119], v[220:221], v[220:221] op_sel:[0,0,1] op_sel_hi:[1,0,1] neg_lo:[0,0,1] neg_hi:[0,0,1]
    v_pk_fma_f32 v[132:133], v[132:133], v[222:223], v[222:223] op_sel:[0,0,1] op_sel_hi:[1,0,1] neg_lo:[0,0,1] neg_hi:[0,0,1]
    v_pk_fma_f32 v[134:135], v[134:135], v[222:223], v[222:223] op_sel:[0,0,1] op_sel_hi:[1,0,1] neg_lo:[0,0,1] neg_hi:[0,0,1]
    v_cvt_pk_bf16_f32 v240, v116, v117
    v_cvt_pk_bf16_f32 v241, v118, v119
    v_cvt_pk_bf16_f32 v242, v132, v133
    v_cvt_pk_bf16_f32 v243, v134, v135
    s_nop 0
    v_permlane16_swap_b32 v240, v242
    v_permlane16_swap_b32 v241, v243
    buffer_store_dwordx4 v[240:243], v230, s[16:19], s41 offen offset:3072  sc1
    s_add_u32 s41, s41, 65536
    v_pk_fma_f32 v[24:25], v[24:25], v[208:209], v[208:209] op_sel:[0,0,1] op_sel_hi:[1,0,1] neg_lo:[0,0,1] neg_hi:[0,0,1]
    v_pk_fma_f32 v[26:27], v[26:27], v[208:209], v[208:209] op_sel:[0,0,1] op_sel_hi:[1,0,1] neg_lo:[0,0,1] neg_hi:[0,0,1]
    v_pk_fma_f32 v[40:41], v[40:41], v[210:211], v[210:211] op_sel:[0,0,1] op_sel_hi:[1,0,1] neg_lo:[0,0,1] neg_hi:[0,0,1]
    v_pk_fma_f32 v[42:43], v[42:43], v[210:211], v[210:211] op_sel:[0,0,1] op_sel_hi:[1,0,1] neg_lo:[0,0,1] neg_hi:[0,0,1]
    v_cvt_pk_bf16_f32 v244, v24, v25
    v_cvt_pk_bf16_f32 v245, v26, v27
    v_cvt_pk_bf16_f32 v246, v40, v41
    v_cvt_pk_bf16_f32 v247, v42, v43
    s_nop 0
    v_permlane16_swap_b32 v244, v246
    v_permlane16_swap_b32 v245, v247
    buffer_store_dwordx4 v[244:247], v230, s[16:19], s41 offen  sc1
    v_pk_fma_f32 v[56:57], v[56:57], v[212:213], v[212:213] op_sel:[0,0,1] op_sel_hi:[1,0,1] neg_lo:[0,0,1] neg_hi:[0,0,1]
    v_pk_fma_f32 v[58:59], v[58:59], v[212:213], v[212:213] op_sel:[0,0,1] op_sel_hi:[1,0,1] neg_lo:[0,0,1] neg_hi:[0,0,1]
    v_pk_fma_f32 v[72:73], v[72:73], v[214:215], v[214:215] op_sel:[0,0,1] op_sel_hi:[1,0,1] neg_lo:[0,0,1] neg_hi:[0,0,1]
    v_pk_fma_f32 v[74:75], v[74:75], v[214:215], v[214:215] op_sel:[0,0,1] op_sel_hi:[1,0,1] neg_lo:[0,0,1] neg_hi:[0,0,1]
    v_cvt_pk_bf16_f32 v248, v56, v57
    v_cvt_pk_bf16_f32 v249, v58, v59
    v_cvt_pk_bf16_f32 v250, v72, v73
    v_cvt_pk_bf16_f32 v251, v74, v75
    s_nop 0
    v_permlane16_swap_b32 v248, v250
    v_permlane16_swap_b32 v249, v251
    buffer_store_dwordx4 v[248:251], v230, s[16:19], s41 offen offset:1024  sc1
    v_pk_fma_f32 v[88:89], v[88:89], v[216:217], v[216:217] op_sel:[0,0,1] op_sel_hi:[1,0,1] neg_lo:[0,0,1] neg_hi:[0,0,1]
    v_pk_fma_f32 v[90:91], v[90:91], v[216:217], v[216:217] op_sel:[0,0,1] op_sel_hi:[1,0,1] neg_lo:[0,0,1] neg_hi:[0,0,1]
    v_pk_fma_f32 v[104:105], v[104:105], v[218:219], v[218:219] op_sel:[0,0,1] op_sel_hi:[1,0,1] neg_lo:[0,0,1] neg_hi:[0,0,1]
    v_pk_fma_f32 v[106:107], v[106:107], v[218:219], v[218:219] op_sel:[0,0,1] op_sel_hi:[1,0,1] neg_lo:[0,0,1] neg_hi:[0,0,1]
    v_cvt_pk_bf16_f32 v232, v88, v89
    v_cvt_pk_bf16_f32 v233, v90, v91
    v_cvt_pk_bf16_f32 v234, v104, v105
    v_cvt_pk_bf16_f32 v235, v106, v107
    s_nop 0
    v_permlane16_swap_b32 v232, v234
    v_permlane16_swap_b32 v233, v235
    buffer_store_dwordx4 v[232:235], v230, s[16:19], s41 offen offset:2048  sc1
    v_pk_fma_f32 v[120:121], v[120:121], v[220:221], v[220:221] op_sel:[0,0,1] op_sel_hi:[1,0,1] neg_lo:[0,0,1] neg_hi:[0,0,1]
    v_pk_fma_f32 v[122:123], v[122:123], v[220:221], v[220:221] op_sel:[0,0,1] op_sel_hi:[1,0,1] neg_lo:[0,0,1] neg_hi:[0,0,1]
    v_pk_fma_f32 v[136:137], v[136:137], v[222:223], v[222:223] op_sel:[0,0,1] op_sel_hi:[1,0,1] neg_lo:[0,0,1] neg_hi:[0,0,1]
    v_pk_fma_f32 v[138:139], v[138:139], v[222:223], v[222:223] op_sel:[0,0,1] op_sel_hi:[1,0,1] neg_lo:[0,0,1] neg_hi:[0,0,1]
    v_cvt_pk_bf16_f32 v236, v120, v121
    v_cvt_pk_bf16_f32 v237, v122, v123
    v_cvt_pk_bf16_f32 v238, v136, v137
    v_cvt_pk_bf16_f32 v239, v138, v139
L_pad_p1z_4:
    s_cbranch_execz L_pad_p1z_8
    s_nop 0
    v_permlane16_swap_b32 v236, v238
    v_permlane16_swap_b32 v237, v239
    buffer_store_dwordx4 v[236:239], v230, s[16:19], s41 offen offset:3072  sc1
    s_add_u32 s41, s41, 65536
    v_pk_fma_f32 v[28:29], v[28:29], v[208:209], v[208:209] op_sel:[0,0,1] op_sel_hi:[1,0,1] neg_lo:[0,0,1] neg_hi:[0,0,1]
    v_pk_fma_f32 v[30:31], v[30:31], v[208:209], v[208:209] op_sel:[0,0,1] op_sel_hi:[1,0,1] neg_lo:[0,0,1] neg_hi:[0,0,1]
    v_pk_fma_f32 v[44:45], v[44:45], v[210:211], v[210:211] op_sel:[0,0,1] op_sel_hi:[1,0,1] neg_lo:[0,0,1] neg_hi:[0,0,1]
    v_pk_fma_f32 v[46:47], v[46:47], v[210:211], v[210:211] op_sel:[0,0,1] op_sel_hi:[1,0,1] neg_lo:[0,0,1] neg_hi:[0,0,1]
    v_cvt_pk_bf16_f32 v240, v28, v29
    v_cvt_pk_bf16_f32 v241, v30, v31
    v_cvt_pk_bf16_f32 v242, v44, v45
    v_cvt_pk_bf16_f32 v243, v46, v47
    s_nop 0
    v_permlane16_swap_b32 v240, v242
    v_permlane16_swap_b32 v241, v243
    buffer_store_dwordx4 v[240:243], v230, s[16:19], s41 offen  sc1
    v_pk_fma_f32 v[60:61], v[60:61], v[212:213], v[212:213] op_sel:[0,0,1] op_sel_hi:[1,0,1] neg_lo:[0,0,1] neg_hi:[0,0,1]
    v_pk_fma_f32 v[62:63], v[62:63], v[212:213], v[212:213] op_sel:[0,0,1] op_sel_hi:[1,0,1] neg_lo:[0,0,1] neg_hi:[0,0,1]
    v_pk_fma_f32 v[76:77], v[76:77], v[214:215], v[214:215] op_sel:[0,0,1] op_sel_hi:[1,0,1] neg_lo:[0,0,1] neg_hi:[0,0,1]
    v_pk_fma_f32 v[78:79], v[78:79], v[214:215], v[214:215] op_sel:[0,0,1] op_sel_hi:[1,0,1] neg_lo:[0,0,1] neg_hi:[0,0,1]
    v_cvt_pk_bf16_f32 v244, v60, v61
    v_cvt_pk_bf16_f32 v245, v62, v63
    v_cvt_pk_bf16_f32 v246, v76, v77
    v_cvt_pk_bf16_f32 v247, v78, v79
    s_nop 0
    v_permlane16_swap_b32 v244, v246
    v_permlane16_swap_b32 v245, v247
    buffer_store_dwordx4 v[244:247], v230, s[16:19], s41 offen offset:1024  sc1
    v_pk_fma_f32 v[92:93], v[92:93], v[216:217], v[216:217] op_sel:[0,0,1] op_sel_hi:[1,0,1] neg_lo:[0,0,1] neg_hi:[0,0,1]
    v_pk_fma_f32 v[94:95], v[94:95], v[216:217], v[216:217] op_sel:[0,0,1] op_sel_hi:[1,0,1] neg_lo:[0,0,1] neg_hi:[0,0,1]
    v_pk_fma_f32 v[108:109], v[108:109], v[218:219], v[218:219] op_sel:[0,0,1] op_sel_hi:[1,0,1] neg_lo:[0,0,1] neg_hi:[0,0,1]
    v_pk_fma_f32 v[110:111], v[110:111], v[218:219], v[218:219] op_sel:[0,0,1] op_sel_hi:[1,0,1] neg_lo:[0,0,1] neg_hi:[0,0,1]
    v_cvt_pk_bf16_f32 v248, v92, v93
    v_cvt_pk_bf16_f32 v249, v94, v95
    v_cvt_pk_bf16_f32 v250, v108, v109
    v_cvt_pk_bf16_f32 v251, v110, v111
    s_nop 0
    v_permlane16_swap_b32 v248, v250
    v_permlane16_swap_b32 v249, v251
    buffer_store_dwordx4 v[248:251], v230, s[16:19], s41 offen offset:2048  sc1
    v_pk_fma_f32 v[124:125], v[124:125], v[220:221], v[220:221] op_sel:[0,0,1] op_sel_hi:[1,0,1] neg_lo:[0,0,1] neg_hi:[0,0,1]
    v_pk_fma_f32 v[126:127], v[126:127], v[220:221], v[220:221] op_sel:[0,0,1] op_sel_hi:[1,0,1] neg_lo:[0,0,1] neg_hi:[0,0,1]
    v_pk_fma_f32 v[140:141], v[140:141], v[222:223], v[222:223] op_sel:[0,0,1] op_sel_hi:[1,0,1] neg_lo:[0,0,1] neg_hi:[0,0,1]
    v_pk_fma_f32 v[142:143], v[142:143], v[222:223], v[222:223] op_sel:[0,0,1] op_sel_hi:[1,0,1] neg_lo:[0,0,1] neg_hi:[0,0,1]
    v_cvt_pk_bf16_f32 v232, v124, v125
    v_cvt_pk_bf16_f32 v233, v126, v127
    v_cvt_pk_bf16_f32 v234, v140, v141
    v_cvt_pk_bf16_f32 v235, v142, v143
    s_nop 0
    v_permlane16_swap_b32 v232, v234
    v_permlane16_swap_b32 v233, v235
    buffer_store_dwordx4 v[232:235], v230, s[16:19], s41 offen offset:3072  sc1
L_p1_done:
    v_mbcnt_lo_u32_b32 v123, -1, 0
    v_mbcnt_hi_u32_b32 v123, -1, v123
    s_and_b32 s41, s2, 7
    s_lshr_b32 s42, s2, 3
    s_lshr_b32 s25, s41, 1
    s_lshl_b32 s25, s25, 2
    s_and_b32 s43, s42, 3
    s_add_u32 s25, s25, s43
    s_and_b32 s26, s41, 1
    s_lshl_b32 s26, s26, 3
    s_lshr_b32 s43, s42, 2
    s_add_u32 s26, s26, s43
L_pad_p1z_5:
    s_cbranch_execz L_pad_p1z_9
    s_lshr_b32 s52, s25, 1
    s_lshl_b32 s52, s52, 7
    v_and_b32 v124, 31, v123
    v_lshlrev_b32 v124, 2, v124
    v_add_u32 v124, 0x1c60000, v124
    s_and_b32 s50, s24, 1
    s_lshr_b32 s51, s24, 1
    s_mov_b32 s38, s25
    s_mov_b32 s4, s66
    s_mov_b32 s5, s67
    s_mov_b32 s6, 0x800000
    s_mov_b32 s7, 0x20000
    s_add_u32 s8, s78, 0x1400000
    s_addc_u32 s9, s79, 0
    s_mov_b32 s10, 0x700000
    s_mov_b32 s11, 0x20000
    s_mov_b32 s12, s68
    s_mov_b32 s13, s69
    s_mov_b32 s14, 0x1000
    s_mov_b32 s15, 0x20000
    v_lshrrev_b32 v160, 3, v123
    v_and_b32 v161, 7, v123
    v_lshrrev_b32 v162, 1, v160
    v_xor_b32 v163, v161, v162
    v_xor_b32 v164, 4, v163
    v_lshlrev_b32 v160, 13, v160
    v_lshl_add_u32 v163, v163, 4, v160
    v_lshl_add_u32 v164, v164, 4, v160
    s_lshl_b32 s41, s25, 7
    s_lshl_b32 s42, s24, 5
    s_add_u32 s41, s41, s42
    s_lshl_b32 s41, s41, 12
    s_add_u32 s42, s41, 0
    v_add_u32 v112, s42, v163
    s_add_u32 s42, s41, 64512
    v_add_u32 v113, s42, v164
    s_add_u32 s42, s41, 2048
    v_add_u32 v114, s42, v163
    s_add_u32 s42, s41, 66560
    v_add_u32 v115, s42, v164
    s_mul_i32 s41, s24, 3584
    s_and_b32 s42, s26, 1
    s_mul_i32 s43, s26, 7
    v_lshl_add_u32 v160, v123, 4, s41
    v_mov_b32 v161, v160
    v_lshrrev_b32 v162, 11, v161
    v_and_b32 v161, 0x7ff, v161
    v_add_u32 v162, s42, v162
    v_cmp_eq_u32 vcc, 7, v162
    s_nop 1
    v_cndmask_b32 v162, v162, 0, vcc
    v_add_u32 v162, s43, v162
    v_lshl_add_u32 v161, v162, 16, v161
    v_mov_b32 v116, v161
    v_add_u32 v161, 1024, v160
    v_lshrrev_b32 v162, 11, v161
    v_and_b32 v161, 0x7ff, v161
    v_add_u32 v162, s42, v162
    v_cmp_eq_u32 vcc, 7, v162
    s_nop 1
    v_cndmask_b32 v162, v162, 0, vcc
    v_add_u32 v162, s43, v162
    v_lshl_add_u32 v161, v162, 16, v161
    v_subrev_u32 v117, 1024, v161
    v_add_u32 v161, 2048, v160
    v_lshrrev_b32 v162, 11, v161
    v_and_b32 v161, 0x7ff, v161
    v_add_u32 v162, s42, v162
    v_cmp_eq_u32 vcc, 7, v162
    s_nop 1
    v_cndmask_b32 v162, v162, 0, vcc
    v_add_u32 v162, s43, v162
    v_lshl_add_u32 v161, v162, 16, v161
    v_subrev_u32 v118, 2048, v161
    v_add_u32 v161, 3072, v160
    v_lshrrev_b32 v162, 11, v161
    v_and_b32 v161, 0x7ff, v161
    v_add_u32 v162, s42, v162
L_pad_p1z_6:
    s_cbranch_execz L_pad_p1z_10
    v_cmp_eq_u32 vcc, 7, v162
    s_nop 1
    v_cndmask_b32 v162, v162, 0, vcc
    v_add_u32 v162, s43, v162
    v_lshl_add_u32 v161, v162, 16, v161
    v_subrev_u32 v119, 3072, v161
    s_lshl_b32 s34, s24, 12
    s_add_u32 s35, s41, 16384
    v_and_b32 v165, 15, v123
    v_lshrrev_b32 v166, 4, v123
    v_bfe_u32 v167, v123, 2, 2
    v_and_b32 v168, 3, v123
    s_lshl_b32 s41, s51, 2
    v_add_u32 v160, s41, v166
    v_lshrrev_b32 v161, 1, v165
    v_xor_b32 v160, v160, v161
    v_lshlrev_b32 v160, 4, v160
    v_lshl_add_u32 v160, v165, 7, v160
    s_lshl_b32 s41, s50, 13
    s_lshl_b32 s42, s51, 12
    s_add_u32 s41, s41, s42
    v_add_u32 v120, s41, v160
    v_xor_b32 v121, 0x1000, v120
    v_lshrrev_b32 v160, 1, v166
    v_and_b32 v161, 1, v166
    v_lshl_add_u32 v161, v161, 2, v167
    v_lshl_add_u32 v160, v160, 4, v161
    v_lshlrev_b32 v160, 5, v160
    v_lshl_add_u32 v160, v168, 3, v160
    s_lshl_b32 s41, s51, 10
    s_add_u32 s41, s41, 16384
    v_add_u32 v122, s41, v160
    s_lshl_b32 s54, s25, 2
    s_lshl_b32 s41, s50, 1
    s_add_u32 s54, s54, s41
    s_add_u32 s54, s54, s51
    v_and_b32 v160, 1, v123
    v_mul_u32_u24 v160, 6, v160
    v_add_u32 v160, s43, v160
    v_bfe_u32 v160, v160, 3, 1
    v_and_b32 v161, 14, v123
    v_or_b32 v160, v160, v161
    s_mul_i32 s41, s26, 4352
    s_add_u32 s41, s41, 0x1c62000
    v_lshl_add_u32 v169, v160, 2, s41
    v_lshlrev_b32 v170, 4, v123
    v_lshlrev_b32 v171, 2, v165
    s_cmp_eq_u32 s87, 4
    s_cbranch_scc0 L_t1_rdy
    s_waitcnt vmcnt(0)
    s_barrier
    s_cmp_eq_u32 s24, 0
    s_cbranch_scc0 L_t1_rdy
    s_add_u32 s43, s85, 4352
    v_mov_b32 v252, s85
    v_writelane_b32 v252, s43, 1
    v_mov_b32 v253, 1
    s_mov_b64 exec, 3
    buffer_store_dword v253, v252, s[16:19], 0 offen sc1
    s_mov_b64 exec, -1
L_t1_rdy:
    s_mov_b32 s32, 0
    s_mov_b32 s39, -1
    s_add_u32 s39, s39, 1
    s_add_u32 s42, s39, s38
    s_and_b32 s42, s42, 3
    s_and_b32 s29, s39, -4
    s_or_b32 s29, s29, s42
    s_lshl_b32 s28, s29, 7
    s_lshl_b32 s29, s29, 11
    s_add_u32 m0, s32, s34
    s_nop 0
    buffer_load_dwordx4 v112, s[4:7], s28 offen lds
    buffer_load_dwordx4 v113, s[4:7], s28 offen offset:1024 lds
    buffer_load_dwordx4 v114, s[4:7], s28 offen offset:2048 lds
    buffer_load_dwordx4 v115, s[4:7], s28 offen offset:3072 lds
    s_mov_b32 s32, 30720
    s_mov_b32 s39, 0
    s_add_u32 s39, s39, 1
    s_add_u32 s42, s39, s38
    s_and_b32 s42, s42, 3
    s_and_b32 s29, s39, -4
    s_or_b32 s29, s29, s42
    s_lshl_b32 s28, s29, 7
L_pad_p1z_7:
    s_cbranch_execz L_pad_p1z_11
    s_lshl_b32 s29, s29, 11
    s_add_u32 m0, s32, s34
    s_nop 0
    buffer_load_dwordx4 v112, s[4:7], s28 offen lds
    buffer_load_dwordx4 v113, s[4:7], s28 offen offset:1024 lds
    buffer_load_dwordx4 v114, s[4:7], s28 offen offset:2048 lds
    buffer_load_dwordx4 v115, s[4:7], s28 offen offset:3072 lds
    s_mov_b32 s32, 61440
    s_mov_b32 s39, 1
    s_add_u32 s39, s39, 1
    s_add_u32 s42, s39, s38
    s_and_b32 s42, s42, 3
    s_and_b32 s29, s39, -4
    s_or_b32 s29, s29, s42
    s_lshl_b32 s28, s29, 7
    s_lshl_b32 s29, s29, 11
    s_add_u32 m0, s32, s34
    s_nop 0
    buffer_load_dwordx4 v112, s[4:7], s28 offen lds
    buffer_load_dwordx4 v113, s[4:7], s28 offen offset:1024 lds
    buffer_load_dwordx4 v114, s[4:7], s28 offen offset:2048 lds
    buffer_load_dwordx4 v115, s[4:7], s28 offen offset:3072 lds
    s_mov_b32 s32, 92160
    s_mov_b32 s39, 2
    s_add_u32 s39, s39, 1
    s_add_u32 s42, s39, s38
    s_and_b32 s42, s42, 3
    s_and_b32 s29, s39, -4
    s_or_b32 s29, s29, s42
    s_lshl_b32 s28, s29, 7
    s_lshl_b32 s29, s29, 11
    s_add_u32 m0, s32, s34
    s_nop 0
    buffer_load_dwordx4 v112, s[4:7], s28 offen lds
    buffer_load_dwordx4 v113, s[4:7], s28 offen offset:1024 lds
    buffer_load_dwordx4 v114, s[4:7], s28 offen offset:2048 lds
    buffer_load_dwordx4 v115, s[4:7], s28 offen offset:3072 lds
    s_mov_b32 s32, 122880
    s_mov_b32 s39, 3
    s_add_u32 s39, s39, 1
    s_add_u32 s42, s39, s38
    s_and_b32 s42, s42, 3
    s_and_b32 s29, s39, -4
    s_or_b32 s29, s29, s42
    s_lshl_b32 s28, s29, 7
    s_lshl_b32 s29, s29, 11
    s_add_u32 m0, s32, s34
    s_nop 0
    buffer_load_dwordx4 v112, s[4:7], s28 offen lds
    buffer_load_dwordx4 v113, s[4:7], s28 offen offset:1024 lds
    buffer_load_dwordx4 v114, s[4:7], s28 offen offset:2048 lds
    buffer_load_dwordx4 v115, s[4:7], s28 offen offset:3072 lds
    s_mul_i32 s41, s54, 112
    s_mul_i32 s42, s26, 7
    s_add_u32 s41, s41, s42
    s_lshl_b32 s41, s41, 10
    s_add_u32 s41, s41, 0xc00000
    s_and_b32 s43, s26, 1
    s_lshl_b32 s88, s43, 10
    s_add_u32 s88, s88, s41
    s_add_u32 s89, s88, 4096
    s_cmp_eq_u32 s43, 0
    s_cselect_b32 s90, 6144, 0
    s_add_u32 s90, s90, s41
    s_lshl_b32 s91, s54, 6
    s_lshl_b32 s55, s25, 2
    s_add_u32 s55, s55, s24
    s_mov_b32 s60, s60
    s_mov_b32 s61, s61
    s_mov_b32 s62, 0x200000
    s_mov_b32 s63, 0x20000
    s_mov_b32 s56, s78
    s_mov_b32 s57, s79
    s_mov_b32 s58, 0xb00000
    s_mov_b32 s59, 0x20000
    v_lshrrev_b32 v160, 3, v123
    v_and_b32 v161, 7, v123
    v_and_b32 v162, 6, v160
    v_xor_b32 v161, v161, v162
L_pad_p1z_8:
    s_cbranch_execz L_pad_p1z_12
    v_lshlrev_b32 v161, 4, v161
    v_lshl_add_u32 v161, v160, 11, v161
    s_lshl_b32 s43, s24, 15
    s_lshl_b32 s44, s26, 7
    s_add_u32 s43, s43, s44
    v_add_u32 v157, s43, v161
    v_add_u32 v158, 15360, v157
    s_mul_i32 s43, s55, 180224
    v_lshl_add_u32 v159, v123, 4, s43
    s_lshl_b32 s30, s24, 11
    s_add_u32 s30, s30, 61440
    s_mov_b32 s64, s74
    s_mov_b32 s65, s75
    s_mov_b32 s66, 0x400000
    s_mov_b32 s67, 0x20000
    v_lshrrev_b32 v160, 4, v123
    v_bfe_u32 v161, v123, 2, 2
    v_lshl_add_u32 v160, v160, 2, v161
    v_bfe_u32 v161, v160, 1, 2
    v_lshlrev_b32 v160, 7, v160
    v_and_b32 v162, 3, v123
    v_lshl_add_u32 v160, v162, 3, v160
    v_add_u32 v160, 61440, v160
    v_xor_b32 v162, 0, v161
    v_lshl_add_u32 v172, v162, 5, v160
    v_xor_b32 v162, 1, v161
    v_lshl_add_u32 v173, v162, 5, v160
    v_xor_b32 v162, 2, v161
    v_lshl_add_u32 v174, v162, 5, v160
    v_xor_b32 v162, 3, v161
    v_lshl_add_u32 v175, v162, 5, v160
    s_lshl_b32 s53, s25, 7
    s_add_u32 s43, s25, s26
    s_add_u32 s44, s43, 0
    s_and_b32 s44, s44, 3
    s_lshl_b32 s80, s44, 17
    s_lshl_b32 s84, s44, 12
    s_add_u32 s44, s43, 1
    s_and_b32 s44, s44, 3
    s_lshl_b32 s81, s44, 17
    s_lshl_b32 s85, s44, 12
    s_add_u32 s44, s43, 2
    s_and_b32 s44, s44, 3
    s_lshl_b32 s82, s44, 17
    s_lshl_b32 s86, s44, 12
    s_add_u32 s44, s43, 3
    s_and_b32 s44, s44, 3
    s_lshl_b32 s83, s44, 17
    s_lshl_b32 s87, s44, 12
    v_mov_b32 v0, 0
    v_mov_b32 v1, 0
    v_mov_b32 v2, 0
    v_mov_b32 v3, 0
    v_mov_b32 v4, 0
    v_mov_b32 v5, 0
    v_mov_b32 v6, 0
    v_mov_b32 v7, 0
    v_mov_b32 v8, 0
    v_mov_b32 v9, 0
    v_mov_b32 v10, 0
    v_mov_b32 v11, 0
    v_mov_b32 v12, 0
    v_mov_b32 v13, 0
    v_mov_b32 v14, 0
    v_mov_b32 v15, 0
    v_mov_b32 v16, 0
    v_mov_b32 v17, 0
    v_mov_b32 v18, 0
    v_mov_b32 v19, 0
    v_mov_b32 v20, 0
    v_mov_b32 v21, 0
    v_mov_b32 v22, 0
    v_mov_b32 v23, 0
    v_mov_b32 v24, 0
    v_mov_b32 v25, 0
    v_mov_b32 v26, 0
    v_mov_b32 v27, 0
    v_mov_b32 v28, 0
    v_mov_b32 v29, 0
    v_mov_b32 v30, 0
    v_mov_b32 v31, 0
    v_mov_b32 v32, 0
    v_mov_b32 v33, 0
    v_mov_b32 v34, 0
    v_mov_b32 v35, 0
    v_mov_b32 v36, 0
    v_mov_b32 v37, 0
    v_mov_b32 v38, 0
    v_mov_b32 v39, 0
L_pad_p1z_9:
    s_cbranch_execz L_pad_p1z_13
    v_mov_b32 v40, 0
    v_mov_b32 v41, 0
    v_mov_b32 v42, 0
    v_mov_b32 v43, 0
    v_mov_b32 v44, 0
    v_mov_b32 v45, 0
    v_mov_b32 v46, 0
    v_mov_b32 v47, 0
    v_mov_b32 v48, 0
    v_mov_b32 v49, 0
    v_mov_b32 v50, 0
    v_mov_b32 v51, 0
    v_mov_b32 v52, 0
    v_mov_b32 v53, 0
    v_mov_b32 v54, 0
    v_mov_b32 v55, 0
    v_mov_b32 v56, 0
    v_mov_b32 v57, 0
    v_mov_b32 v58, 0
    v_mov_b32 v59, 0
    v_mov_b32 v60, 0
    v_mov_b32 v61, 0
    v_mov_b32 v62, 0
    v_mov_b32 v63, 0
    v_mov_b32 v64, 0
    v_mov_b32 v65, 0
    v_mov_b32 v66, 0
    v_mov_b32 v67, 0
    v_mov_b32 v68, 0
    v_mov_b32 v69, 0
    v_mov_b32 v70, 0
    v_mov_b32 v71, 0
    v_mov_b32 v72, 0
    v_mov_b32 v73, 0
    v_mov_b32 v74, 0
    v_mov_b32 v75, 0
    v_mov_b32 v76, 0
    v_mov_b32 v77, 0
    v_mov_b32 v78, 0
    v_mov_b32 v79, 0
    v_mov_b32 v80, 0
    v_mov_b32 v81, 0
    v_mov_b32 v82, 0
    v_mov_b32 v83, 0
    v_mov_b32 v84, 0
    v_mov_b32 v85, 0
    v_mov_b32 v86, 0
    v_mov_b32 v87, 0
    v_mov_b32 v88, 0
    v_mov_b32 v89, 0
    v_mov_b32 v90, 0
    v_mov_b32 v91, 0
    v_mov_b32 v92, 0
    v_mov_b32 v93, 0
    v_mov_b32 v94, 0
    v_mov_b32 v95, 0
    v_mov_b32 v96, 0
    v_mov_b32 v97, 0
    v_mov_b32 v98, 0
    v_mov_b32 v99, 0
    v_mov_b32 v100, 0
    v_mov_b32 v101, 0
    v_mov_b32 v102, 0
    v_mov_b32 v103, 0
    v_mov_b32 v104, 0
    v_mov_b32 v105, 0
    v_mov_b32 v106, 0
    v_mov_b32 v107, 0
    v_mov_b32 v108, 0
    v_mov_b32 v109, 0
    v_mov_b32 v110, 0
    v_mov_b32 v111, 0
    s_mov_b32 s36, 0
    s_mov_b32 s33, 30720
    s_cmp_eq_u32 s24, 0
    s_cbranch_scc0 L_t1_f_out
    s_mov_b32 s96, 0
L_t1_f:
    buffer_load_dword v125, v169, s[16:19], 0 offen sc1
    s_waitcnt vmcnt(0)
    v_cmp_eq_u32 vcc, 0, v125
    s_nop 0
    s_cmp_eq_u64 vcc, 0
    s_cbranch_scc1 L_t1_f_out
    s_add_u32 s96, s96, 1
    s_cmp_lt_u32 s96, 0x40000
    s_cbranch_scc1 L_t1_f
L_t1_f_out:
    s_waitcnt vmcnt(0)
    s_barrier
    s_cmp_eq_u32 s24, 0
    s_cbranch_scc0 L_t1_fflag
    v_mov_b32 v252, 0x1c60000
    v_mov_b32 v253, 1
    s_mov_b64 exec, 1
    buffer_store_dword v253, v252, s[16:19], s31 offen sc1
    s_mov_b64 exec, -1
L_t1_fflag:
    s_mov_b32 s32, 0
    s_mov_b32 s39, -1
    s_add_u32 s39, s39, 1
    s_add_u32 s42, s39, s38
    s_and_b32 s42, s42, 3
    s_and_b32 s29, s39, -4
L_pad_p1z_10:
    s_cbranch_execz L_pad_p1z_ret
    s_or_b32 s29, s29, s42
    s_lshl_b32 s28, s29, 7
    s_lshl_b32 s29, s29, 11
    s_add_u32 m0, s32, s35
    s_nop 0
    buffer_load_dwordx4 v116, s[8:11], s29 offen  sc1 lds
    buffer_load_dwordx4 v117, s[8:11], s29 offen offset:1024  sc1 lds
    buffer_load_dwordx4 v118, s[8:11], s29 offen offset:2048  sc1 lds
    s_mov_b32 exec_hi, 0
    buffer_load_dwordx4 v119, s[8:11], s29 offen offset:3072  sc1 lds
    s_mov_b32 exec_hi, -1
    s_mov_b32 s32, 30720
    s_mov_b32 s39, 0
    s_add_u32 s39, s39, 1
    s_add_u32 s42, s39, s38
    s_and_b32 s42, s42, 3
    s_and_b32 s29, s39, -4
    s_or_b32 s29, s29, s42
    s_lshl_b32 s28, s29, 7
    s_lshl_b32 s29, s29, 11
    s_add_u32 m0, s32, s35
    s_nop 0
    buffer_load_dwordx4 v116, s[8:11], s29 offen  sc1 lds
    buffer_load_dwordx4 v117, s[8:11], s29 offen offset:1024  sc1 lds
    buffer_load_dwordx4 v118, s[8:11], s29 offen offset:2048  sc1 lds
    s_mov_b32 exec_hi, 0
    buffer_load_dwordx4 v119, s[8:11], s29 offen offset:3072  sc1 lds
    s_mov_b32 exec_hi, -1
    s_mov_b32 s32, 61440
    s_mov_b32 s39, 1
    s_add_u32 s39, s39, 1
    s_add_u32 s42, s39, s38
    s_and_b32 s42, s42, 3
    s_and_b32 s29, s39, -4
    s_or_b32 s29, s29, s42
    s_lshl_b32 s28, s29, 7
    s_lshl_b32 s29, s29, 11
    s_add_u32 m0, s32, s35
    s_nop 0
    buffer_load_dwordx4 v116, s[8:11], s29 offen  sc1 lds
    buffer_load_dwordx4 v117, s[8:11], s29 offen offset:1024  sc1 lds
    buffer_load_dwordx4 v118, s[8:11], s29 offen offset:2048  sc1 lds
    s_mov_b32 exec_hi, 0
    buffer_load_dwordx4 v119, s[8:11], s29 offen offset:3072  sc1 lds
    s_mov_b32 exec_hi, -1
    s_mov_b32 s32, 92160
    s_mov_b32 s39, 2
    s_add_u32 s39, s39, 1
    s_add_u32 s42, s39, s38
    s_and_b32 s42, s42, 3
    s_and_b32 s29, s39, -4
    s_or_b32 s29, s29, s42
    s_lshl_b32 s28, s29, 7
    s_lshl_b32 s29, s29, 11
    s_add_u32 m0, s32, s35
    s_nop 0
    buffer_load_dwordx4 v116, s[8:11], s29 offen  sc1 lds
    buffer_load_dwordx4 v117, s[8:11], s29 offen offset:1024  sc1 lds
    buffer_load_dwordx4 v118, s[8:11], s29 offen offset:2048  sc1 lds
    s_mov_b32 exec_hi, 0
    buffer_load_dwordx4 v119, s[8:11], s29 offen offset:3072  sc1 lds
    s_mov_b32 exec_hi, -1
    s_mov_b32 s32, 122880
    s_mov_b32 s39, 3
    s_add_u32 s39, s39, 1
    s_add_u32 s42, s39, s38
    s_and_b32 s42, s42, 3
    s_and_b32 s29, s39, -4
    s_or_b32 s29, s29, s42
    s_lshl_b32 s28, s29, 7
    s_lshl_b32 s29, s29, 11
    s_add_u32 m0, s32, s35
    s_nop 0
    buffer_load_dwordx4 v116, s[8:11], s29 offen  sc1 lds
    buffer_load_dwordx4 v117, s[8:11], s29 offen offset:1024  sc1 lds
    buffer_load_dwordx4 v118, s[8:11], s29 offen offset:2048  sc1 lds
    s_mov_b32 exec_hi, 0
    buffer_load_dwordx4 v119, s[8:11], s29 offen offset:3072  sc1 lds
    s_mov_b32 exec_hi, -1
    s_mov_b32 s32, 0
    s_add_u32 s39, s39, 1
    s_add_u32 s42, s39, s38
L_pad_p1z_11:
    s_cbranch_execz L_pad_p1z_ret
    s_and_b32 s42, s42, 3
    s_and_b32 s29, s39, -4
    s_or_b32 s29, s29, s42
    s_lshl_b32 s28, s29, 7
    s_lshl_b32 s29, s29, 11
    s_waitcnt vmcnt(16)
    s_barrier
    ds_read_b128 a[0:3], v120 offset:0
    ds_read_b64_tr_b16 a[16:17], v122 offset:0
    ds_read_b64_tr_b16 a[18:19], v122 offset:256
    ds_read_b64_tr_b16 a[20:21], v122 offset:2048
    ds_read_b64_tr_b16 a[22:23], v122 offset:2304
    ds_read_b64_tr_b16 a[24:25], v122 offset:4096
    ds_read_b64_tr_b16 a[26:27], v122 offset:4352
    ds_read_b64_tr_b16 a[28:29], v122 offset:6144
    ds_read_b64_tr_b16 a[30:31], v122 offset:6400
    ds_read_b64_tr_b16 a[32:33], v122 offset:8192
    ds_read_b64_tr_b16 a[34:35], v122 offset:8448
    ds_read_b64_tr_b16 a[36:37], v122 offset:10240
    ds_read_b64_tr_b16 a[38:39], v122 offset:10496
    ds_read_b64_tr_b16 a[40:41], v122 offset:12288
    ds_read_b64_tr_b16 a[42:43], v122 offset:12544
    ds_read_b128 a[4:7], v120 offset:2048
    ds_read_b128 a[8:11], v121 offset:0
    ds_read_b128 a[12:15], v121 offset:2048
    v_add_u32 v120, 30720, v120
    v_add_u32 v121, 30720, v121
    v_add_u32 v122, 30720, v122
L_p2_loop:
    s_waitcnt vmcnt(12) lgkmcnt(0)
    s_barrier
    v_mfma_f32_16x16x32_bf16 v[0:3], a[16:19], a[0:3], v[0:3]
    s_add_u32 m0, s32, s34
    ds_read_b128 a[64:67], v120 offset:0
    v_mfma_f32_16x16x32_bf16 v[4:7], a[20:23], a[0:3], v[4:7]
    ds_read_b64_tr_b16 a[80:81], v122 offset:0
    v_mfma_f32_16x16x32_bf16 v[8:11], a[24:27], a[0:3], v[8:11]
    buffer_load_dwordx4 v112, s[4:7], s28 offen lds
    ds_read_b64_tr_b16 a[82:83], v122 offset:256
    v_mfma_f32_16x16x32_bf16 v[12:15], a[28:31], a[0:3], v[12:15]
    ds_read_b64_tr_b16 a[84:85], v122 offset:2048
    v_mfma_f32_16x16x32_bf16 v[16:19], a[32:35], a[0:3], v[16:19]
    buffer_load_dwordx4 v113, s[4:7], s28 offen offset:1024 lds
    ds_read_b64_tr_b16 a[86:87], v122 offset:2304
    v_mfma_f32_16x16x32_bf16 v[20:23], a[36:39], a[0:3], v[20:23]
    ds_read_b64_tr_b16 a[88:89], v122 offset:4096
    v_mfma_f32_16x16x32_bf16 v[24:27], a[40:43], a[0:3], v[24:27]
    buffer_load_dwordx4 v114, s[4:7], s28 offen offset:2048 lds
    ds_read_b64_tr_b16 a[90:91], v122 offset:4352
    v_mfma_f32_16x16x32_bf16 v[28:31], a[16:19], a[4:7], v[28:31]
    ds_read_b64_tr_b16 a[92:93], v122 offset:6144
    v_mfma_f32_16x16x32_bf16 v[32:35], a[20:23], a[4:7], v[32:35]
    ds_read_b64_tr_b16 a[94:95], v122 offset:6400
    v_mfma_f32_16x16x32_bf16 v[36:39], a[24:27], a[4:7], v[36:39]
    buffer_load_dwordx4 v115, s[4:7], s28 offen offset:3072 lds
    ds_read_b64_tr_b16 a[96:97], v122 offset:8192
    v_mfma_f32_16x16x32_bf16 v[40:43], a[28:31], a[4:7], v[40:43]
    ds_read_b64_tr_b16 a[98:99], v122 offset:8448
    v_mfma_f32_16x16x32_bf16 v[44:47], a[32:35], a[4:7], v[44:47]
L_pad_p1z_12:
    s_cbranch_execz L_pad_p1z_ret
    s_add_u32 m0, s32, s35
    ds_read_b64_tr_b16 a[100:101], v122 offset:10240
    v_mfma_f32_16x16x32_bf16 v[48:51], a[36:39], a[4:7], v[48:51]
    ds_read_b64_tr_b16 a[102:103], v122 offset:10496
    v_mfma_f32_16x16x32_bf16 v[52:55], a[40:43], a[4:7], v[52:55]
    buffer_load_dwordx4 v116, s[8:11], s29 offen  sc1 lds
    ds_read_b64_tr_b16 a[104:105], v122 offset:12288
    v_mfma_f32_16x16x32_bf16 v[56:59], a[16:19], a[8:11], v[56:59]
    ds_read_b64_tr_b16 a[106:107], v122 offset:12544
    v_mfma_f32_16x16x32_bf16 v[60:63], a[20:23], a[8:11], v[60:63]
    ds_read_b128 a[68:71], v120 offset:2048
    s_add_u32 s41, s33, 30720
    v_mfma_f32_16x16x32_bf16 v[64:67], a[24:27], a[8:11], v[64:67]
    buffer_load_dwordx4 v117, s[8:11], s29 offen offset:1024  sc1 lds
    ds_read_b128 a[72:75], v121 offset:0
    v_mfma_f32_16x16x32_bf16 v[68:71], a[28:31], a[8:11], v[68:71]
    ds_read_b128 a[76:79], v121 offset:2048
    s_cmp_eq_u32 s41, 153600
    s_cselect_b32 s41, 0, s41
    v_mfma_f32_16x16x32_bf16 v[72:75], a[32:35], a[8:11], v[72:75]
    buffer_load_dwordx4 v118, s[8:11], s29 offen offset:2048  sc1 lds
    s_sub_u32 s37, s41, s33
    v_mfma_f32_16x16x32_bf16 v[76:79], a[36:39], a[8:11], v[76:79]
    v_add_u32 v120, s37, v120
    v_mfma_f32_16x16x32_bf16 v[80:83], a[40:43], a[8:11], v[80:83]
    s_mov_b32 exec_hi, 0
    buffer_load_dwordx4 v119, s[8:11], s29 offen offset:3072  sc1 lds
    s_mov_b32 exec_hi, -1
    v_add_u32 v121, s37, v121
    v_mfma_f32_16x16x32_bf16 v[84:87], a[16:19], a[12:15], v[84:87]
    v_add_u32 v122, s37, v122
    s_mov_b32 s32, s33
    v_mfma_f32_16x16x32_bf16 v[88:91], a[20:23], a[12:15], v[88:91]
    s_add_u32 s39, s39, 1
    s_add_u32 s42, s39, s38
    v_mfma_f32_16x16x32_bf16 v[92:95], a[24:27], a[12:15], v[92:95]
    s_and_b32 s42, s42, 3
    s_and_b32 s29, s39, -4
    v_mfma_f32_16x16x32_bf16 v[96:99], a[28:31], a[12:15], v[96:99]
    s_or_b32 s29, s29, s42
    s_lshl_b32 s28, s29, 7
    v_mfma_f32_16x16x32_bf16 v[100:103], a[32:35], a[12:15], v[100:103]
    s_lshl_b32 s29, s29, 11
    s_mov_b32 s33, s41
    v_mfma_f32_16x16x32_bf16 v[104:107], a[36:39], a[12:15], v[104:107]
    v_mfma_f32_16x16x32_bf16 v[108:111], a[40:43], a[12:15], v[108:111]
    s_waitcnt vmcnt(12) lgkmcnt(0)
    s_barrier
    v_mfma_f32_16x16x32_bf16 v[0:3], a[80:83], a[64:67], v[0:3]
    s_add_u32 m0, s32, s34
    ds_read_b128 a[0:3], v120 offset:0
    v_mfma_f32_16x16x32_bf16 v[4:7], a[84:87], a[64:67], v[4:7]
    ds_read_b64_tr_b16 a[16:17], v122 offset:0
    v_mfma_f32_16x16x32_bf16 v[8:11], a[88:91], a[64:67], v[8:11]
    buffer_load_dwordx4 v112, s[4:7], s28 offen lds
    ds_read_b64_tr_b16 a[18:19], v122 offset:256
    v_mfma_f32_16x16x32_bf16 v[12:15], a[92:95], a[64:67], v[12:15]
    ds_read_b64_tr_b16 a[20:21], v122 offset:2048
    v_mfma_f32_16x16x32_bf16 v[16:19], a[96:99], a[64:67], v[16:19]
    buffer_load_dwordx4 v113, s[4:7], s28 offen offset:1024 lds
    ds_read_b64_tr_b16 a[22:23], v122 offset:2304
    v_mfma_f32_16x16x32_bf16 v[20:23], a[100:103], a[64:67], v[20:23]
    ds_read_b64_tr_b16 a[24:25], v122 offset:4096
L_pad_p1z_13:
    s_cbranch_execz L_pad_p1z_ret
    v_mfma_f32_16x16x32_bf16 v[24:27], a[104:107], a[64:67], v[24:27]
    buffer_load_dwordx4 v114, s[4:7], s28 offen offset:2048 lds
    ds_read_b64_tr_b16 a[26:27], v122 offset:4352
    v_mfma_f32_16x16x32_bf16 v[28:31], a[80:83], a[68:71], v[28:31]
    ds_read_b64_tr_b16 a[28:29], v122 offset:6144
    v_mfma_f32_16x16x32_bf16 v[32:35], a[84:87], a[68:71], v[32:35]
    ds_read_b64_tr_b16 a[30:31], v122 offset:6400
    v_mfma_f32_16x16x32_bf16 v[36:39], a[88:91], a[68:71], v[36:39]
    buffer_load_dwordx4 v115, s[4:7], s28 offen offset:3072 lds
    ds_read_b64_tr_b16 a[32:33], v122 offset:8192
    v_mfma_f32_16x16x32_bf16 v[40:43], a[92:95], a[68:71], v[40:43]
    ds_read_b64_tr_b16 a[34:35], v122 offset:8448
    v_mfma_f32_16x16x32_bf16 v[44:47], a[96:99], a[68:71], v[44:47]
    s_add_u32 m0, s32, s35
    ds_read_b64_tr_b16 a[36:37], v122 offset:10240
    v_mfma_f32_16x16x32_bf16 v[48:51], a[100:103], a[68:71], v[48:51]
    ds_read_b64_tr_b16 a[38:39], v122 offset:10496
    v_mfma_f32_16x16x32_bf16 v[52:55], a[104:107], a[68:71], v[52:55]
    buffer_load_dwordx4 v116, s[8:11], s29 offen  sc1 lds
    ds_read_b64_tr_b16 a[40:41], v122 offset:12288
    v_mfma_f32_16x16x32_bf16 v[56:59], a[80:83], a[72:75], v[56:59]
    ds_read_b64_tr_b16 a[42:43], v122 offset:12544
    v_mfma_f32_16x16x32_bf16 v[60:63], a[84:87], a[72:75], v[60:63]
    ds_read_b128 a[4:7], v120 offset:2048
    s_add_u32 s41, s33, 30720
    v_mfma_f32_16x16x32_bf16 v[64:67], a[88:91], a[72:75], v[64:67]
    buffer_load_dwordx4 v117, s[8:11], s29 offen offset:1024  sc1 lds
    ds_read_b128 a[8:11], v121 offset:0
    v_mfma_f32_16x16x32_bf16 v[68:71], a[92:95], a[72:75], v[68:71]
    ds_read_b128 a[12:15], v121 offset:2048
    s_cmp_eq_u32 s41, 153600
    s_cselect_b32 s41, 0, s41
    v_mfma_f32_16x16x32_bf16 v[72:75], a[96:99], a[72:75], v[72:75]
    buffer_load_dwordx4 v118, s[8:11], s29 offen offset:2048  sc1 lds
    s_sub_u32 s37, s41, s33
    v_mfma_f32_16x16x32_bf16 v[76:79], a[100:103], a[72:75], v[76:79]
    v_add_u32 v120, s37, v120
    v_mfma_f32_16x16x32_bf16 v[80:83], a[104:107], a[72:75], v[80:83]
    s_mov_b32 exec_hi, 0
    buffer_load_dwordx4 v119, s[8:11], s29 offen offset:3072  sc1 lds
    s_mov_b32 exec_hi, -1
    v_add_u32 v121, s37, v121
    v_mfma_f32_16x16x32_bf16 v[84:87], a[80:83], a[76:79], v[84:87]
    v_add_u32 v122, s37, v122
    s_mov_b32 s32, s33
    v_mfma_f32_16x16x32_bf16 v[88:91], a[84:87], a[76:79], v[88:91]
    s_add_u32 s39, s39, 1
    s_add_u32 s42, s39, s38
    v_mfma_f32_16x16x32_bf16 v[92:95], a[88:91], a[76:79], v[92:95]
    s_and_b32 s42, s42, 3
    s_and_b32 s29, s39, -4
    v_mfma_f32_16x16x32_bf16 v[96:99], a[92:95], a[76:79], v[96:99]
    s_or_b32 s29, s29, s42
    s_lshl_b32 s28, s29, 7
    v_mfma_f32_16x16x32_bf16 v[100:103], a[96:99], a[76:79], v[100:103]
    s_lshl_b32 s29, s29, 11
    s_mov_b32 s33, s41
    v_mfma_f32_16x16x32_bf16 v[104:107], a[100:103], a[76:79], v[104:107]
    s_add_u32 s36, s36, 1
    v_mfma_f32_16x16x32_bf16 v[108:111], a[104:107], a[76:79], v[108:111]
    s_cmp_lt_u32 s36, 13
    s_cbranch_scc1 L_p2_loop
    s_waitcnt vmcnt(24) lgkmcnt(0)
    s_barrier
    v_mfma_f32_16x16x32_bf16 v[0:3], a[16:19], a[0:3], v[0:3]
    buffer_load_dword v125, v124, s[16:19], s52 offen sc1
    ds_read_b128 a[64:67], v120 offset:0
    v_mfma_f32_16x16x32_bf16 v[4:7], a[20:23], a[0:3], v[4:7]
    ds_read_b64_tr_b16 a[80:81], v122 offset:0
    v_mfma_f32_16x16x32_bf16 v[8:11], a[24:27], a[0:3], v[8:11]
    s_add_u32 m0, s32, s34
    ds_read_b64_tr_b16 a[82:83], v122 offset:256
    v_mfma_f32_16x16x32_bf16 v[12:15], a[28:31], a[0:3], v[12:15]
    ds_read_b64_tr_b16 a[84:85], v122 offset:2048
    v_mfma_f32_16x16x32_bf16 v[16:19], a[32:35], a[0:3], v[16:19]
    buffer_load_dwordx4 v112, s[4:7], s28 offen lds
    ds_read_b64_tr_b16 a[86:87], v122 offset:2304
    v_mfma_f32_16x16x32_bf16 v[20:23], a[36:39], a[0:3], v[20:23]
    ds_read_b64_tr_b16 a[88:89], v122 offset:4096
    v_mfma_f32_16x16x32_bf16 v[24:27], a[40:43], a[0:3], v[24:27]
    buffer_load_dwordx4 v113, s[4:7], s28 offen offset:1024 lds
    ds_read_b64_tr_b16 a[90:91], v122 offset:4352
    v_mfma_f32_16x16x32_bf16 v[28:31], a[16:19], a[4:7], v[28:31]
    ds_read_b64_tr_b16 a[92:93], v122 offset:6144
    v_mfma_f32_16x16x32_bf16 v[32:35], a[20:23], a[4:7], v[32:35]
    ds_read_b64_tr_b16 a[94:95], v122 offset:6400
    v_mfma_f32_16x16x32_bf16 v[36:39], a[24:27], a[4:7], v[36:39]
    buffer_load_dwordx4 v114, s[4:7], s28 offen offset:2048 lds
    ds_read_b64_tr_b16 a[96:97], v122 offset:8192
    v_mfma_f32_16x16x32_bf16 v[40:43], a[28:31], a[4:7], v[40:43]
    ds_read_b64_tr_b16 a[98:99], v122 offset:8448
    v_mfma_f32_16x16x32_bf16 v[44:47], a[32:35], a[4:7], v[44:47]
    buffer_load_dwordx4 v115, s[4:7], s28 offen offset:3072 lds
    ds_read_b64_tr_b16 a[100:101], v122 offset:10240
    v_mfma_f32_16x16x32_bf16 v[48:51], a[36:39], a[4:7], v[48:51]
    ds_read_b64_tr_b16 a[102:103], v122 offset:10496
    v_mfma_f32_16x16x32_bf16 v[52:55], a[40:43], a[4:7], v[52:55]
    s_add_u32 m0, s32, s35
    ds_read_b64_tr_b16 a[104:105], v122 offset:12288
    v_mfma_f32_16x16x32_bf16 v[56:59], a[16:19], a[8:11], v[56:59]
    ds_read_b64_tr_b16 a[106:107], v122 offset:12544
    v_mfma_f32_16x16x32_bf16 v[60:63], a[20:23], a[8:11], v[60:63]
    ds_read_b128 a[68:71], v120 offset:2048
    s_add_u32 s41, s33, 30720
    v_mfma_f32_16x16x32_bf16 v[64:67], a[24:27], a[8:11], v[64:67]
    buffer_load_dwordx4 v116, s[8:11], s29 offen  sc1 lds
    ds_read_b128 a[72:75], v121 offset:0
    v_mfma_f32_16x16x32_bf16 v[68:71], a[28:31], a[8:11], v[68:71]
    ds_read_b128 a[76:79], v121 offset:2048
    s_cmp_eq_u32 s41, 153600
    s_cselect_b32 s41, 0, s41
    v_mfma_f32_16x16x32_bf16 v[72:75], a[32:35], a[8:11], v[72:75]
    buffer_load_dwordx4 v117, s[8:11], s29 offen offset:1024  sc1 lds
    s_sub_u32 s37, s41, s33
    v_mfma_f32_16x16x32_bf16 v[76:79], a[36:39], a[8:11], v[76:79]
    v_add_u32 v120, s37, v120
    v_mfma_f32_16x16x32_bf16 v[80:83], a[40:43], a[8:11], v[80:83]
    buffer_load_dwordx4 v118, s[8:11], s29 offen offset:2048  sc1 lds
    v_add_u32 v121, s37, v121
    v_mfma_f32_16x16x32_bf16 v[84:87], a[16:19], a[12:15], v[84:87]
    v_add_u32 v122, s37, v122
    v_mfma_f32_16x16x32_bf16 v[88:91], a[20:23], a[12:15], v[88:91]
    v_mfma_f32_16x16x32_bf16 v[92:95], a[24:27], a[12:15], v[92:95]
    s_mov_b32 exec_hi, 0
    buffer_load_dwordx4 v119, s[8:11], s29 offen offset:3072  sc1 lds
    s_mov_b32 exec_hi, -1
    v_mfma_f32_16x16x32_bf16 v[96:99], a[28:31], a[12:15], v[96:99]
    s_mov_b32 s32, s33
    s_add_u32 s39, s39, 1
    v_mfma_f32_16x16x32_bf16 v[100:103], a[32:35], a[12:15], v[100:103]
    s_add_u32 s42, s39, s38
    s_and_b32 s42, s42, 3
    v_mfma_f32_16x16x32_bf16 v[104:107], a[36:39], a[12:15], v[104:107]
    s_and_b32 s29, s39, -4
    s_or_b32 s29, s29, s42
    v_mfma_f32_16x16x32_bf16 v[108:111], a[40:43], a[12:15], v[108:111]
    s_lshl_b32 s28, s29, 7
    s_lshl_b32 s29, s29, 11
    s_mov_b32 s33, s41
    s_waitcnt vmcnt(25) lgkmcnt(0)
    s_barrier
    v_mfma_f32_16x16x32_bf16 v[0:3], a[80:83], a[64:67], v[0:3]
    ds_read_b128 a[0:3], v120 offset:0
    s_add_u32 m0, s30, 0
    v_mfma_f32_16x16x32_bf16 v[4:7], a[84:87], a[64:67], v[4:7]
    ds_read_b64_tr_b16 a[16:17], v122 offset:0
    v_mfma_f32_16x16x32_bf16 v[8:11], a[88:91], a[64:67], v[8:11]
    ds_read_b64_tr_b16 a[18:19], v122 offset:256
    buffer_load_dwordx4 v157, s[60:63], s80 offen lds
    v_mfma_f32_16x16x32_bf16 v[12:15], a[92:95], a[64:67], v[12:15]
    ds_read_b64_tr_b16 a[20:21], v122 offset:2048
    v_mfma_f32_16x16x32_bf16 v[16:19], a[96:99], a[64:67], v[16:19]
    ds_read_b64_tr_b16 a[22:23], v122 offset:2304
    buffer_load_dwordx4 v158, s[60:63], s80 offen offset:1024 lds
    v_mfma_f32_16x16x32_bf16 v[20:23], a[100:103], a[64:67], v[20:23]
    ds_read_b64_tr_b16 a[24:25], v122 offset:4096
    v_mfma_f32_16x16x32_bf16 v[24:27], a[104:107], a[64:67], v[24:27]
    ds_read_b64_tr_b16 a[26:27], v122 offset:4352
    s_add_u32 s80, s80, 524288
    v_mfma_f32_16x16x32_bf16 v[28:31], a[80:83], a[68:71], v[28:31]
    ds_read_b64_tr_b16 a[28:29], v122 offset:6144
    v_mfma_f32_16x16x32_bf16 v[32:35], a[84:87], a[68:71], v[32:35]
    ds_read_b64_tr_b16 a[30:31], v122 offset:6400
    v_mfma_f32_16x16x32_bf16 v[36:39], a[88:91], a[68:71], v[36:39]
    ds_read_b64_tr_b16 a[32:33], v122 offset:8192
    s_add_u32 m0, s30, 8192
    v_mfma_f32_16x16x32_bf16 v[40:43], a[92:95], a[68:71], v[40:43]
    ds_read_b64_tr_b16 a[34:35], v122 offset:8448
    v_mfma_f32_16x16x32_bf16 v[44:47], a[96:99], a[68:71], v[44:47]
    ds_read_b64_tr_b16 a[36:37], v122 offset:10240
    buffer_load_dwordx4 v157, s[60:63], s81 offen lds
    v_mfma_f32_16x16x32_bf16 v[48:51], a[100:103], a[68:71], v[48:51]
    ds_read_b64_tr_b16 a[38:39], v122 offset:10496
    v_mfma_f32_16x16x32_bf16 v[52:55], a[104:107], a[68:71], v[52:55]
    ds_read_b64_tr_b16 a[40:41], v122 offset:12288
    buffer_load_dwordx4 v158, s[60:63], s81 offen offset:1024 lds
    v_mfma_f32_16x16x32_bf16 v[56:59], a[80:83], a[72:75], v[56:59]
    ds_read_b64_tr_b16 a[42:43], v122 offset:12544
    v_mfma_f32_16x16x32_bf16 v[60:63], a[84:87], a[72:75], v[60:63]
    ds_read_b128 a[4:7], v120 offset:2048
    s_add_u32 s41, s33, 30720
    v_mfma_f32_16x16x32_bf16 v[64:67], a[88:91], a[72:75], v[64:67]
    ds_read_b128 a[8:11], v121 offset:0
    s_cmp_eq_u32 s41, 153600
    s_cselect_b32 s41, 0, s41
    v_mfma_f32_16x16x32_bf16 v[68:71], a[92:95], a[72:75], v[68:71]
    ds_read_b128 a[12:15], v121 offset:2048
    s_sub_u32 s37, s41, s33
    v_mfma_f32_16x16x32_bf16 v[72:75], a[96:99], a[72:75], v[72:75]
    v_add_u32 v120, s37, v120
    s_mov_b32 s33, s41
    v_mfma_f32_16x16x32_bf16 v[76:79], a[100:103], a[72:75], v[76:79]
    v_add_u32 v121, s37, v121
    s_add_u32 s81, s81, 524288
    v_mfma_f32_16x16x32_bf16 v[80:83], a[104:107], a[72:75], v[80:83]
    v_add_u32 v122, s37, v122
    s_add_u32 m0, s30, 16384
    v_mfma_f32_16x16x32_bf16 v[84:87], a[80:83], a[76:79], v[84:87]
    buffer_load_dwordx4 v157, s[60:63], s82 offen lds
    v_mfma_f32_16x16x32_bf16 v[88:91], a[84:87], a[76:79], v[88:91]
    buffer_load_dwordx4 v158, s[60:63], s82 offen offset:1024 lds
    v_mfma_f32_16x16x32_bf16 v[92:95], a[88:91], a[76:79], v[92:95]
    v_mfma_f32_16x16x32_bf16 v[96:99], a[92:95], a[76:79], v[96:99]
    s_add_u32 s82, s82, 524288
    v_mfma_f32_16x16x32_bf16 v[100:103], a[96:99], a[76:79], v[100:103]
    v_mfma_f32_16x16x32_bf16 v[104:107], a[100:103], a[76:79], v[104:107]
    v_mfma_f32_16x16x32_bf16 v[108:111], a[104:107], a[76:79], v[108:111]
    s_waitcnt vmcnt(14) lgkmcnt(0)
    s_barrier
    v_cmp_eq_u32 vcc, 0, v125
    s_nop 0
    s_cmp_eq_u64 vcc, 0
    s_cbranch_scc1 L_p2_f_out
    s_mov_b32 s96, 0
L_p2_f:
    buffer_load_dword v125, v124, s[16:19], s52 offen sc1
    s_waitcnt vmcnt(0)
    v_cmp_eq_u32 vcc, 0, v125
    s_nop 0
    s_cmp_eq_u64 vcc, 0
    s_cbranch_scc1 L_p2_f_out
    s_add_u32 s96, s96, 1
    s_cmp_lt_u32 s96, 0x40000
    s_cbranch_scc1 L_p2_f
L_p2_f_out:
    v_mfma_f32_16x16x32_bf16 v[0:3], a[16:19], a[0:3], v[0:3]
    ds_read_b128 a[64:67], v120 offset:0
    buffer_load_dwordx4 v[128:131], v170, s[16:19], s88 offen sc1
    v_mfma_f32_16x16x32_bf16 v[4:7], a[20:23], a[0:3], v[4:7]
    ds_read_b64_tr_b16 a[80:81], v122 offset:0
    v_mfma_f32_16x16x32_bf16 v[8:11], a[24:27], a[0:3], v[8:11]
    ds_read_b64_tr_b16 a[82:83], v122 offset:256
    v_mfma_f32_16x16x32_bf16 v[12:15], a[28:31], a[0:3], v[12:15]
    ds_read_b64_tr_b16 a[84:85], v122 offset:2048
    buffer_load_dwordx4 v[132:135], v170, s[16:19], s88 offen offset:1024 sc1
    v_mfma_f32_16x16x32_bf16 v[16:19], a[32:35], a[0:3], v[16:19]
    ds_read_b64_tr_b16 a[86:87], v122 offset:2304
    v_mfma_f32_16x16x32_bf16 v[20:23], a[36:39], a[0:3], v[20:23]
    ds_read_b64_tr_b16 a[88:89], v122 offset:4096
    v_mfma_f32_16x16x32_bf16 v[24:27], a[40:43], a[0:3], v[24:27]
    ds_read_b64_tr_b16 a[90:91], v122 offset:4352
    buffer_load_dwordx4 v[136:139], v170, s[16:19], s88 offen offset:2048 sc1
    v_mfma_f32_16x16x32_bf16 v[28:31], a[16:19], a[4:7], v[28:31]
    ds_read_b64_tr_b16 a[92:93], v122 offset:6144
    v_mfma_f32_16x16x32_bf16 v[32:35], a[20:23], a[4:7], v[32:35]
    ds_read_b64_tr_b16 a[94:95], v122 offset:6400
    v_mfma_f32_16x16x32_bf16 v[36:39], a[24:27], a[4:7], v[36:39]
    ds_read_b64_tr_b16 a[96:97], v122 offset:8192
    v_mfma_f32_16x16x32_bf16 v[40:43], a[28:31], a[4:7], v[40:43]
    ds_read_b64_tr_b16 a[98:99], v122 offset:8448
    buffer_load_dwordx4 v[140:143], v170, s[16:19], s88 offen offset:3072 sc1
    v_mfma_f32_16x16x32_bf16 v[44:47], a[32:35], a[4:7], v[44:47]
    ds_read_b64_tr_b16 a[100:101], v122 offset:10240
    v_mfma_f32_16x16x32_bf16 v[48:51], a[36:39], a[4:7], v[48:51]
    ds_read_b64_tr_b16 a[102:103], v122 offset:10496
    v_mfma_f32_16x16x32_bf16 v[52:55], a[40:43], a[4:7], v[52:55]
    ds_read_b64_tr_b16 a[104:105], v122 offset:12288
    buffer_load_dwordx4 v[144:147], v170, s[16:19], s89 offen sc1
    v_mfma_f32_16x16x32_bf16 v[56:59], a[16:19], a[8:11], v[56:59]
    ds_read_b64_tr_b16 a[106:107], v122 offset:12544
    v_mfma_f32_16x16x32_bf16 v[60:63], a[20:23], a[8:11], v[60:63]
    ds_read_b128 a[68:71], v120 offset:2048
    s_add_u32 s41, s33, 30720
    v_mfma_f32_16x16x32_bf16 v[64:67], a[24:27], a[8:11], v[64:67]
    ds_read_b128 a[72:75], v121 offset:0
    s_cmp_eq_u32 s41, 153600
    s_cselect_b32 s41, 0, s41
    v_mfma_f32_16x16x32_bf16 v[68:71], a[28:31], a[8:11], v[68:71]
    ds_read_b128 a[76:79], v121 offset:2048
    s_sub_u32 s37, s41, s33
    v_mfma_f32_16x16x32_bf16 v[72:75], a[32:35], a[8:11], v[72:75]
    v_add_u32 v120, s37, v120
    s_mov_b32 s33, s41
    v_mfma_f32_16x16x32_bf16 v[76:79], a[36:39], a[8:11], v[76:79]
    v_add_u32 v121, s37, v121
    buffer_load_dwordx4 v[148:151], v170, s[16:19], s89 offen offset:1024 sc1
    v_mfma_f32_16x16x32_bf16 v[80:83], a[40:43], a[8:11], v[80:83]
    v_add_u32 v122, s37, v122
    buffer_load_dwordx4 v[152:155], v170, s[16:19], s90 offen sc1
    v_mfma_f32_16x16x32_bf16 v[84:87], a[16:19], a[12:15], v[84:87]
    v_mfma_f32_16x16x32_bf16 v[88:91], a[20:23], a[12:15], v[88:91]
    v_mfma_f32_16x16x32_bf16 v[92:95], a[24:27], a[12:15], v[92:95]
    buffer_load_dword v156, v171, s[12:15], s91 offen
    v_mfma_f32_16x16x32_bf16 v[96:99], a[28:31], a[12:15], v[96:99]
    v_mfma_f32_16x16x32_bf16 v[100:103], a[32:35], a[12:15], v[100:103]
    v_mfma_f32_16x16x32_bf16 v[104:107], a[36:39], a[12:15], v[104:107]
    v_mfma_f32_16x16x32_bf16 v[108:111], a[40:43], a[12:15], v[108:111]
    s_waitcnt vmcnt(22) lgkmcnt(0)
    s_barrier
    v_mfma_f32_16x16x32_bf16 v[0:3], a[80:83], a[64:67], v[0:3]
    ds_read_b128 a[0:3], v120 offset:0
    buffer_load_dwordx4 a[128:131], v159, s[56:59], s84 offen sc1
    v_mfma_f32_16x16x32_bf16 v[4:7], a[84:87], a[64:67], v[4:7]
    ds_read_b64_tr_b16 a[16:17], v122 offset:0
    v_mfma_f32_16x16x32_bf16 v[8:11], a[88:91], a[64:67], v[8:11]
    ds_read_b64_tr_b16 a[18:19], v122 offset:256
    buffer_load_dwordx4 a[132:135], v159, s[56:59], s84 offen offset:1024 sc1
    v_mfma_f32_16x16x32_bf16 v[12:15], a[92:95], a[64:67], v[12:15]
    ds_read_b64_tr_b16 a[20:21], v122 offset:2048
    v_mfma_f32_16x16x32_bf16 v[16:19], a[96:99], a[64:67], v[16:19]
    ds_read_b64_tr_b16 a[22:23], v122 offset:2304
    v_mfma_f32_16x16x32_bf16 v[20:23], a[100:103], a[64:67], v[20:23]
    ds_read_b64_tr_b16 a[24:25], v122 offset:4096
    buffer_load_dwordx4 a[136:139], v159, s[56:59], s84 offen offset:2048 sc1
    v_mfma_f32_16x16x32_bf16 v[24:27], a[104:107], a[64:67], v[24:27]
    ds_read_b64_tr_b16 a[26:27], v122 offset:4352
    v_mfma_f32_16x16x32_bf16 v[28:31], a[80:83], a[68:71], v[28:31]
    ds_read_b64_tr_b16 a[28:29], v122 offset:6144
    v_mfma_f32_16x16x32_bf16 v[32:35], a[84:87], a[68:71], v[32:35]
    ds_read_b64_tr_b16 a[30:31], v122 offset:6400
    buffer_load_dwordx4 a[140:143], v159, s[56:59], s84 offen offset:3072 sc1
    v_mfma_f32_16x16x32_bf16 v[36:39], a[88:91], a[68:71], v[36:39]
    ds_read_b64_tr_b16 a[32:33], v122 offset:8192
    v_mfma_f32_16x16x32_bf16 v[40:43], a[92:95], a[68:71], v[40:43]
    ds_read_b64_tr_b16 a[34:35], v122 offset:8448
    s_add_u32 s84, s84, 16384
    v_mfma_f32_16x16x32_bf16 v[44:47], a[96:99], a[68:71], v[44:47]
    ds_read_b64_tr_b16 a[36:37], v122 offset:10240
    v_mfma_f32_16x16x32_bf16 v[48:51], a[100:103], a[68:71], v[48:51]
    ds_read_b64_tr_b16 a[38:39], v122 offset:10496
    v_mfma_f32_16x16x32_bf16 v[52:55], a[104:107], a[68:71], v[52:55]
    ds_read_b64_tr_b16 a[40:41], v122 offset:12288
    buffer_load_dwordx4 a[144:147], v159, s[56:59], s85 offen sc1
    v_mfma_f32_16x16x32_bf16 v[56:59], a[80:83], a[72:75], v[56:59]
    ds_read_b64_tr_b16 a[42:43], v122 offset:12544
    v_mfma_f32_16x16x32_bf16 v[60:63], a[84:87], a[72:75], v[60:63]
    ds_read_b128 a[4:7], v120 offset:2048
    s_add_u32 s41, s33, 30720
    v_mfma_f32_16x16x32_bf16 v[64:67], a[88:91], a[72:75], v[64:67]
    ds_read_b128 a[8:11], v121 offset:0
    s_cmp_eq_u32 s41, 153600
    s_cselect_b32 s41, 0, s41
    v_mfma_f32_16x16x32_bf16 v[68:71], a[92:95], a[72:75], v[68:71]
    ds_read_b128 a[12:15], v121 offset:2048
    s_sub_u32 s37, s41, s33
    v_mfma_f32_16x16x32_bf16 v[72:75], a[96:99], a[72:75], v[72:75]
    v_add_u32 v120, s37, v120
    s_mov_b32 s33, s41
    v_mfma_f32_16x16x32_bf16 v[76:79], a[100:103], a[72:75], v[76:79]
    v_add_u32 v121, s37, v121
    buffer_load_dwordx4 a[148:151], v159, s[56:59], s85 offen offset:1024 sc1
    v_mfma_f32_16x16x32_bf16 v[80:83], a[104:107], a[72:75], v[80:83]
    v_add_u32 v122, s37, v122
    buffer_load_dwordx4 a[152:155], v159, s[56:59], s85 offen offset:2048 sc1
    v_mfma_f32_16x16x32_bf16 v[84:87], a[80:83], a[76:79], v[84:87]
    buffer_load_dwordx4 a[156:159], v159, s[56:59], s85 offen offset:3072 sc1
    v_mfma_f32_16x16x32_bf16 v[88:91], a[84:87], a[76:79], v[88:91]
    v_mfma_f32_16x16x32_bf16 v[92:95], a[88:91], a[76:79], v[92:95]
    v_mfma_f32_16x16x32_bf16 v[96:99], a[92:95], a[76:79], v[96:99]
    s_add_u32 s85, s85, 16384
    v_mfma_f32_16x16x32_bf16 v[100:103], a[96:99], a[76:79], v[100:103]
    v_mfma_f32_16x16x32_bf16 v[104:107], a[100:103], a[76:79], v[104:107]
    v_mfma_f32_16x16x32_bf16 v[108:111], a[104:107], a[76:79], v[108:111]
    s_waitcnt vmcnt(22) lgkmcnt(0)
    s_barrier
    v_mfma_f32_16x16x32_bf16 v[0:3], a[16:19], a[0:3], v[0:3]
    ds_read_b128 a[64:67], v120 offset:0
    s_add_u32 m0, s30, 24576
    v_mfma_f32_16x16x32_bf16 v[4:7], a[20:23], a[0:3], v[4:7]
    ds_read_b64_tr_b16 a[80:81], v122 offset:0
    v_mfma_f32_16x16x32_bf16 v[8:11], a[24:27], a[0:3], v[8:11]
    ds_read_b64_tr_b16 a[82:83], v122 offset:256
    buffer_load_dwordx4 v157, s[60:63], s83 offen lds
    v_mfma_f32_16x16x32_bf16 v[12:15], a[28:31], a[0:3], v[12:15]
    ds_read_b64_tr_b16 a[84:85], v122 offset:2048
    v_mfma_f32_16x16x32_bf16 v[16:19], a[32:35], a[0:3], v[16:19]
    ds_read_b64_tr_b16 a[86:87], v122 offset:2304
    buffer_load_dwordx4 v158, s[60:63], s83 offen offset:1024 lds
    v_mfma_f32_16x16x32_bf16 v[20:23], a[36:39], a[0:3], v[20:23]
    ds_read_b64_tr_b16 a[88:89], v122 offset:4096
    v_mfma_f32_16x16x32_bf16 v[24:27], a[40:43], a[0:3], v[24:27]
    ds_read_b64_tr_b16 a[90:91], v122 offset:4352
    s_add_u32 s83, s83, 524288
    v_mfma_f32_16x16x32_bf16 v[28:31], a[16:19], a[4:7], v[28:31]
    ds_read_b64_tr_b16 a[92:93], v122 offset:6144
    v_mfma_f32_16x16x32_bf16 v[32:35], a[20:23], a[4:7], v[32:35]
    ds_read_b64_tr_b16 a[94:95], v122 offset:6400
    buffer_load_dwordx4 a[160:163], v159, s[56:59], s86 offen sc1
    v_mfma_f32_16x16x32_bf16 v[36:39], a[24:27], a[4:7], v[36:39]
    ds_read_b64_tr_b16 a[96:97], v122 offset:8192
    v_mfma_f32_16x16x32_bf16 v[40:43], a[28:31], a[4:7], v[40:43]
    ds_read_b64_tr_b16 a[98:99], v122 offset:8448
    buffer_load_dwordx4 a[164:167], v159, s[56:59], s86 offen offset:1024 sc1
    v_mfma_f32_16x16x32_bf16 v[44:47], a[32:35], a[4:7], v[44:47]
    ds_read_b64_tr_b16 a[100:101], v122 offset:10240
    v_mfma_f32_16x16x32_bf16 v[48:51], a[36:39], a[4:7], v[48:51]
    ds_read_b64_tr_b16 a[102:103], v122 offset:10496
    buffer_load_dwordx4 a[168:171], v159, s[56:59], s86 offen offset:2048 sc1
    v_mfma_f32_16x16x32_bf16 v[52:55], a[40:43], a[4:7], v[52:55]
    ds_read_b64_tr_b16 a[104:105], v122 offset:12288
    v_mfma_f32_16x16x32_bf16 v[56:59], a[16:19], a[8:11], v[56:59]
    ds_read_b64_tr_b16 a[106:107], v122 offset:12544
    buffer_load_dwordx4 a[172:175], v159, s[56:59], s86 offen offset:3072 sc1
    v_mfma_f32_16x16x32_bf16 v[60:63], a[20:23], a[8:11], v[60:63]
    ds_read_b128 a[68:71], v120 offset:2048
    v_mfma_f32_16x16x32_bf16 v[64:67], a[24:27], a[8:11], v[64:67]
    ds_read_b128 a[72:75], v121 offset:0
    s_add_u32 s86, s86, 16384
    v_mfma_f32_16x16x32_bf16 v[68:71], a[28:31], a[8:11], v[68:71]
    ds_read_b128 a[76:79], v121 offset:2048
    v_mfma_f32_16x16x32_bf16 v[72:75], a[32:35], a[8:11], v[72:75]
    s_add_u32 m0, s30, 32768
    v_mfma_f32_16x16x32_bf16 v[76:79], a[36:39], a[8:11], v[76:79]
    v_mfma_f32_16x16x32_bf16 v[80:83], a[40:43], a[8:11], v[80:83]
    buffer_load_dwordx4 v157, s[60:63], s80 offen lds
    v_mfma_f32_16x16x32_bf16 v[84:87], a[16:19], a[12:15], v[84:87]
    v_mfma_f32_16x16x32_bf16 v[88:91], a[20:23], a[12:15], v[88:91]
    buffer_load_dwordx4 v158, s[60:63], s80 offen offset:1024 lds
    v_mfma_f32_16x16x32_bf16 v[92:95], a[24:27], a[12:15], v[92:95]
    v_mfma_f32_16x16x32_bf16 v[96:99], a[28:31], a[12:15], v[96:99]
    s_add_u32 s80, s80, 524288
    v_mfma_f32_16x16x32_bf16 v[100:103], a[32:35], a[12:15], v[100:103]
    v_mfma_f32_16x16x32_bf16 v[104:107], a[36:39], a[12:15], v[104:107]
    v_mfma_f32_16x16x32_bf16 v[108:111], a[40:43], a[12:15], v[108:111]
    s_waitcnt vmcnt(16) lgkmcnt(0)
    s_barrier
    v_mfma_f32_16x16x32_bf16 v[0:3], a[80:83], a[64:67], v[0:3]
    v_lshlrev_b32 v176, 16, v128
    buffer_load_dwordx4 a[176:179], v159, s[56:59], s87 offen sc1
    v_mfma_f32_16x16x32_bf16 v[4:7], a[84:87], a[64:67], v[4:7]
    v_and_b32 v177, 0xffff0000, v128
    v_lshlrev_b32 v178, 16, v129
    v_mfma_f32_16x16x32_bf16 v[8:11], a[88:91], a[64:67], v[8:11]
    v_and_b32 v179, 0xffff0000, v129
    v_lshlrev_b32 v180, 16, v130
    v_mfma_f32_16x16x32_bf16 v[12:15], a[92:95], a[64:67], v[12:15]
    v_and_b32 v181, 0xffff0000, v130
    v_lshlrev_b32 v182, 16, v131
    v_mfma_f32_16x16x32_bf16 v[16:19], a[96:99], a[64:67], v[16:19]
    buffer_load_dwordx4 a[180:183], v159, s[56:59], s87 offen offset:1024 sc1
    v_and_b32 v183, 0xffff0000, v131
    v_mfma_f32_16x16x32_bf16 v[20:23], a[100:103], a[64:67], v[20:23]
    v_lshlrev_b32 v184, 16, v132
    v_and_b32 v185, 0xffff0000, v132
    v_mfma_f32_16x16x32_bf16 v[24:27], a[104:107], a[64:67], v[24:27]
    v_lshlrev_b32 v186, 16, v133
    v_and_b32 v187, 0xffff0000, v133
    v_mfma_f32_16x16x32_bf16 v[28:31], a[80:83], a[68:71], v[28:31]
    v_lshlrev_b32 v188, 16, v134
    buffer_load_dwordx4 a[184:187], v159, s[56:59], s87 offen offset:2048 sc1
    v_mfma_f32_16x16x32_bf16 v[32:35], a[84:87], a[68:71], v[32:35]
    v_and_b32 v189, 0xffff0000, v134
    v_lshlrev_b32 v190, 16, v135
    v_mfma_f32_16x16x32_bf16 v[36:39], a[88:91], a[68:71], v[36:39]
    v_and_b32 v191, 0xffff0000, v135
    v_lshlrev_b32 v192, 16, v136
    v_mfma_f32_16x16x32_bf16 v[40:43], a[92:95], a[68:71], v[40:43]
    v_and_b32 v193, 0xffff0000, v136
    v_lshlrev_b32 v194, 16, v137
    v_mfma_f32_16x16x32_bf16 v[44:47], a[96:99], a[68:71], v[44:47]
    buffer_load_dwordx4 a[188:191], v159, s[56:59], s87 offen offset:3072 sc1
    v_and_b32 v195, 0xffff0000, v137
    v_mfma_f32_16x16x32_bf16 v[48:51], a[100:103], a[68:71], v[48:51]
    v_lshlrev_b32 v196, 16, v138
    v_and_b32 v197, 0xffff0000, v138
    v_mfma_f32_16x16x32_bf16 v[52:55], a[104:107], a[68:71], v[52:55]
    v_lshlrev_b32 v198, 16, v139
    v_and_b32 v199, 0xffff0000, v139
    v_mfma_f32_16x16x32_bf16 v[56:59], a[80:83], a[72:75], v[56:59]
    v_lshlrev_b32 v200, 16, v140
    s_add_u32 s87, s87, 16384
    v_mfma_f32_16x16x32_bf16 v[60:63], a[84:87], a[72:75], v[60:63]
    v_and_b32 v201, 0xffff0000, v140
    v_lshlrev_b32 v202, 16, v141
    v_mfma_f32_16x16x32_bf16 v[64:67], a[88:91], a[72:75], v[64:67]
    v_and_b32 v203, 0xffff0000, v141
    v_lshlrev_b32 v204, 16, v142
    v_mfma_f32_16x16x32_bf16 v[68:71], a[92:95], a[72:75], v[68:71]
    v_and_b32 v205, 0xffff0000, v142
    v_lshlrev_b32 v206, 16, v143
    v_mfma_f32_16x16x32_bf16 v[72:75], a[96:99], a[72:75], v[72:75]
    v_and_b32 v207, 0xffff0000, v143
    s_add_u32 m0, s30, 40960
    v_mfma_f32_16x16x32_bf16 v[76:79], a[100:103], a[72:75], v[76:79]
    v_lshlrev_b32 v208, 16, v144
    v_and_b32 v209, 0xffff0000, v144
    v_mfma_f32_16x16x32_bf16 v[80:83], a[104:107], a[72:75], v[80:83]
    v_lshlrev_b32 v210, 16, v145
    v_and_b32 v211, 0xffff0000, v145
    v_mfma_f32_16x16x32_bf16 v[84:87], a[80:83], a[76:79], v[84:87]
    v_lshlrev_b32 v212, 16, v146
    v_and_b32 v213, 0xffff0000, v146
    v_mfma_f32_16x16x32_bf16 v[88:91], a[84:87], a[76:79], v[88:91]
    buffer_load_dwordx4 v157, s[60:63], s81 offen lds
    v_lshlrev_b32 v214, 16, v147
    v_mfma_f32_16x16x32_bf16 v[92:95], a[88:91], a[76:79], v[92:95]
    v_and_b32 v215, 0xffff0000, v147
    v_lshlrev_b32 v216, 16, v148
    v_mfma_f32_16x16x32_bf16 v[96:99], a[92:95], a[76:79], v[96:99]
    v_and_b32 v217, 0xffff0000, v148
    v_lshlrev_b32 v218, 16, v149
    v_mfma_f32_16x16x32_bf16 v[100:103], a[96:99], a[76:79], v[100:103]
    v_and_b32 v219, 0xffff0000, v149
    buffer_load_dwordx4 v158, s[60:63], s81 offen offset:1024 lds
    v_mfma_f32_16x16x32_bf16 v[104:107], a[100:103], a[76:79], v[104:107]
    v_lshlrev_b32 v220, 16, v150
    v_and_b32 v221, 0xffff0000, v150
    v_mfma_f32_16x16x32_bf16 v[108:111], a[104:107], a[76:79], v[108:111]
    v_lshlrev_b32 v222, 16, v151
    v_and_b32 v223, 0xffff0000, v151
    v_lshlrev_b32 v224, 16, v152
    v_and_b32 v225, 0xffff0000, v152
    s_add_u32 s81, s81, 524288
    v_lshlrev_b32 v226, 16, v153
    v_and_b32 v227, 0xffff0000, v153
    v_lshlrev_b32 v228, 16, v154
    v_and_b32 v229, 0xffff0000, v154
    v_lshlrev_b32 v230, 16, v155
    v_and_b32 v231, 0xffff0000, v155
    s_mul_i32 s41, s24, 14336
    v_add_u32 v162, s41, v170
    s_xor_b32 s41, s24, 2
    s_mul_i32 s41, s41, 14336
    v_add_u32 v163, s41, v170
    ds_write_b128 v162, v[56:59] offset:0
    buffer_load_dwordx4 a[192:195], v159, s[56:59], s84 offen sc1
    buffer_load_dwordx4 a[196:199], v159, s[56:59], s84 offen offset:1024 sc1
    ds_write_b128 v162, v[60:63] offset:1024
    buffer_load_dwordx4 a[200:203], v159, s[56:59], s84 offen offset:2048 sc1
    ds_write_b128 v162, v[64:67] offset:2048
    buffer_load_dwordx4 a[204:207], v159, s[56:59], s84 offen offset:3072 sc1
    ds_write_b128 v162, v[68:71] offset:3072
    s_add_u32 s84, s84, 16384
    s_add_u32 m0, s30, 49152
    ds_write_b128 v162, v[72:75] offset:4096
    buffer_load_dwordx4 v157, s[60:63], s82 offen lds
    ds_write_b128 v162, v[76:79] offset:5120
    buffer_load_dwordx4 v158, s[60:63], s82 offen offset:1024 lds
    ds_write_b128 v162, v[80:83] offset:6144
    s_add_u32 s82, s82, 524288
    ds_write_b128 v162, v[84:87] offset:7168
    buffer_load_dwordx4 a[208:211], v159, s[56:59], s85 offen sc1
    buffer_load_dwordx4 a[212:215], v159, s[56:59], s85 offen offset:1024 sc1
    ds_write_b128 v162, v[88:91] offset:8192
    buffer_load_dwordx4 a[216:219], v159, s[56:59], s85 offen offset:2048 sc1
    ds_write_b128 v162, v[92:95] offset:9216
    buffer_load_dwordx4 a[220:223], v159, s[56:59], s85 offen offset:3072 sc1
    ds_write_b128 v162, v[96:99] offset:10240
    s_add_u32 s85, s85, 16384
    s_add_u32 m0, s30, 57344
    ds_write_b128 v162, v[100:103] offset:11264
    buffer_load_dwordx4 v157, s[60:63], s83 offen lds
    ds_write_b128 v162, v[104:107] offset:12288
    buffer_load_dwordx4 v158, s[60:63], s83 offen offset:1024 lds
    ds_write_b128 v162, v[108:111] offset:13312
    s_add_u32 s83, s83, 524288
    v_lshlrev_b32 v166, 16, v156
    v_and_b32 v168, 0xffff0000, v156
    v_pk_add_f32 v[0:1], v[0:1], v[166:167] op_sel_hi:[1,0]
    v_pk_add_f32 v[2:3], v[2:3], v[166:167] op_sel_hi:[1,0]
    v_pk_add_f32 v[4:5], v[4:5], v[166:167] op_sel_hi:[1,0]
    v_pk_add_f32 v[6:7], v[6:7], v[166:167] op_sel_hi:[1,0]
    v_pk_add_f32 v[8:9], v[8:9], v[166:167] op_sel_hi:[1,0]
    v_pk_add_f32 v[10:11], v[10:11], v[166:167] op_sel_hi:[1,0]
    v_pk_add_f32 v[12:13], v[12:13], v[166:167] op_sel_hi:[1,0]
    v_pk_add_f32 v[14:15], v[14:15], v[166:167] op_sel_hi:[1,0]
    v_pk_add_f32 v[16:17], v[16:17], v[166:167] op_sel_hi:[1,0]
    v_pk_add_f32 v[18:19], v[18:19], v[166:167] op_sel_hi:[1,0]
    v_pk_add_f32 v[20:21], v[20:21], v[166:167] op_sel_hi:[1,0]
    v_pk_add_f32 v[22:23], v[22:23], v[166:167] op_sel_hi:[1,0]
    v_pk_add_f32 v[24:25], v[24:25], v[166:167] op_sel_hi:[1,0]
    v_pk_add_f32 v[26:27], v[26:27], v[166:167] op_sel_hi:[1,0]
    v_pk_add_f32 v[28:29], v[28:29], v[168:169] op_sel_hi:[1,0]
    v_pk_add_f32 v[30:31], v[30:31], v[168:169] op_sel_hi:[1,0]
    v_pk_add_f32 v[32:33], v[32:33], v[168:169] op_sel_hi:[1,0]
    v_pk_add_f32 v[34:35], v[34:35], v[168:169] op_sel_hi:[1,0]
    v_pk_add_f32 v[36:37], v[36:37], v[168:169] op_sel_hi:[1,0]
    v_pk_add_f32 v[38:39], v[38:39], v[168:169] op_sel_hi:[1,0]
    v_pk_add_f32 v[40:41], v[40:41], v[168:169] op_sel_hi:[1,0]
    v_pk_add_f32 v[42:43], v[42:43], v[168:169] op_sel_hi:[1,0]
    v_pk_add_f32 v[44:45], v[44:45], v[168:169] op_sel_hi:[1,0]
    v_pk_add_f32 v[46:47], v[46:47], v[168:169] op_sel_hi:[1,0]
    v_pk_add_f32 v[48:49], v[48:49], v[168:169] op_sel_hi:[1,0]
    v_pk_add_f32 v[50:51], v[50:51], v[168:169] op_sel_hi:[1,0]
    v_pk_add_f32 v[52:53], v[52:53], v[168:169] op_sel_hi:[1,0]
    v_pk_add_f32 v[54:55], v[54:55], v[168:169] op_sel_hi:[1,0]
    s_mul_i32 s41, s54, 88
    s_add_u32 s41, s41, 32
    s_mul_i32 s42, s26, 7
    s_and_b32 s43, s26, 1
    s_add_u32 s44, s42, s43
    s_lshr_b32 s44, s44, 1
    s_add_u32 s44, s44, s41
    s_lshl_b32 s44, s44, 11
    s_cmp_eq_u32 s43, 0
    s_cselect_b32 s45, 6, 0
    s_add_u32 s45, s45, s42
    s_lshr_b32 s45, s45, 1
    s_add_u32 s45, s45, s41
    s_lshl_b32 s45, s45, 11
    s_lshl_b32 s43, s43, 3
    s_add_u32 s45, s45, s43
    s_waitcnt lgkmcnt(0)
    s_barrier
    ds_read_b128 v[56:59], v163 offset:0
    ds_read_b128 v[60:63], v163 offset:1024
    ds_read_b128 v[64:67], v163 offset:2048
    ds_read_b128 v[68:71], v163 offset:3072
    ds_read_b128 v[72:75], v163 offset:4096
    ds_read_b128 v[76:79], v163 offset:5120
    ds_read_b128 v[80:83], v163 offset:6144
    ds_read_b128 v[84:87], v163 offset:7168
    ds_read_b128 v[88:91], v163 offset:8192
    ds_read_b128 v[92:95], v163 offset:9216
    ds_read_b128 v[96:99], v163 offset:10240
    ds_read_b128 v[100:103], v163 offset:11264
    ds_read_b128 v[104:107], v163 offset:12288
    ds_read_b128 v[108:111], v163 offset:13312
    buffer_load_dwordx4 a[224:227], v159, s[56:59], s86 offen sc1
    buffer_load_dwordx4 a[228:231], v159, s[56:59], s86 offen offset:1024 sc1
    buffer_load_dwordx4 a[232:235], v159, s[56:59], s86 offen offset:2048 sc1
    buffer_load_dwordx4 a[236:239], v159, s[56:59], s86 offen offset:3072 sc1
    s_add_u32 s86, s86, 16384
    buffer_load_dwordx4 a[240:243], v159, s[56:59], s87 offen sc1
    buffer_load_dwordx4 a[244:247], v159, s[56:59], s87 offen offset:1024 sc1
    buffer_load_dwordx4 a[248:251], v159, s[56:59], s87 offen offset:2048 sc1
    buffer_load_dwordx4 a[252:255], v159, s[56:59], s87 offen offset:3072 sc1
    s_add_u32 s87, s87, 16384
    s_waitcnt lgkmcnt(7)
    v_pk_add_f32 v[0:1], v[0:1], v[56:57]
    v_pk_add_f32 v[2:3], v[2:3], v[58:59]
    v_pk_mul_f32 v[0:1], v[0:1], v[176:177]
    v_pk_mul_f32 v[2:3], v[2:3], v[178:179]
    v_pk_add_f32 v[4:5], v[4:5], v[60:61]
    v_pk_add_f32 v[6:7], v[6:7], v[62:63]
    v_pk_mul_f32 v[4:5], v[4:5], v[184:185]
    v_pk_mul_f32 v[6:7], v[6:7], v[186:187]
    v_pk_add_f32 v[8:9], v[8:9], v[64:65]
    v_pk_add_f32 v[10:11], v[10:11], v[66:67]
    v_pk_mul_f32 v[8:9], v[8:9], v[192:193]
    v_pk_mul_f32 v[10:11], v[10:11], v[194:195]
    v_pk_add_f32 v[12:13], v[12:13], v[68:69]
    v_pk_add_f32 v[14:15], v[14:15], v[70:71]
    v_pk_mul_f32 v[12:13], v[12:13], v[200:201]
    v_pk_mul_f32 v[14:15], v[14:15], v[202:203]
    v_pk_add_f32 v[16:17], v[16:17], v[72:73]
    v_pk_add_f32 v[18:19], v[18:19], v[74:75]
    v_pk_mul_f32 v[16:17], v[16:17], v[208:209]
    v_pk_mul_f32 v[18:19], v[18:19], v[210:211]
    v_pk_add_f32 v[20:21], v[20:21], v[76:77]
    v_pk_add_f32 v[22:23], v[22:23], v[78:79]
    v_pk_mul_f32 v[20:21], v[20:21], v[216:217]
    v_pk_mul_f32 v[22:23], v[22:23], v[218:219]
    v_pk_add_f32 v[24:25], v[24:25], v[80:81]
    v_pk_add_f32 v[26:27], v[26:27], v[82:83]
    v_pk_mul_f32 v[24:25], v[24:25], v[224:225]
    v_pk_mul_f32 v[26:27], v[26:27], v[226:227]
    v_cvt_pk_bf16_f32 v232, v0, v1
    v_cvt_pk_bf16_f32 v233, v2, v3
    v_cvt_pk_bf16_f32 v234, v4, v5
    v_cvt_pk_bf16_f32 v235, v6, v7
    buffer_store_dwordx4 v[232:235], v170, s[16:19], s44 offen sc1
    v_cvt_pk_bf16_f32 v236, v8, v9
    v_cvt_pk_bf16_f32 v237, v10, v11
    v_cvt_pk_bf16_f32 v238, v12, v13
    v_cvt_pk_bf16_f32 v239, v14, v15
    buffer_store_dwordx4 v[236:239], v170, s[16:19], s44 offen offset:2048 sc1
    v_cvt_pk_bf16_f32 v240, v16, v17
    v_cvt_pk_bf16_f32 v241, v18, v19
    v_cvt_pk_bf16_f32 v242, v20, v21
    v_cvt_pk_bf16_f32 v243, v22, v23
    s_add_u32 s46, s44, 4096
    buffer_store_dwordx4 v[240:243], v170, s[16:19], s46 offen sc1
    v_cvt_pk_bf16_f32 v248, v24, v25
    v_cvt_pk_bf16_f32 v249, v26, v27
    buffer_store_dwordx2 v[248:249], v170, s[16:19], s45 offen sc1
    s_waitcnt lgkmcnt(0)
    v_pk_add_f32 v[28:29], v[28:29], v[84:85]
    v_pk_add_f32 v[30:31], v[30:31], v[86:87]
    v_pk_mul_f32 v[28:29], v[28:29], v[180:181]
    v_pk_mul_f32 v[30:31], v[30:31], v[182:183]
    v_pk_add_f32 v[32:33], v[32:33], v[88:89]
    v_pk_add_f32 v[34:35], v[34:35], v[90:91]
    v_pk_mul_f32 v[32:33], v[32:33], v[188:189]
    v_pk_mul_f32 v[34:35], v[34:35], v[190:191]
    v_pk_add_f32 v[36:37], v[36:37], v[92:93]
    v_pk_add_f32 v[38:39], v[38:39], v[94:95]
    v_pk_mul_f32 v[36:37], v[36:37], v[196:197]
    v_pk_mul_f32 v[38:39], v[38:39], v[198:199]
    v_pk_add_f32 v[40:41], v[40:41], v[96:97]
    v_pk_add_f32 v[42:43], v[42:43], v[98:99]
    v_pk_mul_f32 v[40:41], v[40:41], v[204:205]
    v_pk_mul_f32 v[42:43], v[42:43], v[206:207]
    v_pk_add_f32 v[44:45], v[44:45], v[100:101]
    v_pk_add_f32 v[46:47], v[46:47], v[102:103]
    v_pk_mul_f32 v[44:45], v[44:45], v[212:213]
    v_pk_mul_f32 v[46:47], v[46:47], v[214:215]
    v_pk_add_f32 v[48:49], v[48:49], v[104:105]
    v_pk_add_f32 v[50:51], v[50:51], v[106:107]
    v_pk_mul_f32 v[48:49], v[48:49], v[220:221]
    v_pk_mul_f32 v[50:51], v[50:51], v[222:223]
    v_pk_add_f32 v[52:53], v[52:53], v[108:109]
    v_pk_add_f32 v[54:55], v[54:55], v[110:111]
    v_pk_mul_f32 v[52:53], v[52:53], v[228:229]
    v_pk_mul_f32 v[54:55], v[54:55], v[230:231]
    v_cvt_pk_bf16_f32 v244, v28, v29
    v_cvt_pk_bf16_f32 v245, v30, v31
    v_cvt_pk_bf16_f32 v246, v32, v33
    v_cvt_pk_bf16_f32 v247, v34, v35
    buffer_store_dwordx4 v[244:247], v170, s[16:19], s44 offen offset:1024 sc1
    v_cvt_pk_bf16_f32 v232, v36, v37
    v_cvt_pk_bf16_f32 v233, v38, v39
    v_cvt_pk_bf16_f32 v234, v40, v41
    v_cvt_pk_bf16_f32 v235, v42, v43
    buffer_store_dwordx4 v[232:235], v170, s[16:19], s44 offen offset:3072 sc1
    v_cvt_pk_bf16_f32 v236, v44, v45
    v_cvt_pk_bf16_f32 v237, v46, v47
    v_cvt_pk_bf16_f32 v238, v48, v49
    v_cvt_pk_bf16_f32 v239, v50, v51
    s_add_u32 s46, s44, 4096
    buffer_store_dwordx4 v[236:239], v170, s[16:19], s46 offen offset:1024 sc1
    v_cvt_pk_bf16_f32 v250, v52, v53
    v_cvt_pk_bf16_f32 v251, v54, v55
    buffer_store_dwordx2 v[250:251], v170, s[16:19], s45 offen offset:1024 sc1
    v_and_b32 v124, 15, v123
    v_lshlrev_b32 v124, 2, v124
    v_add_u32 v124, 0x1c60800, v124
    v_mov_b32 v0, 0
    v_mov_b32 v1, 0
    v_mov_b32 v2, 0
    v_mov_b32 v3, 0
    v_mov_b32 v4, 0
    v_mov_b32 v5, 0
    v_mov_b32 v6, 0
    v_mov_b32 v7, 0
    v_mov_b32 v8, 0
    v_mov_b32 v9, 0
    v_mov_b32 v10, 0
    v_mov_b32 v11, 0
    v_mov_b32 v12, 0
    v_mov_b32 v13, 0
    v_mov_b32 v14, 0
    v_mov_b32 v15, 0
    v_mov_b32 v16, 0
    v_mov_b32 v17, 0
    v_mov_b32 v18, 0
    v_mov_b32 v19, 0
    v_mov_b32 v20, 0
    v_mov_b32 v21, 0
    v_mov_b32 v22, 0
    v_mov_b32 v23, 0
    v_mov_b32 v24, 0
    v_mov_b32 v25, 0
    v_mov_b32 v26, 0
    v_mov_b32 v27, 0
    v_mov_b32 v28, 0
    v_mov_b32 v29, 0
    v_mov_b32 v30, 0
    v_mov_b32 v31, 0
    v_mov_b32 v32, 0
    v_mov_b32 v33, 0
    v_mov_b32 v34, 0
    v_mov_b32 v35, 0
    v_mov_b32 v36, 0
    v_mov_b32 v37, 0
    v_mov_b32 v38, 0
    v_mov_b32 v39, 0
    v_mov_b32 v40, 0
    v_mov_b32 v41, 0
    v_mov_b32 v42, 0
    v_mov_b32 v43, 0
    v_mov_b32 v44, 0
    v_mov_b32 v45, 0
    v_mov_b32 v46, 0
    v_mov_b32 v47, 0
    v_mov_b32 v48, 0
    v_mov_b32 v49, 0
    v_mov_b32 v50, 0
    v_mov_b32 v51, 0
    v_mov_b32 v52, 0
    v_mov_b32 v53, 0
    v_mov_b32 v54, 0
    v_mov_b32 v55, 0
    v_mov_b32 v56, 0
    v_mov_b32 v57, 0
    v_mov_b32 v58, 0
    v_mov_b32 v59, 0
    v_mov_b32 v60, 0
    v_mov_b32 v61, 0
    v_mov_b32 v62, 0
    v_mov_b32 v63, 0
    s_lshl_b32 s49, s26, 2
    s_add_u32 s49, s49, s53
    s_waitcnt vmcnt(54)
    s_barrier
    ds_read_b64_tr_b16 a[0:1], v172 offset:0
    ds_read_b64_tr_b16 a[2:3], v172 offset:2048
    ds_read_b64_tr_b16 a[4:5], v173 offset:0
    ds_read_b64_tr_b16 a[6:7], v173 offset:2048
    ds_read_b64_tr_b16 a[8:9], v174 offset:0
    ds_read_b64_tr_b16 a[10:11], v174 offset:2048
    ds_read_b64_tr_b16 a[12:13], v175 offset:0
    ds_read_b64_tr_b16 a[14:15], v175 offset:2048
    ds_read_b64_tr_b16 a[16:17], v172 offset:4096
    ds_read_b64_tr_b16 a[18:19], v172 offset:6144
    ds_read_b64_tr_b16 a[20:21], v173 offset:4096
    ds_read_b64_tr_b16 a[22:23], v173 offset:6144
    ds_read_b64_tr_b16 a[24:25], v174 offset:4096
    ds_read_b64_tr_b16 a[26:27], v174 offset:6144
    ds_read_b64_tr_b16 a[28:29], v175 offset:4096
    ds_read_b64_tr_b16 a[30:31], v175 offset:6144
    s_waitcnt vmcnt(46) lgkmcnt(0)
    s_barrier
    v_mfma_f32_16x16x32_bf16 v[0:3], a[0:3], a[128:131], v[0:3]
    ds_read_b64_tr_b16 a[32:33], v172 offset:8192
    ds_read_b64_tr_b16 a[34:35], v172 offset:10240
    v_mfma_f32_16x16x32_bf16 v[16:19], a[0:3], a[132:135], v[16:19]
    ds_read_b64_tr_b16 a[36:37], v173 offset:8192
    v_mfma_f32_16x16x32_bf16 v[4:7], a[4:7], a[128:131], v[4:7]
    ds_read_b64_tr_b16 a[38:39], v173 offset:10240
    v_mfma_f32_16x16x32_bf16 v[20:23], a[4:7], a[132:135], v[20:23]
    ds_read_b64_tr_b16 a[40:41], v174 offset:8192
    ds_read_b64_tr_b16 a[42:43], v174 offset:10240
    v_mfma_f32_16x16x32_bf16 v[8:11], a[8:11], a[128:131], v[8:11]
    ds_read_b64_tr_b16 a[44:45], v175 offset:8192
    v_mfma_f32_16x16x32_bf16 v[24:27], a[8:11], a[132:135], v[24:27]
    ds_read_b64_tr_b16 a[46:47], v175 offset:10240
    v_mfma_f32_16x16x32_bf16 v[12:15], a[12:15], a[128:131], v[12:15]
    ds_read_b64_tr_b16 a[48:49], v172 offset:12288
    ds_read_b64_tr_b16 a[50:51], v172 offset:14336
    v_mfma_f32_16x16x32_bf16 v[28:31], a[12:15], a[132:135], v[28:31]
    ds_read_b64_tr_b16 a[52:53], v173 offset:12288
    v_mfma_f32_16x16x32_bf16 v[0:3], a[16:19], a[136:139], v[0:3]
    ds_read_b64_tr_b16 a[54:55], v173 offset:14336
    v_mfma_f32_16x16x32_bf16 v[16:19], a[16:19], a[140:143], v[16:19]
    ds_read_b64_tr_b16 a[56:57], v174 offset:12288
    ds_read_b64_tr_b16 a[58:59], v174 offset:14336
    v_mfma_f32_16x16x32_bf16 v[4:7], a[20:23], a[136:139], v[4:7]
    ds_read_b64_tr_b16 a[60:61], v175 offset:12288
    v_mfma_f32_16x16x32_bf16 v[20:23], a[20:23], a[140:143], v[20:23]
    ds_read_b64_tr_b16 a[62:63], v175 offset:14336
    v_mfma_f32_16x16x32_bf16 v[8:11], a[24:27], a[136:139], v[8:11]
    v_mfma_f32_16x16x32_bf16 v[24:27], a[24:27], a[140:143], v[24:27]
    v_mfma_f32_16x16x32_bf16 v[12:15], a[28:31], a[136:139], v[12:15]
    v_mfma_f32_16x16x32_bf16 v[28:31], a[28:31], a[140:143], v[28:31]
    s_waitcnt vmcnt(42) lgkmcnt(0)
    s_barrier
    v_mfma_f32_16x16x32_bf16 v[0:3], a[32:35], a[144:147], v[0:3]
    ds_read_b64_tr_b16 a[0:1], v172 offset:16384
    ds_read_b64_tr_b16 a[2:3], v172 offset:18432
    v_mfma_f32_16x16x32_bf16 v[16:19], a[32:35], a[148:151], v[16:19]
    ds_read_b64_tr_b16 a[4:5], v173 offset:16384
    v_mfma_f32_16x16x32_bf16 v[4:7], a[36:39], a[144:147], v[4:7]
    ds_read_b64_tr_b16 a[6:7], v173 offset:18432
    v_mfma_f32_16x16x32_bf16 v[20:23], a[36:39], a[148:151], v[20:23]
    ds_read_b64_tr_b16 a[8:9], v174 offset:16384
    ds_read_b64_tr_b16 a[10:11], v174 offset:18432
    v_mfma_f32_16x16x32_bf16 v[8:11], a[40:43], a[144:147], v[8:11]
    ds_read_b64_tr_b16 a[12:13], v175 offset:16384
    v_mfma_f32_16x16x32_bf16 v[24:27], a[40:43], a[148:151], v[24:27]
    ds_read_b64_tr_b16 a[14:15], v175 offset:18432
    v_mfma_f32_16x16x32_bf16 v[12:15], a[44:47], a[144:147], v[12:15]
    ds_read_b64_tr_b16 a[16:17], v172 offset:20480
    ds_read_b64_tr_b16 a[18:19], v172 offset:22528
    v_mfma_f32_16x16x32_bf16 v[28:31], a[44:47], a[148:151], v[28:31]
    ds_read_b64_tr_b16 a[20:21], v173 offset:20480
    v_mfma_f32_16x16x32_bf16 v[0:3], a[48:51], a[152:155], v[0:3]
    ds_read_b64_tr_b16 a[22:23], v173 offset:22528
    v_mfma_f32_16x16x32_bf16 v[16:19], a[48:51], a[156:159], v[16:19]
    ds_read_b64_tr_b16 a[24:25], v174 offset:20480
    ds_read_b64_tr_b16 a[26:27], v174 offset:22528
    v_mfma_f32_16x16x32_bf16 v[4:7], a[52:55], a[152:155], v[4:7]
    ds_read_b64_tr_b16 a[28:29], v175 offset:20480
    v_mfma_f32_16x16x32_bf16 v[20:23], a[52:55], a[156:159], v[20:23]
    ds_read_b64_tr_b16 a[30:31], v175 offset:22528
    v_mfma_f32_16x16x32_bf16 v[8:11], a[56:59], a[152:155], v[8:11]
    v_mfma_f32_16x16x32_bf16 v[24:27], a[56:59], a[156:159], v[24:27]
    v_mfma_f32_16x16x32_bf16 v[12:15], a[60:63], a[152:155], v[12:15]
    v_mfma_f32_16x16x32_bf16 v[28:31], a[60:63], a[156:159], v[28:31]
    s_waitcnt vmcnt(36) lgkmcnt(0)
    s_barrier
    v_mfma_f32_16x16x32_bf16 v[0:3], a[0:3], a[160:163], v[0:3]
    ds_read_b64_tr_b16 a[32:33], v172 offset:24576
    ds_read_b64_tr_b16 a[34:35], v172 offset:26624
    v_mfma_f32_16x16x32_bf16 v[16:19], a[0:3], a[164:167], v[16:19]
    ds_read_b64_tr_b16 a[36:37], v173 offset:24576
    v_mfma_f32_16x16x32_bf16 v[4:7], a[4:7], a[160:163], v[4:7]
    ds_read_b64_tr_b16 a[38:39], v173 offset:26624
    v_mfma_f32_16x16x32_bf16 v[20:23], a[4:7], a[164:167], v[20:23]
    ds_read_b64_tr_b16 a[40:41], v174 offset:24576
    ds_read_b64_tr_b16 a[42:43], v174 offset:26624
    v_mfma_f32_16x16x32_bf16 v[8:11], a[8:11], a[160:163], v[8:11]
    ds_read_b64_tr_b16 a[44:45], v175 offset:24576
    v_mfma_f32_16x16x32_bf16 v[24:27], a[8:11], a[164:167], v[24:27]
    ds_read_b64_tr_b16 a[46:47], v175 offset:26624
    v_mfma_f32_16x16x32_bf16 v[12:15], a[12:15], a[160:163], v[12:15]
    ds_read_b64_tr_b16 a[48:49], v172 offset:28672
    ds_read_b64_tr_b16 a[50:51], v172 offset:30720
    v_mfma_f32_16x16x32_bf16 v[28:31], a[12:15], a[164:167], v[28:31]
    ds_read_b64_tr_b16 a[52:53], v173 offset:28672
    v_mfma_f32_16x16x32_bf16 v[0:3], a[16:19], a[168:171], v[0:3]
    ds_read_b64_tr_b16 a[54:55], v173 offset:30720
    v_mfma_f32_16x16x32_bf16 v[16:19], a[16:19], a[172:175], v[16:19]
    ds_read_b64_tr_b16 a[56:57], v174 offset:28672
    ds_read_b64_tr_b16 a[58:59], v174 offset:30720
    v_mfma_f32_16x16x32_bf16 v[4:7], a[20:23], a[168:171], v[4:7]
    ds_read_b64_tr_b16 a[60:61], v175 offset:28672
    v_mfma_f32_16x16x32_bf16 v[20:23], a[20:23], a[172:175], v[20:23]
    ds_read_b64_tr_b16 a[62:63], v175 offset:30720
    v_mfma_f32_16x16x32_bf16 v[8:11], a[24:27], a[168:171], v[8:11]
    v_mfma_f32_16x16x32_bf16 v[24:27], a[24:27], a[172:175], v[24:27]
    v_mfma_f32_16x16x32_bf16 v[12:15], a[28:31], a[168:171], v[12:15]
    v_mfma_f32_16x16x32_bf16 v[28:31], a[28:31], a[172:175], v[28:31]
    s_waitcnt vmcnt(30) lgkmcnt(0)
    s_barrier
    v_mfma_f32_16x16x32_bf16 v[0:3], a[32:35], a[176:179], v[0:3]
    ds_read_b64_tr_b16 a[0:1], v172 offset:32768
    ds_read_b64_tr_b16 a[2:3], v172 offset:34816
    v_mfma_f32_16x16x32_bf16 v[16:19], a[32:35], a[180:183], v[16:19]
    ds_read_b64_tr_b16 a[4:5], v173 offset:32768
    v_mfma_f32_16x16x32_bf16 v[4:7], a[36:39], a[176:179], v[4:7]
    ds_read_b64_tr_b16 a[6:7], v173 offset:34816
    v_mfma_f32_16x16x32_bf16 v[20:23], a[36:39], a[180:183], v[20:23]
    ds_read_b64_tr_b16 a[8:9], v174 offset:32768
    ds_read_b64_tr_b16 a[10:11], v174 offset:34816
    v_mfma_f32_16x16x32_bf16 v[8:11], a[40:43], a[176:179], v[8:11]
    ds_read_b64_tr_b16 a[12:13], v175 offset:32768
    v_mfma_f32_16x16x32_bf16 v[24:27], a[40:43], a[180:183], v[24:27]
    ds_read_b64_tr_b16 a[14:15], v175 offset:34816
    v_mfma_f32_16x16x32_bf16 v[12:15], a[44:47], a[176:179], v[12:15]
    ds_read_b64_tr_b16 a[16:17], v172 offset:36864
    ds_read_b64_tr_b16 a[18:19], v172 offset:38912
    v_mfma_f32_16x16x32_bf16 v[28:31], a[44:47], a[180:183], v[28:31]
    ds_read_b64_tr_b16 a[20:21], v173 offset:36864
    v_mfma_f32_16x16x32_bf16 v[0:3], a[48:51], a[184:187], v[0:3]
    ds_read_b64_tr_b16 a[22:23], v173 offset:38912
    v_mfma_f32_16x16x32_bf16 v[16:19], a[48:51], a[188:191], v[16:19]
    ds_read_b64_tr_b16 a[24:25], v174 offset:36864
    ds_read_b64_tr_b16 a[26:27], v174 offset:38912
    v_mfma_f32_16x16x32_bf16 v[4:7], a[52:55], a[184:187], v[4:7]
    ds_read_b64_tr_b16 a[28:29], v175 offset:36864
    v_mfma_f32_16x16x32_bf16 v[20:23], a[52:55], a[188:191], v[20:23]
    ds_read_b64_tr_b16 a[30:31], v175 offset:38912
    v_mfma_f32_16x16x32_bf16 v[8:11], a[56:59], a[184:187], v[8:11]
    v_mfma_f32_16x16x32_bf16 v[24:27], a[56:59], a[188:191], v[24:27]
    v_mfma_f32_16x16x32_bf16 v[12:15], a[60:63], a[184:187], v[12:15]
    v_mfma_f32_16x16x32_bf16 v[28:31], a[60:63], a[188:191], v[28:31]
    s_waitcnt vmcnt(0) lgkmcnt(0)
    s_barrier
    s_cmp_eq_u32 s24, 0
    s_cbranch_scc0 L_p3_gflag
    v_mov_b32 v252, 0x1c60800
    v_mov_b32 v253, 1
    s_mov_b64 exec, 1
    buffer_store_dword v253, v252, s[16:19], s49 offen sc1
    s_mov_b64 exec, -1
L_p3_gflag:
    v_mfma_f32_16x16x32_bf16 v[0:3], a[0:3], a[192:195], v[0:3]
    s_add_u32 m0, s30, 0
    ds_read_b64_tr_b16 a[32:33], v172 offset:40960
    v_mfma_f32_16x16x32_bf16 v[16:19], a[0:3], a[196:199], v[16:19]
    buffer_load_dwordx4 v157, s[60:63], s80 offen lds
    ds_read_b64_tr_b16 a[34:35], v172 offset:43008
    v_mfma_f32_16x16x32_bf16 v[4:7], a[4:7], a[192:195], v[4:7]
    buffer_load_dwordx4 v158, s[60:63], s80 offen offset:1024 lds
    ds_read_b64_tr_b16 a[36:37], v173 offset:40960
    v_mfma_f32_16x16x32_bf16 v[20:23], a[4:7], a[196:199], v[20:23]
    ds_read_b64_tr_b16 a[38:39], v173 offset:43008
    ds_read_b64_tr_b16 a[40:41], v174 offset:40960
    v_mfma_f32_16x16x32_bf16 v[8:11], a[8:11], a[192:195], v[8:11]
    ds_read_b64_tr_b16 a[42:43], v174 offset:43008
    ds_read_b64_tr_b16 a[44:45], v175 offset:40960
    v_mfma_f32_16x16x32_bf16 v[24:27], a[8:11], a[196:199], v[24:27]
    ds_read_b64_tr_b16 a[46:47], v175 offset:43008
    s_add_u32 s80, s80, 524288
    v_mfma_f32_16x16x32_bf16 v[12:15], a[12:15], a[192:195], v[12:15]
    ds_read_b64_tr_b16 a[48:49], v172 offset:45056
    ds_read_b64_tr_b16 a[50:51], v172 offset:47104
    v_mfma_f32_16x16x32_bf16 v[28:31], a[12:15], a[196:199], v[28:31]
    ds_read_b64_tr_b16 a[52:53], v173 offset:45056
    v_mfma_f32_16x16x32_bf16 v[0:3], a[16:19], a[200:203], v[0:3]
    ds_read_b64_tr_b16 a[54:55], v173 offset:47104
    buffer_load_dwordx4 a[128:131], v159, s[56:59], s84 offen sc1
    v_mfma_f32_16x16x32_bf16 v[16:19], a[16:19], a[204:207], v[16:19]
    ds_read_b64_tr_b16 a[56:57], v174 offset:45056
    ds_read_b64_tr_b16 a[58:59], v174 offset:47104
    v_mfma_f32_16x16x32_bf16 v[4:7], a[20:23], a[200:203], v[4:7]
    ds_read_b64_tr_b16 a[60:61], v175 offset:45056
    buffer_load_dwordx4 a[132:135], v159, s[56:59], s84 offen offset:1024 sc1
    v_mfma_f32_16x16x32_bf16 v[20:23], a[20:23], a[204:207], v[20:23]
    ds_read_b64_tr_b16 a[62:63], v175 offset:47104
    v_mfma_f32_16x16x32_bf16 v[8:11], a[24:27], a[200:203], v[8:11]
    v_mfma_f32_16x16x32_bf16 v[24:27], a[24:27], a[204:207], v[24:27]
    v_mfma_f32_16x16x32_bf16 v[12:15], a[28:31], a[200:203], v[12:15]
    v_mfma_f32_16x16x32_bf16 v[28:31], a[28:31], a[204:207], v[28:31]
    buffer_load_dwordx4 a[136:139], v159, s[56:59], s84 offen offset:2048 sc1
    buffer_load_dwordx4 a[140:143], v159, s[56:59], s84 offen offset:3072 sc1
    s_add_u32 s84, s84, 16384
    s_waitcnt vmcnt(16) lgkmcnt(0)
    s_barrier
    v_mfma_f32_16x16x32_bf16 v[0:3], a[32:35], a[208:211], v[0:3]
    s_add_u32 m0, s30, 8192
    ds_read_b64_tr_b16 a[0:1], v172 offset:49152
    v_mfma_f32_16x16x32_bf16 v[16:19], a[32:35], a[212:215], v[16:19]
    buffer_load_dwordx4 v157, s[60:63], s81 offen lds
    ds_read_b64_tr_b16 a[2:3], v172 offset:51200
    v_mfma_f32_16x16x32_bf16 v[4:7], a[36:39], a[208:211], v[4:7]
    buffer_load_dwordx4 v158, s[60:63], s81 offen offset:1024 lds
    ds_read_b64_tr_b16 a[4:5], v173 offset:49152
    v_mfma_f32_16x16x32_bf16 v[20:23], a[36:39], a[212:215], v[20:23]
    ds_read_b64_tr_b16 a[6:7], v173 offset:51200
    ds_read_b64_tr_b16 a[8:9], v174 offset:49152
    v_mfma_f32_16x16x32_bf16 v[8:11], a[40:43], a[208:211], v[8:11]
    ds_read_b64_tr_b16 a[10:11], v174 offset:51200
    ds_read_b64_tr_b16 a[12:13], v175 offset:49152
    v_mfma_f32_16x16x32_bf16 v[24:27], a[40:43], a[212:215], v[24:27]
    ds_read_b64_tr_b16 a[14:15], v175 offset:51200
    s_add_u32 s81, s81, 524288
    v_mfma_f32_16x16x32_bf16 v[12:15], a[44:47], a[208:211], v[12:15]
    ds_read_b64_tr_b16 a[16:17], v172 offset:53248
    ds_read_b64_tr_b16 a[18:19], v172 offset:55296
    v_mfma_f32_16x16x32_bf16 v[28:31], a[44:47], a[212:215], v[28:31]
    ds_read_b64_tr_b16 a[20:21], v173 offset:53248
    v_mfma_f32_16x16x32_bf16 v[0:3], a[48:51], a[216:219], v[0:3]
    ds_read_b64_tr_b16 a[22:23], v173 offset:55296
    buffer_load_dwordx4 a[144:147], v159, s[56:59], s85 offen sc1
    v_mfma_f32_16x16x32_bf16 v[16:19], a[48:51], a[220:223], v[16:19]
    ds_read_b64_tr_b16 a[24:25], v174 offset:53248
    ds_read_b64_tr_b16 a[26:27], v174 offset:55296
    v_mfma_f32_16x16x32_bf16 v[4:7], a[52:55], a[216:219], v[4:7]
    ds_read_b64_tr_b16 a[28:29], v175 offset:53248
    buffer_load_dwordx4 a[148:151], v159, s[56:59], s85 offen offset:1024 sc1
    v_mfma_f32_16x16x32_bf16 v[20:23], a[52:55], a[220:223], v[20:23]
    ds_read_b64_tr_b16 a[30:31], v175 offset:55296
    v_mfma_f32_16x16x32_bf16 v[8:11], a[56:59], a[216:219], v[8:11]
    v_mfma_f32_16x16x32_bf16 v[24:27], a[56:59], a[220:223], v[24:27]
    v_mfma_f32_16x16x32_bf16 v[12:15], a[60:63], a[216:219], v[12:15]
    v_mfma_f32_16x16x32_bf16 v[28:31], a[60:63], a[220:223], v[28:31]
    buffer_load_dwordx4 a[152:155], v159, s[56:59], s85 offen offset:2048 sc1
    buffer_load_dwordx4 a[156:159], v159, s[56:59], s85 offen offset:3072 sc1
    s_add_u32 s85, s85, 16384
    s_waitcnt vmcnt(16) lgkmcnt(0)
    s_barrier
    v_mfma_f32_16x16x32_bf16 v[0:3], a[0:3], a[224:227], v[0:3]
    s_add_u32 m0, s30, 16384
    ds_read_b64_tr_b16 a[32:33], v172 offset:57344
    v_mfma_f32_16x16x32_bf16 v[16:19], a[0:3], a[228:231], v[16:19]
    buffer_load_dwordx4 v157, s[60:63], s82 offen lds
    ds_read_b64_tr_b16 a[34:35], v172 offset:59392
    v_mfma_f32_16x16x32_bf16 v[4:7], a[4:7], a[224:227], v[4:7]
    buffer_load_dwordx4 v158, s[60:63], s82 offen offset:1024 lds
    ds_read_b64_tr_b16 a[36:37], v173 offset:57344
    v_mfma_f32_16x16x32_bf16 v[20:23], a[4:7], a[228:231], v[20:23]
    ds_read_b64_tr_b16 a[38:39], v173 offset:59392
    ds_read_b64_tr_b16 a[40:41], v174 offset:57344
    v_mfma_f32_16x16x32_bf16 v[8:11], a[8:11], a[224:227], v[8:11]
    ds_read_b64_tr_b16 a[42:43], v174 offset:59392
    ds_read_b64_tr_b16 a[44:45], v175 offset:57344
    v_mfma_f32_16x16x32_bf16 v[24:27], a[8:11], a[228:231], v[24:27]
    ds_read_b64_tr_b16 a[46:47], v175 offset:59392
    s_add_u32 s82, s82, 524288
    v_mfma_f32_16x16x32_bf16 v[12:15], a[12:15], a[224:227], v[12:15]
    ds_read_b64_tr_b16 a[48:49], v172 offset:61440
    ds_read_b64_tr_b16 a[50:51], v172 offset:63488
    v_mfma_f32_16x16x32_bf16 v[28:31], a[12:15], a[228:231], v[28:31]
    ds_read_b64_tr_b16 a[52:53], v173 offset:61440
    v_mfma_f32_16x16x32_bf16 v[0:3], a[16:19], a[232:235], v[0:3]
    ds_read_b64_tr_b16 a[54:55], v173 offset:63488
    buffer_load_dwordx4 a[160:163], v159, s[56:59], s86 offen sc1
    v_mfma_f32_16x16x32_bf16 v[16:19], a[16:19], a[236:239], v[16:19]
    ds_read_b64_tr_b16 a[56:57], v174 offset:61440
    ds_read_b64_tr_b16 a[58:59], v174 offset:63488
    v_mfma_f32_16x16x32_bf16 v[4:7], a[20:23], a[232:235], v[4:7]
    ds_read_b64_tr_b16 a[60:61], v175 offset:61440
    buffer_load_dwordx4 a[164:167], v159, s[56:59], s86 offen offset:1024 sc1
    v_mfma_f32_16x16x32_bf16 v[20:23], a[20:23], a[236:239], v[20:23]
    ds_read_b64_tr_b16 a[62:63], v175 offset:63488
    v_mfma_f32_16x16x32_bf16 v[8:11], a[24:27], a[232:235], v[8:11]
    v_mfma_f32_16x16x32_bf16 v[24:27], a[24:27], a[236:239], v[24:27]
    v_mfma_f32_16x16x32_bf16 v[12:15], a[28:31], a[232:235], v[12:15]
    v_mfma_f32_16x16x32_bf16 v[28:31], a[28:31], a[236:239], v[28:31]
    buffer_load_dwordx4 a[168:171], v159, s[56:59], s86 offen offset:2048 sc1
    buffer_load_dwordx4 a[172:175], v159, s[56:59], s86 offen offset:3072 sc1
    s_add_u32 s86, s86, 16384
    s_waitcnt vmcnt(16) lgkmcnt(0)
    s_barrier
    v_mfma_f32_16x16x32_bf16 v[0:3], a[32:35], a[240:243], v[0:3]
    s_add_u32 m0, s30, 24576
    ds_read_b64_tr_b16 a[0:1], v172 offset:0
    v_mfma_f32_16x16x32_bf16 v[16:19], a[32:35], a[244:247], v[16:19]
    buffer_load_dwordx4 v157, s[60:63], s83 offen lds
    ds_read_b64_tr_b16 a[2:3], v172 offset:2048
    v_mfma_f32_16x16x32_bf16 v[4:7], a[36:39], a[240:243], v[4:7]
    buffer_load_dwordx4 v158, s[60:63], s83 offen offset:1024 lds
    ds_read_b64_tr_b16 a[4:5], v173 offset:0
    v_mfma_f32_16x16x32_bf16 v[20:23], a[36:39], a[244:247], v[20:23]
    ds_read_b64_tr_b16 a[6:7], v173 offset:2048
    ds_read_b64_tr_b16 a[8:9], v174 offset:0
    v_mfma_f32_16x16x32_bf16 v[8:11], a[40:43], a[240:243], v[8:11]
    ds_read_b64_tr_b16 a[10:11], v174 offset:2048
    ds_read_b64_tr_b16 a[12:13], v175 offset:0
    v_mfma_f32_16x16x32_bf16 v[24:27], a[40:43], a[244:247], v[24:27]
    ds_read_b64_tr_b16 a[14:15], v175 offset:2048
    s_add_u32 s83, s83, 524288
    v_mfma_f32_16x16x32_bf16 v[12:15], a[44:47], a[240:243], v[12:15]
    ds_read_b64_tr_b16 a[16:17], v172 offset:4096
    ds_read_b64_tr_b16 a[18:19], v172 offset:6144
    v_mfma_f32_16x16x32_bf16 v[28:31], a[44:47], a[244:247], v[28:31]
    ds_read_b64_tr_b16 a[20:21], v173 offset:4096
    v_mfma_f32_16x16x32_bf16 v[0:3], a[48:51], a[248:251], v[0:3]
    ds_read_b64_tr_b16 a[22:23], v173 offset:6144
    buffer_load_dwordx4 a[176:179], v159, s[56:59], s87 offen sc1
    v_mfma_f32_16x16x32_bf16 v[16:19], a[48:51], a[252:255], v[16:19]
    ds_read_b64_tr_b16 a[24:25], v174 offset:4096
    ds_read_b64_tr_b16 a[26:27], v174 offset:6144
    v_mfma_f32_16x16x32_bf16 v[4:7], a[52:55], a[248:251], v[4:7]
    ds_read_b64_tr_b16 a[28:29], v175 offset:4096
    buffer_load_dwordx4 a[180:183], v159, s[56:59], s87 offen offset:1024 sc1
    v_mfma_f32_16x16x32_bf16 v[20:23], a[52:55], a[252:255], v[20:23]
    ds_read_b64_tr_b16 a[30:31], v175 offset:6144
    v_mfma_f32_16x16x32_bf16 v[8:11], a[56:59], a[248:251], v[8:11]
    v_mfma_f32_16x16x32_bf16 v[24:27], a[56:59], a[252:255], v[24:27]
    v_mfma_f32_16x16x32_bf16 v[12:15], a[60:63], a[248:251], v[12:15]
    v_mfma_f32_16x16x32_bf16 v[28:31], a[60:63], a[252:255], v[28:31]
    buffer_load_dwordx4 a[184:187], v159, s[56:59], s87 offen offset:2048 sc1
    buffer_load_dwordx4 a[188:191], v159, s[56:59], s87 offen offset:3072 sc1
    s_add_u32 s87, s87, 16384
    s_waitcnt vmcnt(16) lgkmcnt(0)
    s_barrier
    v_mfma_f32_16x16x32_bf16 v[0:3], a[0:3], a[128:131], v[0:3]
    s_add_u32 m0, s30, 0
    ds_read_b64_tr_b16 a[32:33], v172 offset:8192
    v_mfma_f32_16x16x32_bf16 v[16:19], a[0:3], a[132:135], v[16:19]
    buffer_load_dwordx4 v157, s[60:63], s80 offen lds
    ds_read_b64_tr_b16 a[34:35], v172 offset:10240
    v_mfma_f32_16x16x32_bf16 v[4:7], a[4:7], a[128:131], v[4:7]
    buffer_load_dwordx4 v158, s[60:63], s80 offen offset:1024 lds
    ds_read_b64_tr_b16 a[36:37], v173 offset:8192
    v_mfma_f32_16x16x32_bf16 v[20:23], a[4:7], a[132:135], v[20:23]
    ds_read_b64_tr_b16 a[38:39], v173 offset:10240
    ds_read_b64_tr_b16 a[40:41], v174 offset:8192
    v_mfma_f32_16x16x32_bf16 v[8:11], a[8:11], a[128:131], v[8:11]
    ds_read_b64_tr_b16 a[42:43], v174 offset:10240
    ds_read_b64_tr_b16 a[44:45], v175 offset:8192
    v_mfma_f32_16x16x32_bf16 v[24:27], a[8:11], a[132:135], v[24:27]
    ds_read_b64_tr_b16 a[46:47], v175 offset:10240
    s_add_u32 s80, s80, 524288
    v_mfma_f32_16x16x32_bf16 v[12:15], a[12:15], a[128:131], v[12:15]
    ds_read_b64_tr_b16 a[48:49], v172 offset:12288
    ds_read_b64_tr_b16 a[50:51], v172 offset:14336
    v_mfma_f32_16x16x32_bf16 v[28:31], a[12:15], a[132:135], v[28:31]
    ds_read_b64_tr_b16 a[52:53], v173 offset:12288
    buffer_load_dword v125, v124, s[16:19], s53 offen sc1
    v_mfma_f32_16x16x32_bf16 v[0:3], a[16:19], a[136:139], v[0:3]
    ds_read_b64_tr_b16 a[54:55], v173 offset:14336
    buffer_load_dwordx4 a[128:131], v159, s[56:59], s84 offen sc1
    v_mfma_f32_16x16x32_bf16 v[16:19], a[16:19], a[140:143], v[16:19]
    ds_read_b64_tr_b16 a[56:57], v174 offset:12288
    ds_read_b64_tr_b16 a[58:59], v174 offset:14336
    v_mfma_f32_16x16x32_bf16 v[4:7], a[20:23], a[136:139], v[4:7]
    ds_read_b64_tr_b16 a[60:61], v175 offset:12288
    buffer_load_dwordx4 a[132:135], v159, s[56:59], s84 offen offset:1024 sc1
    v_mfma_f32_16x16x32_bf16 v[20:23], a[20:23], a[140:143], v[20:23]
    ds_read_b64_tr_b16 a[62:63], v175 offset:14336
    v_mfma_f32_16x16x32_bf16 v[8:11], a[24:27], a[136:139], v[8:11]
    v_mfma_f32_16x16x32_bf16 v[24:27], a[24:27], a[140:143], v[24:27]
    v_mfma_f32_16x16x32_bf16 v[12:15], a[28:31], a[136:139], v[12:15]
    v_mfma_f32_16x16x32_bf16 v[28:31], a[28:31], a[140:143], v[28:31]
    buffer_load_dwordx4 a[136:139], v159, s[56:59], s84 offen offset:2048 sc1
    buffer_load_dwordx4 a[140:143], v159, s[56:59], s84 offen offset:3072 sc1
    s_add_u32 s84, s84, 16384
    s_waitcnt vmcnt(16) lgkmcnt(0)
    s_barrier
    v_mfma_f32_16x16x32_bf16 v[0:3], a[32:35], a[144:147], v[0:3]
    s_add_u32 m0, s30, 8192
    ds_read_b64_tr_b16 a[0:1], v172 offset:16384
    v_mfma_f32_16x16x32_bf16 v[16:19], a[32:35], a[148:151], v[16:19]
    buffer_load_dwordx4 v157, s[60:63], s81 offen lds
    ds_read_b64_tr_b16 a[2:3], v172 offset:18432
    v_mfma_f32_16x16x32_bf16 v[4:7], a[36:39], a[144:147], v[4:7]
    buffer_load_dwordx4 v158, s[60:63], s81 offen offset:1024 lds
    ds_read_b64_tr_b16 a[4:5], v173 offset:16384
    v_mfma_f32_16x16x32_bf16 v[20:23], a[36:39], a[148:151], v[20:23]
    ds_read_b64_tr_b16 a[6:7], v173 offset:18432
    ds_read_b64_tr_b16 a[8:9], v174 offset:16384
    v_mfma_f32_16x16x32_bf16 v[8:11], a[40:43], a[144:147], v[8:11]
    ds_read_b64_tr_b16 a[10:11], v174 offset:18432
    ds_read_b64_tr_b16 a[12:13], v175 offset:16384
    v_mfma_f32_16x16x32_bf16 v[24:27], a[40:43], a[148:151], v[24:27]
    ds_read_b64_tr_b16 a[14:15], v175 offset:18432
    s_add_u32 s81, s81, 524288
    v_mfma_f32_16x16x32_bf16 v[12:15], a[44:47], a[144:147], v[12:15]
    ds_read_b64_tr_b16 a[16:17], v172 offset:20480
    ds_read_b64_tr_b16 a[18:19], v172 offset:22528
    v_mfma_f32_16x16x32_bf16 v[28:31], a[44:47], a[148:151], v[28:31]
    ds_read_b64_tr_b16 a[20:21], v173 offset:20480
    v_mfma_f32_16x16x32_bf16 v[0:3], a[48:51], a[152:155], v[0:3]
    ds_read_b64_tr_b16 a[22:23], v173 offset:22528
    buffer_load_dwordx4 a[144:147], v159, s[56:59], s85 offen sc1
    v_mfma_f32_16x16x32_bf16 v[16:19], a[48:51], a[156:159], v[16:19]
    ds_read_b64_tr_b16 a[24:25], v174 offset:20480
    ds_read_b64_tr_b16 a[26:27], v174 offset:22528
    v_mfma_f32_16x16x32_bf16 v[4:7], a[52:55], a[152:155], v[4:7]
    ds_read_b64_tr_b16 a[28:29], v175 offset:20480
    buffer_load_dwordx4 a[148:151], v159, s[56:59], s85 offen offset:1024 sc1
    v_mfma_f32_16x16x32_bf16 v[20:23], a[52:55], a[156:159], v[20:23]
    ds_read_b64_tr_b16 a[30:31], v175 offset:22528
    v_mfma_f32_16x16x32_bf16 v[8:11], a[56:59], a[152:155], v[8:11]
    v_mfma_f32_16x16x32_bf16 v[24:27], a[56:59], a[156:159], v[24:27]
    v_mfma_f32_16x16x32_bf16 v[12:15], a[60:63], a[152:155], v[12:15]
    v_mfma_f32_16x16x32_bf16 v[28:31], a[60:63], a[156:159], v[28:31]
    buffer_load_dwordx4 a[152:155], v159, s[56:59], s85 offen offset:2048 sc1
    buffer_load_dwordx4 a[156:159], v159, s[56:59], s85 offen offset:3072 sc1
    s_add_u32 s85, s85, 16384
    s_waitcnt vmcnt(16) lgkmcnt(0)
    s_barrier
    v_mfma_f32_16x16x32_bf16 v[0:3], a[0:3], a[160:163], v[0:3]
    s_add_u32 m0, s30, 16384
    ds_read_b64_tr_b16 a[32:33], v172 offset:24576
    v_mfma_f32_16x16x32_bf16 v[16:19], a[0:3], a[164:167], v[16:19]
    buffer_load_dwordx4 v157, s[60:63], s82 offen lds
    ds_read_b64_tr_b16 a[34:35], v172 offset:26624
    v_mfma_f32_16x16x32_bf16 v[4:7], a[4:7], a[160:163], v[4:7]
    buffer_load_dwordx4 v158, s[60:63], s82 offen offset:1024 lds
    ds_read_b64_tr_b16 a[36:37], v173 offset:24576
    v_mfma_f32_16x16x32_bf16 v[20:23], a[4:7], a[164:167], v[20:23]
    ds_read_b64_tr_b16 a[38:39], v173 offset:26624
    ds_read_b64_tr_b16 a[40:41], v174 offset:24576
    v_mfma_f32_16x16x32_bf16 v[8:11], a[8:11], a[160:163], v[8:11]
    ds_read_b64_tr_b16 a[42:43], v174 offset:26624
    ds_read_b64_tr_b16 a[44:45], v175 offset:24576
    v_mfma_f32_16x16x32_bf16 v[24:27], a[8:11], a[164:167], v[24:27]
    ds_read_b64_tr_b16 a[46:47], v175 offset:26624
    s_add_u32 s82, s82, 524288
    v_mfma_f32_16x16x32_bf16 v[12:15], a[12:15], a[160:163], v[12:15]
    ds_read_b64_tr_b16 a[48:49], v172 offset:28672
    ds_read_b64_tr_b16 a[50:51], v172 offset:30720
    v_mfma_f32_16x16x32_bf16 v[28:31], a[12:15], a[164:167], v[28:31]
    ds_read_b64_tr_b16 a[52:53], v173 offset:28672
    v_mfma_f32_16x16x32_bf16 v[0:3], a[16:19], a[168:171], v[0:3]
    ds_read_b64_tr_b16 a[54:55], v173 offset:30720
    buffer_load_dwordx4 a[160:163], v159, s[56:59], s86 offen sc1
    v_mfma_f32_16x16x32_bf16 v[16:19], a[16:19], a[172:175], v[16:19]
    ds_read_b64_tr_b16 a[56:57], v174 offset:28672
    ds_read_b64_tr_b16 a[58:59], v174 offset:30720
    v_mfma_f32_16x16x32_bf16 v[4:7], a[20:23], a[168:171], v[4:7]
    ds_read_b64_tr_b16 a[60:61], v175 offset:28672
    buffer_load_dwordx4 a[164:167], v159, s[56:59], s86 offen offset:1024 sc1
    v_mfma_f32_16x16x32_bf16 v[20:23], a[20:23], a[172:175], v[20:23]
    ds_read_b64_tr_b16 a[62:63], v175 offset:30720
    v_mfma_f32_16x16x32_bf16 v[8:11], a[24:27], a[168:171], v[8:11]
    v_mfma_f32_16x16x32_bf16 v[24:27], a[24:27], a[172:175], v[24:27]
    v_mfma_f32_16x16x32_bf16 v[12:15], a[28:31], a[168:171], v[12:15]
    v_mfma_f32_16x16x32_bf16 v[28:31], a[28:31], a[172:175], v[28:31]
    buffer_load_dwordx4 a[168:171], v159, s[56:59], s86 offen offset:2048 sc1
    buffer_load_dwordx4 a[172:175], v159, s[56:59], s86 offen offset:3072 sc1
    s_add_u32 s86, s86, 16384
    s_waitcnt vmcnt(16) lgkmcnt(0)
    s_barrier
    v_mfma_f32_16x16x32_bf16 v[0:3], a[32:35], a[176:179], v[0:3]
    s_add_u32 m0, s30, 24576
    ds_read_b64_tr_b16 a[0:1], v172 offset:0
    v_mfma_f32_16x16x32_bf16 v[16:19], a[32:35], a[180:183], v[16:19]
    buffer_load_dwordx4 v157, s[60:63], s83 offen lds
    ds_read_b64_tr_b16 a[2:3], v172 offset:2048
    v_mfma_f32_16x16x32_bf16 v[4:7], a[36:39], a[176:179], v[4:7]
    buffer_load_dwordx4 v158, s[60:63], s83 offen offset:1024 lds
    ds_read_b64_tr_b16 a[4:5], v173 offset:0
    v_mfma_f32_16x16x32_bf16 v[20:23], a[36:39], a[180:183], v[20:23]
    ds_read_b64_tr_b16 a[6:7], v173 offset:2048
    ds_read_b64_tr_b16 a[8:9], v174 offset:0
    v_mfma_f32_16x16x32_bf16 v[8:11], a[40:43], a[176:179], v[8:11]
    ds_read_b64_tr_b16 a[10:11], v174 offset:2048
    ds_read_b64_tr_b16 a[12:13], v175 offset:0
    v_mfma_f32_16x16x32_bf16 v[24:27], a[40:43], a[180:183], v[24:27]
    ds_read_b64_tr_b16 a[14:15], v175 offset:2048
    s_add_u32 s83, s83, 524288
    v_mfma_f32_16x16x32_bf16 v[12:15], a[44:47], a[176:179], v[12:15]
    ds_read_b64_tr_b16 a[16:17], v172 offset:4096
    ds_read_b64_tr_b16 a[18:19], v172 offset:6144
    v_mfma_f32_16x16x32_bf16 v[28:31], a[44:47], a[180:183], v[28:31]
    ds_read_b64_tr_b16 a[20:21], v173 offset:4096
    v_mfma_f32_16x16x32_bf16 v[0:3], a[48:51], a[184:187], v[0:3]
    ds_read_b64_tr_b16 a[22:23], v173 offset:6144
    buffer_load_dwordx4 a[176:179], v159, s[56:59], s87 offen sc1
    v_mfma_f32_16x16x32_bf16 v[16:19], a[48:51], a[188:191], v[16:19]
    ds_read_b64_tr_b16 a[24:25], v174 offset:4096
    ds_read_b64_tr_b16 a[26:27], v174 offset:6144
    v_mfma_f32_16x16x32_bf16 v[4:7], a[52:55], a[184:187], v[4:7]
    ds_read_b64_tr_b16 a[28:29], v175 offset:4096
    buffer_load_dwordx4 a[180:183], v159, s[56:59], s87 offen offset:1024 sc1
    v_mfma_f32_16x16x32_bf16 v[20:23], a[52:55], a[188:191], v[20:23]
    ds_read_b64_tr_b16 a[30:31], v175 offset:6144
    v_mfma_f32_16x16x32_bf16 v[8:11], a[56:59], a[184:187], v[8:11]
    v_mfma_f32_16x16x32_bf16 v[24:27], a[56:59], a[188:191], v[24:27]
    v_mfma_f32_16x16x32_bf16 v[12:15], a[60:63], a[184:187], v[12:15]
    v_mfma_f32_16x16x32_bf16 v[28:31], a[60:63], a[188:191], v[28:31]
    buffer_load_dwordx4 a[184:187], v159, s[56:59], s87 offen offset:2048 sc1
    buffer_load_dwordx4 a[188:191], v159, s[56:59], s87 offen offset:3072 sc1
    s_add_u32 s87, s87, 16384
    s_waitcnt vmcnt(16) lgkmcnt(0)
    s_barrier
    v_cmp_eq_u32 vcc, 0, v125
    s_nop 0
    s_cmp_eq_u64 vcc, 0
    s_cbranch_scc1 L_p3_g_out
    s_mov_b32 s96, 0
L_p3_g:
    buffer_load_dword v125, v124, s[16:19], s53 offen sc1
    s_waitcnt vmcnt(0)
    v_cmp_eq_u32 vcc, 0, v125
    s_nop 0
    s_cmp_eq_u64 vcc, 0
    s_cbranch_scc1 L_p3_g_out
    s_add_u32 s96, s96, 1
    s_cmp_lt_u32 s96, 0x40000
    s_cbranch_scc1 L_p3_g
L_p3_g_out:
    s_mov_b32 s60, s70
    s_mov_b32 s61, s71
    s_mov_b32 s62, 0x380000
    s_mov_b32 s63, 0x20000
    s_and_b32 s80, s80, 524287
    s_and_b32 s81, s81, 524287
    s_and_b32 s82, s82, 524287
    s_and_b32 s83, s83, 524287
    v_mfma_f32_16x16x32_bf16 v[0:3], a[0:3], a[128:131], v[0:3]
    s_add_u32 m0, s30, 0
    ds_read_b64_tr_b16 a[32:33], v172 offset:8192
    v_mfma_f32_16x16x32_bf16 v[16:19], a[0:3], a[132:135], v[16:19]
    buffer_load_dwordx4 v157, s[60:63], s80 offen lds
    ds_read_b64_tr_b16 a[34:35], v172 offset:10240
    v_mfma_f32_16x16x32_bf16 v[4:7], a[4:7], a[128:131], v[4:7]
    buffer_load_dwordx4 v158, s[60:63], s80 offen offset:1024 lds
    ds_read_b64_tr_b16 a[36:37], v173 offset:8192
    v_mfma_f32_16x16x32_bf16 v[20:23], a[4:7], a[132:135], v[20:23]
    ds_read_b64_tr_b16 a[38:39], v173 offset:10240
    ds_read_b64_tr_b16 a[40:41], v174 offset:8192
    v_mfma_f32_16x16x32_bf16 v[8:11], a[8:11], a[128:131], v[8:11]
    ds_read_b64_tr_b16 a[42:43], v174 offset:10240
    ds_read_b64_tr_b16 a[44:45], v175 offset:8192
    v_mfma_f32_16x16x32_bf16 v[24:27], a[8:11], a[132:135], v[24:27]
    ds_read_b64_tr_b16 a[46:47], v175 offset:10240
    s_add_u32 s80, s80, 524288
    v_mfma_f32_16x16x32_bf16 v[12:15], a[12:15], a[128:131], v[12:15]
    ds_read_b64_tr_b16 a[48:49], v172 offset:12288
    ds_read_b64_tr_b16 a[50:51], v172 offset:14336
    v_mfma_f32_16x16x32_bf16 v[28:31], a[12:15], a[132:135], v[28:31]
    ds_read_b64_tr_b16 a[52:53], v173 offset:12288
    v_mfma_f32_16x16x32_bf16 v[0:3], a[16:19], a[136:139], v[0:3]
    ds_read_b64_tr_b16 a[54:55], v173 offset:14336
    buffer_load_dwordx4 a[128:131], v159, s[56:59], s84 offen sc1
    v_mfma_f32_16x16x32_bf16 v[16:19], a[16:19], a[140:143], v[16:19]
    ds_read_b64_tr_b16 a[56:57], v174 offset:12288
    ds_read_b64_tr_b16 a[58:59], v174 offset:14336
    v_mfma_f32_16x16x32_bf16 v[4:7], a[20:23], a[136:139], v[4:7]
    ds_read_b64_tr_b16 a[60:61], v175 offset:12288
    buffer_load_dwordx4 a[132:135], v159, s[56:59], s84 offen offset:1024 sc1
    v_mfma_f32_16x16x32_bf16 v[20:23], a[20:23], a[140:143], v[20:23]
    ds_read_b64_tr_b16 a[62:63], v175 offset:14336
    v_mfma_f32_16x16x32_bf16 v[8:11], a[24:27], a[136:139], v[8:11]
    v_mfma_f32_16x16x32_bf16 v[24:27], a[24:27], a[140:143], v[24:27]
    v_mfma_f32_16x16x32_bf16 v[12:15], a[28:31], a[136:139], v[12:15]
    v_mfma_f32_16x16x32_bf16 v[28:31], a[28:31], a[140:143], v[28:31]
    buffer_load_dwordx4 a[136:139], v159, s[56:59], s84 offen offset:2048 sc1
    buffer_load_dwordx4 a[140:143], v159, s[56:59], s84 offen offset:3072 sc1
    s_add_u32 s84, s84, 16384
    s_waitcnt vmcnt(16) lgkmcnt(0)
    s_barrier
    v_mfma_f32_16x16x32_bf16 v[0:3], a[32:35], a[144:147], v[0:3]
    s_add_u32 m0, s30, 8192
    ds_read_b64_tr_b16 a[0:1], v172 offset:16384
    v_mfma_f32_16x16x32_bf16 v[16:19], a[32:35], a[148:151], v[16:19]
    buffer_load_dwordx4 v157, s[60:63], s81 offen lds
    ds_read_b64_tr_b16 a[2:3], v172 offset:18432
    v_mfma_f32_16x16x32_bf16 v[4:7], a[36:39], a[144:147], v[4:7]
    buffer_load_dwordx4 v158, s[60:63], s81 offen offset:1024 lds
    ds_read_b64_tr_b16 a[4:5], v173 offset:16384
    v_mfma_f32_16x16x32_bf16 v[20:23], a[36:39], a[148:151], v[20:23]
    ds_read_b64_tr_b16 a[6:7], v173 offset:18432
    ds_read_b64_tr_b16 a[8:9], v174 offset:16384
    v_mfma_f32_16x16x32_bf16 v[8:11], a[40:43], a[144:147], v[8:11]
    ds_read_b64_tr_b16 a[10:11], v174 offset:18432
    ds_read_b64_tr_b16 a[12:13], v175 offset:16384
    v_mfma_f32_16x16x32_bf16 v[24:27], a[40:43], a[148:151], v[24:27]
    ds_read_b64_tr_b16 a[14:15], v175 offset:18432
    s_add_u32 s81, s81, 524288
    v_mfma_f32_16x16x32_bf16 v[12:15], a[44:47], a[144:147], v[12:15]
    ds_read_b64_tr_b16 a[16:17], v172 offset:20480
    ds_read_b64_tr_b16 a[18:19], v172 offset:22528
    v_mfma_f32_16x16x32_bf16 v[28:31], a[44:47], a[148:151], v[28:31]
    ds_read_b64_tr_b16 a[20:21], v173 offset:20480
    v_mfma_f32_16x16x32_bf16 v[0:3], a[48:51], a[152:155], v[0:3]
    ds_read_b64_tr_b16 a[22:23], v173 offset:22528
    buffer_load_dwordx4 a[144:147], v159, s[56:59], s85 offen sc1
    v_mfma_f32_16x16x32_bf16 v[16:19], a[48:51], a[156:159], v[16:19]
    ds_read_b64_tr_b16 a[24:25], v174 offset:20480
    ds_read_b64_tr_b16 a[26:27], v174 offset:22528
    v_mfma_f32_16x16x32_bf16 v[4:7], a[52:55], a[152:155], v[4:7]
    ds_read_b64_tr_b16 a[28:29], v175 offset:20480
    buffer_load_dwordx4 a[148:151], v159, s[56:59], s85 offen offset:1024 sc1
    v_mfma_f32_16x16x32_bf16 v[20:23], a[52:55], a[156:159], v[20:23]
    ds_read_b64_tr_b16 a[30:31], v175 offset:22528
    v_mfma_f32_16x16x32_bf16 v[8:11], a[56:59], a[152:155], v[8:11]
    v_mfma_f32_16x16x32_bf16 v[24:27], a[56:59], a[156:159], v[24:27]
    v_mfma_f32_16x16x32_bf16 v[12:15], a[60:63], a[152:155], v[12:15]
    v_mfma_f32_16x16x32_bf16 v[28:31], a[60:63], a[156:159], v[28:31]
    buffer_load_dwordx4 a[152:155], v159, s[56:59], s85 offen offset:2048 sc1
    buffer_load_dwordx4 a[156:159], v159, s[56:59], s85 offen offset:3072 sc1
    s_add_u32 s85, s85, 16384
    s_waitcnt vmcnt(16) lgkmcnt(0)
    s_barrier
    v_mfma_f32_16x16x32_bf16 v[0:3], a[0:3], a[160:163], v[0:3]
    s_add_u32 m0, s30, 16384
    ds_read_b64_tr_b16 a[32:33], v172 offset:24576
    v_mfma_f32_16x16x32_bf16 v[16:19], a[0:3], a[164:167], v[16:19]
    buffer_load_dwordx4 v157, s[60:63], s82 offen lds
    ds_read_b64_tr_b16 a[34:35], v172 offset:26624
    v_mfma_f32_16x16x32_bf16 v[4:7], a[4:7], a[160:163], v[4:7]
    buffer_load_dwordx4 v158, s[60:63], s82 offen offset:1024 lds
    ds_read_b64_tr_b16 a[36:37], v173 offset:24576
    v_mfma_f32_16x16x32_bf16 v[20:23], a[4:7], a[164:167], v[20:23]
    ds_read_b64_tr_b16 a[38:39], v173 offset:26624
    ds_read_b64_tr_b16 a[40:41], v174 offset:24576
    v_mfma_f32_16x16x32_bf16 v[8:11], a[8:11], a[160:163], v[8:11]
    ds_read_b64_tr_b16 a[42:43], v174 offset:26624
    ds_read_b64_tr_b16 a[44:45], v175 offset:24576
    v_mfma_f32_16x16x32_bf16 v[24:27], a[8:11], a[164:167], v[24:27]
    ds_read_b64_tr_b16 a[46:47], v175 offset:26624
    s_add_u32 s82, s82, 524288
    v_mfma_f32_16x16x32_bf16 v[12:15], a[12:15], a[160:163], v[12:15]
    ds_read_b64_tr_b16 a[48:49], v172 offset:28672
    ds_read_b64_tr_b16 a[50:51], v172 offset:30720
    v_mfma_f32_16x16x32_bf16 v[28:31], a[12:15], a[164:167], v[28:31]
    ds_read_b64_tr_b16 a[52:53], v173 offset:28672
    v_mfma_f32_16x16x32_bf16 v[0:3], a[16:19], a[168:171], v[0:3]
    ds_read_b64_tr_b16 a[54:55], v173 offset:30720
    buffer_load_dwordx4 a[160:163], v159, s[56:59], s86 offen sc1
    v_mfma_f32_16x16x32_bf16 v[16:19], a[16:19], a[172:175], v[16:19]
    ds_read_b64_tr_b16 a[56:57], v174 offset:28672
    ds_read_b64_tr_b16 a[58:59], v174 offset:30720
    v_mfma_f32_16x16x32_bf16 v[4:7], a[20:23], a[168:171], v[4:7]
    ds_read_b64_tr_b16 a[60:61], v175 offset:28672
    buffer_load_dwordx4 a[164:167], v159, s[56:59], s86 offen offset:1024 sc1
    v_mfma_f32_16x16x32_bf16 v[20:23], a[20:23], a[172:175], v[20:23]
    ds_read_b64_tr_b16 a[62:63], v175 offset:30720
    v_mfma_f32_16x16x32_bf16 v[8:11], a[24:27], a[168:171], v[8:11]
    v_mfma_f32_16x16x32_bf16 v[24:27], a[24:27], a[172:175], v[24:27]
    v_mfma_f32_16x16x32_bf16 v[12:15], a[28:31], a[168:171], v[12:15]
    v_mfma_f32_16x16x32_bf16 v[28:31], a[28:31], a[172:175], v[28:31]
    buffer_load_dwordx4 a[168:171], v159, s[56:59], s86 offen offset:2048 sc1
    buffer_load_dwordx4 a[172:175], v159, s[56:59], s86 offen offset:3072 sc1
    s_add_u32 s86, s86, 16384
    s_waitcnt vmcnt(16) lgkmcnt(0)
    s_barrier
    v_mfma_f32_16x16x32_bf16 v[0:3], a[32:35], a[176:179], v[0:3]
    s_add_u32 m0, s30, 24576
    ds_read_b64_tr_b16 a[0:1], v172 offset:0
    v_mfma_f32_16x16x32_bf16 v[16:19], a[32:35], a[180:183], v[16:19]
    buffer_load_dwordx4 v157, s[60:63], s83 offen lds
    ds_read_b64_tr_b16 a[2:3], v172 offset:2048
    v_mfma_f32_16x16x32_bf16 v[4:7], a[36:39], a[176:179], v[4:7]
    buffer_load_dwordx4 v158, s[60:63], s83 offen offset:1024 lds
    ds_read_b64_tr_b16 a[4:5], v173 offset:0
    v_mfma_f32_16x16x32_bf16 v[20:23], a[36:39], a[180:183], v[20:23]
    ds_read_b64_tr_b16 a[6:7], v173 offset:2048
    ds_read_b64_tr_b16 a[8:9], v174 offset:0
    v_mfma_f32_16x16x32_bf16 v[8:11], a[40:43], a[176:179], v[8:11]
    ds_read_b64_tr_b16 a[10:11], v174 offset:2048
    ds_read_b64_tr_b16 a[12:13], v175 offset:0
    v_mfma_f32_16x16x32_bf16 v[24:27], a[40:43], a[180:183], v[24:27]
    ds_read_b64_tr_b16 a[14:15], v175 offset:2048
    s_add_u32 s83, s83, 524288
    v_mfma_f32_16x16x32_bf16 v[12:15], a[44:47], a[176:179], v[12:15]
    ds_read_b64_tr_b16 a[16:17], v172 offset:4096
    ds_read_b64_tr_b16 a[18:19], v172 offset:6144
    v_mfma_f32_16x16x32_bf16 v[28:31], a[44:47], a[180:183], v[28:31]
    ds_read_b64_tr_b16 a[20:21], v173 offset:4096
    v_mfma_f32_16x16x32_bf16 v[0:3], a[48:51], a[184:187], v[0:3]
    ds_read_b64_tr_b16 a[22:23], v173 offset:6144
    buffer_load_dwordx4 a[176:179], v159, s[56:59], s87 offen sc1
    v_mfma_f32_16x16x32_bf16 v[16:19], a[48:51], a[188:191], v[16:19]
    ds_read_b64_tr_b16 a[24:25], v174 offset:4096
    ds_read_b64_tr_b16 a[26:27], v174 offset:6144
    v_mfma_f32_16x16x32_bf16 v[4:7], a[52:55], a[184:187], v[4:7]
    ds_read_b64_tr_b16 a[28:29], v175 offset:4096
    buffer_load_dwordx4 a[180:183], v159, s[56:59], s87 offen offset:1024 sc1
    v_mfma_f32_16x16x32_bf16 v[20:23], a[52:55], a[188:191], v[20:23]
    ds_read_b64_tr_b16 a[30:31], v175 offset:6144
    v_mfma_f32_16x16x32_bf16 v[8:11], a[56:59], a[184:187], v[8:11]
    v_mfma_f32_16x16x32_bf16 v[24:27], a[56:59], a[188:191], v[24:27]
    v_mfma_f32_16x16x32_bf16 v[12:15], a[60:63], a[184:187], v[12:15]
    v_mfma_f32_16x16x32_bf16 v[28:31], a[60:63], a[188:191], v[28:31]
    buffer_load_dwordx4 a[184:187], v159, s[56:59], s87 offen offset:2048 sc1
    buffer_load_dwordx4 a[188:191], v159, s[56:59], s87 offen offset:3072 sc1
    s_add_u32 s87, s87, 16384
    s_mov_b32 s36, 0
L_p3_loop:
    s_waitcnt vmcnt(16) lgkmcnt(0)
    s_barrier
    v_mfma_f32_16x16x32_bf16 v[32:35], a[0:3], a[128:131], v[32:35]
    s_add_u32 m0, s30, 0
    ds_read_b64_tr_b16 a[32:33], v172 offset:8192
    v_mfma_f32_16x16x32_bf16 v[48:51], a[0:3], a[132:135], v[48:51]
    buffer_load_dwordx4 v157, s[60:63], s80 offen lds
    ds_read_b64_tr_b16 a[34:35], v172 offset:10240
    v_mfma_f32_16x16x32_bf16 v[36:39], a[4:7], a[128:131], v[36:39]
    buffer_load_dwordx4 v158, s[60:63], s80 offen offset:1024 lds
    ds_read_b64_tr_b16 a[36:37], v173 offset:8192
    v_mfma_f32_16x16x32_bf16 v[52:55], a[4:7], a[132:135], v[52:55]
    ds_read_b64_tr_b16 a[38:39], v173 offset:10240
    ds_read_b64_tr_b16 a[40:41], v174 offset:8192
    v_mfma_f32_16x16x32_bf16 v[40:43], a[8:11], a[128:131], v[40:43]
    ds_read_b64_tr_b16 a[42:43], v174 offset:10240
    ds_read_b64_tr_b16 a[44:45], v175 offset:8192
    v_mfma_f32_16x16x32_bf16 v[56:59], a[8:11], a[132:135], v[56:59]
    ds_read_b64_tr_b16 a[46:47], v175 offset:10240
    s_add_u32 s80, s80, 524288
    v_mfma_f32_16x16x32_bf16 v[44:47], a[12:15], a[128:131], v[44:47]
    ds_read_b64_tr_b16 a[48:49], v172 offset:12288
    ds_read_b64_tr_b16 a[50:51], v172 offset:14336
    v_mfma_f32_16x16x32_bf16 v[60:63], a[12:15], a[132:135], v[60:63]
    ds_read_b64_tr_b16 a[52:53], v173 offset:12288
    v_mfma_f32_16x16x32_bf16 v[32:35], a[16:19], a[136:139], v[32:35]
    ds_read_b64_tr_b16 a[54:55], v173 offset:14336
    buffer_load_dwordx4 a[128:131], v159, s[56:59], s84 offen sc1
    v_mfma_f32_16x16x32_bf16 v[48:51], a[16:19], a[140:143], v[48:51]
    ds_read_b64_tr_b16 a[56:57], v174 offset:12288
    ds_read_b64_tr_b16 a[58:59], v174 offset:14336
    v_mfma_f32_16x16x32_bf16 v[36:39], a[20:23], a[136:139], v[36:39]
    ds_read_b64_tr_b16 a[60:61], v175 offset:12288
    buffer_load_dwordx4 a[132:135], v159, s[56:59], s84 offen offset:1024 sc1
    v_mfma_f32_16x16x32_bf16 v[52:55], a[20:23], a[140:143], v[52:55]
    ds_read_b64_tr_b16 a[62:63], v175 offset:14336
    v_mfma_f32_16x16x32_bf16 v[40:43], a[24:27], a[136:139], v[40:43]
    v_mfma_f32_16x16x32_bf16 v[56:59], a[24:27], a[140:143], v[56:59]
    v_mfma_f32_16x16x32_bf16 v[44:47], a[28:31], a[136:139], v[44:47]
    v_mfma_f32_16x16x32_bf16 v[60:63], a[28:31], a[140:143], v[60:63]
    buffer_load_dwordx4 a[136:139], v159, s[56:59], s84 offen offset:2048 sc1
    buffer_load_dwordx4 a[140:143], v159, s[56:59], s84 offen offset:3072 sc1
    s_add_u32 s84, s84, 16384
    s_waitcnt vmcnt(16) lgkmcnt(0)
    s_barrier
    v_mfma_f32_16x16x32_bf16 v[32:35], a[32:35], a[144:147], v[32:35]
    s_add_u32 m0, s30, 8192
    ds_read_b64_tr_b16 a[0:1], v172 offset:16384
    v_mfma_f32_16x16x32_bf16 v[48:51], a[32:35], a[148:151], v[48:51]
    buffer_load_dwordx4 v157, s[60:63], s81 offen lds
    ds_read_b64_tr_b16 a[2:3], v172 offset:18432
    v_mfma_f32_16x16x32_bf16 v[36:39], a[36:39], a[144:147], v[36:39]
    buffer_load_dwordx4 v158, s[60:63], s81 offen offset:1024 lds
    ds_read_b64_tr_b16 a[4:5], v173 offset:16384
    v_mfma_f32_16x16x32_bf16 v[52:55], a[36:39], a[148:151], v[52:55]
    ds_read_b64_tr_b16 a[6:7], v173 offset:18432
    ds_read_b64_tr_b16 a[8:9], v174 offset:16384
    v_mfma_f32_16x16x32_bf16 v[40:43], a[40:43], a[144:147], v[40:43]
    ds_read_b64_tr_b16 a[10:11], v174 offset:18432
    ds_read_b64_tr_b16 a[12:13], v175 offset:16384
    v_mfma_f32_16x16x32_bf16 v[56:59], a[40:43], a[148:151], v[56:59]
    ds_read_b64_tr_b16 a[14:15], v175 offset:18432
    s_add_u32 s81, s81, 524288
    v_mfma_f32_16x16x32_bf16 v[44:47], a[44:47], a[144:147], v[44:47]
    ds_read_b64_tr_b16 a[16:17], v172 offset:20480
    ds_read_b64_tr_b16 a[18:19], v172 offset:22528
    v_mfma_f32_16x16x32_bf16 v[60:63], a[44:47], a[148:151], v[60:63]
    ds_read_b64_tr_b16 a[20:21], v173 offset:20480
    v_mfma_f32_16x16x32_bf16 v[32:35], a[48:51], a[152:155], v[32:35]
    ds_read_b64_tr_b16 a[22:23], v173 offset:22528
    buffer_load_dwordx4 a[144:147], v159, s[56:59], s85 offen sc1
    v_mfma_f32_16x16x32_bf16 v[48:51], a[48:51], a[156:159], v[48:51]
    ds_read_b64_tr_b16 a[24:25], v174 offset:20480
    ds_read_b64_tr_b16 a[26:27], v174 offset:22528
    v_mfma_f32_16x16x32_bf16 v[36:39], a[52:55], a[152:155], v[36:39]
    ds_read_b64_tr_b16 a[28:29], v175 offset:20480
    buffer_load_dwordx4 a[148:151], v159, s[56:59], s85 offen offset:1024 sc1
    v_mfma_f32_16x16x32_bf16 v[52:55], a[52:55], a[156:159], v[52:55]
    ds_read_b64_tr_b16 a[30:31], v175 offset:22528
    v_mfma_f32_16x16x32_bf16 v[40:43], a[56:59], a[152:155], v[40:43]
    v_mfma_f32_16x16x32_bf16 v[56:59], a[56:59], a[156:159], v[56:59]
    v_mfma_f32_16x16x32_bf16 v[44:47], a[60:63], a[152:155], v[44:47]
    v_mfma_f32_16x16x32_bf16 v[60:63], a[60:63], a[156:159], v[60:63]
    buffer_load_dwordx4 a[152:155], v159, s[56:59], s85 offen offset:2048 sc1
    buffer_load_dwordx4 a[156:159], v159, s[56:59], s85 offen offset:3072 sc1
    s_add_u32 s85, s85, 16384
    s_waitcnt vmcnt(16) lgkmcnt(0)
    s_barrier
    v_mfma_f32_16x16x32_bf16 v[32:35], a[0:3], a[160:163], v[32:35]
    s_add_u32 m0, s30, 16384
    ds_read_b64_tr_b16 a[32:33], v172 offset:24576
    v_mfma_f32_16x16x32_bf16 v[48:51], a[0:3], a[164:167], v[48:51]
    buffer_load_dwordx4 v157, s[60:63], s82 offen lds
    ds_read_b64_tr_b16 a[34:35], v172 offset:26624
    v_mfma_f32_16x16x32_bf16 v[36:39], a[4:7], a[160:163], v[36:39]
    buffer_load_dwordx4 v158, s[60:63], s82 offen offset:1024 lds
    ds_read_b64_tr_b16 a[36:37], v173 offset:24576
    v_mfma_f32_16x16x32_bf16 v[52:55], a[4:7], a[164:167], v[52:55]
    ds_read_b64_tr_b16 a[38:39], v173 offset:26624
    ds_read_b64_tr_b16 a[40:41], v174 offset:24576
    v_mfma_f32_16x16x32_bf16 v[40:43], a[8:11], a[160:163], v[40:43]
    ds_read_b64_tr_b16 a[42:43], v174 offset:26624
    ds_read_b64_tr_b16 a[44:45], v175 offset:24576
    v_mfma_f32_16x16x32_bf16 v[56:59], a[8:11], a[164:167], v[56:59]
    ds_read_b64_tr_b16 a[46:47], v175 offset:26624
    s_add_u32 s82, s82, 524288
    v_mfma_f32_16x16x32_bf16 v[44:47], a[12:15], a[160:163], v[44:47]
    ds_read_b64_tr_b16 a[48:49], v172 offset:28672
    ds_read_b64_tr_b16 a[50:51], v172 offset:30720
    v_mfma_f32_16x16x32_bf16 v[60:63], a[12:15], a[164:167], v[60:63]
    ds_read_b64_tr_b16 a[52:53], v173 offset:28672
    v_mfma_f32_16x16x32_bf16 v[32:35], a[16:19], a[168:171], v[32:35]
    ds_read_b64_tr_b16 a[54:55], v173 offset:30720
    buffer_load_dwordx4 a[160:163], v159, s[56:59], s86 offen sc1
    v_mfma_f32_16x16x32_bf16 v[48:51], a[16:19], a[172:175], v[48:51]
    ds_read_b64_tr_b16 a[56:57], v174 offset:28672
    ds_read_b64_tr_b16 a[58:59], v174 offset:30720
    v_mfma_f32_16x16x32_bf16 v[36:39], a[20:23], a[168:171], v[36:39]
    ds_read_b64_tr_b16 a[60:61], v175 offset:28672
    buffer_load_dwordx4 a[164:167], v159, s[56:59], s86 offen offset:1024 sc1
    v_mfma_f32_16x16x32_bf16 v[52:55], a[20:23], a[172:175], v[52:55]
    ds_read_b64_tr_b16 a[62:63], v175 offset:30720
    v_mfma_f32_16x16x32_bf16 v[40:43], a[24:27], a[168:171], v[40:43]
    v_mfma_f32_16x16x32_bf16 v[56:59], a[24:27], a[172:175], v[56:59]
    v_mfma_f32_16x16x32_bf16 v[44:47], a[28:31], a[168:171], v[44:47]
    v_mfma_f32_16x16x32_bf16 v[60:63], a[28:31], a[172:175], v[60:63]
    buffer_load_dwordx4 a[168:171], v159, s[56:59], s86 offen offset:2048 sc1
    buffer_load_dwordx4 a[172:175], v159, s[56:59], s86 offen offset:3072 sc1
    s_add_u32 s86, s86, 16384
    s_waitcnt vmcnt(16) lgkmcnt(0)
    s_barrier
    v_mfma_f32_16x16x32_bf16 v[32:35], a[32:35], a[176:179], v[32:35]
    s_add_u32 m0, s30, 24576
    ds_read_b64_tr_b16 a[0:1], v172 offset:0
    v_mfma_f32_16x16x32_bf16 v[48:51], a[32:35], a[180:183], v[48:51]
    buffer_load_dwordx4 v157, s[60:63], s83 offen lds
    ds_read_b64_tr_b16 a[2:3], v172 offset:2048
    v_mfma_f32_16x16x32_bf16 v[36:39], a[36:39], a[176:179], v[36:39]
    buffer_load_dwordx4 v158, s[60:63], s83 offen offset:1024 lds
    ds_read_b64_tr_b16 a[4:5], v173 offset:0
    v_mfma_f32_16x16x32_bf16 v[52:55], a[36:39], a[180:183], v[52:55]
    ds_read_b64_tr_b16 a[6:7], v173 offset:2048
    ds_read_b64_tr_b16 a[8:9], v174 offset:0
    v_mfma_f32_16x16x32_bf16 v[40:43], a[40:43], a[176:179], v[40:43]
    ds_read_b64_tr_b16 a[10:11], v174 offset:2048
    ds_read_b64_tr_b16 a[12:13], v175 offset:0
    v_mfma_f32_16x16x32_bf16 v[56:59], a[40:43], a[180:183], v[56:59]
    ds_read_b64_tr_b16 a[14:15], v175 offset:2048
    s_add_u32 s83, s83, 524288
    v_mfma_f32_16x16x32_bf16 v[44:47], a[44:47], a[176:179], v[44:47]
    ds_read_b64_tr_b16 a[16:17], v172 offset:4096
    ds_read_b64_tr_b16 a[18:19], v172 offset:6144
    v_mfma_f32_16x16x32_bf16 v[60:63], a[44:47], a[180:183], v[60:63]
    ds_read_b64_tr_b16 a[20:21], v173 offset:4096
    v_mfma_f32_16x16x32_bf16 v[32:35], a[48:51], a[184:187], v[32:35]
    ds_read_b64_tr_b16 a[22:23], v173 offset:6144
    buffer_load_dwordx4 a[176:179], v159, s[56:59], s87 offen sc1
    v_mfma_f32_16x16x32_bf16 v[48:51], a[48:51], a[188:191], v[48:51]
    ds_read_b64_tr_b16 a[24:25], v174 offset:4096
    ds_read_b64_tr_b16 a[26:27], v174 offset:6144
    v_mfma_f32_16x16x32_bf16 v[36:39], a[52:55], a[184:187], v[36:39]
    ds_read_b64_tr_b16 a[28:29], v175 offset:4096
    buffer_load_dwordx4 a[180:183], v159, s[56:59], s87 offen offset:1024 sc1
    v_mfma_f32_16x16x32_bf16 v[52:55], a[52:55], a[188:191], v[52:55]
    ds_read_b64_tr_b16 a[30:31], v175 offset:6144
    v_mfma_f32_16x16x32_bf16 v[40:43], a[56:59], a[184:187], v[40:43]
    v_mfma_f32_16x16x32_bf16 v[56:59], a[56:59], a[188:191], v[56:59]
    v_mfma_f32_16x16x32_bf16 v[44:47], a[60:63], a[184:187], v[44:47]
    v_mfma_f32_16x16x32_bf16 v[60:63], a[60:63], a[188:191], v[60:63]
    buffer_load_dwordx4 a[184:187], v159, s[56:59], s87 offen offset:2048 sc1
    buffer_load_dwordx4 a[188:191], v159, s[56:59], s87 offen offset:3072 sc1
    s_add_u32 s87, s87, 16384
    s_add_u32 s36, s36, 1
    s_cmp_lt_u32 s36, 6
    s_cbranch_scc1 L_p3_loop
    s_waitcnt vmcnt(16) lgkmcnt(0)
    s_barrier
    v_mfma_f32_16x16x32_bf16 v[32:35], a[0:3], a[128:131], v[32:35]
    ds_read_b64_tr_b16 a[32:33], v172 offset:8192
    ds_read_b64_tr_b16 a[34:35], v172 offset:10240
    v_mfma_f32_16x16x32_bf16 v[48:51], a[0:3], a[132:135], v[48:51]
    ds_read_b64_tr_b16 a[36:37], v173 offset:8192
    v_mfma_f32_16x16x32_bf16 v[36:39], a[4:7], a[128:131], v[36:39]
    ds_read_b64_tr_b16 a[38:39], v173 offset:10240
    v_mfma_f32_16x16x32_bf16 v[52:55], a[4:7], a[132:135], v[52:55]
    ds_read_b64_tr_b16 a[40:41], v174 offset:8192
    ds_read_b64_tr_b16 a[42:43], v174 offset:10240
    v_mfma_f32_16x16x32_bf16 v[40:43], a[8:11], a[128:131], v[40:43]
    ds_read_b64_tr_b16 a[44:45], v175 offset:8192
    v_and_b32 v165, 15, v123
    v_mfma_f32_16x16x32_bf16 v[56:59], a[8:11], a[132:135], v[56:59]
    ds_read_b64_tr_b16 a[46:47], v175 offset:10240
    v_mfma_f32_16x16x32_bf16 v[44:47], a[12:15], a[128:131], v[44:47]
    ds_read_b64_tr_b16 a[48:49], v172 offset:12288
    ds_read_b64_tr_b16 a[50:51], v172 offset:14336
    v_mfma_f32_16x16x32_bf16 v[60:63], a[12:15], a[132:135], v[60:63]
    ds_read_b64_tr_b16 a[52:53], v173 offset:12288
    v_lshlrev_b32 v160, 3, v165
    v_mfma_f32_16x16x32_bf16 v[32:35], a[16:19], a[136:139], v[32:35]
    ds_read_b64_tr_b16 a[54:55], v173 offset:14336
    s_lshl_b32 s41, s55, 7
    v_mfma_f32_16x16x32_bf16 v[48:51], a[16:19], a[140:143], v[48:51]
    ds_read_b64_tr_b16 a[56:57], v174 offset:12288
    ds_read_b64_tr_b16 a[58:59], v174 offset:14336
    v_mfma_f32_16x16x32_bf16 v[36:39], a[20:23], a[136:139], v[36:39]
    ds_read_b64_tr_b16 a[60:61], v175 offset:12288
    v_mfma_f32_16x16x32_bf16 v[52:55], a[20:23], a[140:143], v[52:55]
    ds_read_b64_tr_b16 a[62:63], v175 offset:14336
    s_add_u32 s41, s41, 0x1c00000
    v_mfma_f32_16x16x32_bf16 v[40:43], a[24:27], a[136:139], v[40:43]
    v_mfma_f32_16x16x32_bf16 v[56:59], a[24:27], a[140:143], v[56:59]
    buffer_load_dwordx2 v[126:127], v160, s[16:19], s41 offen sc1
    v_mfma_f32_16x16x32_bf16 v[44:47], a[28:31], a[136:139], v[44:47]
    v_mfma_f32_16x16x32_bf16 v[60:63], a[28:31], a[140:143], v[60:63]
    s_waitcnt vmcnt(10) lgkmcnt(0)
    s_barrier
    v_mfma_f32_16x16x32_bf16 v[32:35], a[32:35], a[144:147], v[32:35]
    ds_read_b64_tr_b16 a[0:1], v172 offset:16384
    ds_read_b64_tr_b16 a[2:3], v172 offset:18432
    v_mfma_f32_16x16x32_bf16 v[48:51], a[32:35], a[148:151], v[48:51]
    ds_read_b64_tr_b16 a[4:5], v173 offset:16384
    v_mfma_f32_16x16x32_bf16 v[36:39], a[36:39], a[144:147], v[36:39]
    ds_read_b64_tr_b16 a[6:7], v173 offset:18432
    v_mfma_f32_16x16x32_bf16 v[52:55], a[36:39], a[148:151], v[52:55]
    ds_read_b64_tr_b16 a[8:9], v174 offset:16384
    ds_read_b64_tr_b16 a[10:11], v174 offset:18432
    v_mfma_f32_16x16x32_bf16 v[40:43], a[40:43], a[144:147], v[40:43]
    ds_read_b64_tr_b16 a[12:13], v175 offset:16384
    v_lshrrev_b32 v166, 4, v123
    v_mfma_f32_16x16x32_bf16 v[56:59], a[40:43], a[148:151], v[56:59]
    ds_read_b64_tr_b16 a[14:15], v175 offset:18432
    v_lshlrev_b32 v160, 12, v165
    v_mfma_f32_16x16x32_bf16 v[44:47], a[44:47], a[144:147], v[44:47]
    ds_read_b64_tr_b16 a[16:17], v172 offset:20480
    ds_read_b64_tr_b16 a[18:19], v172 offset:22528
    v_mfma_f32_16x16x32_bf16 v[60:63], a[44:47], a[148:151], v[60:63]
    ds_read_b64_tr_b16 a[20:21], v173 offset:20480
    v_and_b32 v161, 1, v166
    v_mfma_f32_16x16x32_bf16 v[32:35], a[48:51], a[152:155], v[32:35]
    ds_read_b64_tr_b16 a[22:23], v173 offset:22528
    v_lshl_add_u32 v160, v161, 5, v160
    v_mfma_f32_16x16x32_bf16 v[48:51], a[48:51], a[156:159], v[48:51]
    ds_read_b64_tr_b16 a[24:25], v174 offset:20480
    ds_read_b64_tr_b16 a[26:27], v174 offset:22528
    v_mfma_f32_16x16x32_bf16 v[36:39], a[52:55], a[152:155], v[36:39]
    ds_read_b64_tr_b16 a[28:29], v175 offset:20480
    v_lshrrev_b32 v161, 1, v166
    v_mfma_f32_16x16x32_bf16 v[52:55], a[52:55], a[156:159], v[52:55]
    ds_read_b64_tr_b16 a[30:31], v175 offset:22528
    v_lshl_add_u32 v160, v161, 4, v160
    v_mfma_f32_16x16x32_bf16 v[40:43], a[56:59], a[152:155], v[40:43]
    s_lshl_b32 s41, s55, 16
    v_mfma_f32_16x16x32_bf16 v[56:59], a[56:59], a[156:159], v[56:59]
    s_lshl_b32 s42, s26, 7
    v_mfma_f32_16x16x32_bf16 v[44:47], a[60:63], a[152:155], v[44:47]
    s_add_u32 s41, s41, s42
    v_mfma_f32_16x16x32_bf16 v[60:63], a[60:63], a[156:159], v[60:63]
    s_waitcnt vmcnt(4) lgkmcnt(0)
    s_barrier
    v_mfma_f32_16x16x32_bf16 v[32:35], a[0:3], a[160:163], v[32:35]
    ds_read_b64_tr_b16 a[32:33], v172 offset:24576
    ds_read_b64_tr_b16 a[34:35], v172 offset:26624
    v_mfma_f32_16x16x32_bf16 v[48:51], a[0:3], a[164:167], v[48:51]
    ds_read_b64_tr_b16 a[36:37], v173 offset:24576
    v_mfma_f32_16x16x32_bf16 v[36:39], a[4:7], a[160:163], v[36:39]
    ds_read_b64_tr_b16 a[38:39], v173 offset:26624
    v_mfma_f32_16x16x32_bf16 v[52:55], a[4:7], a[164:167], v[52:55]
    ds_read_b64_tr_b16 a[40:41], v174 offset:24576
    ds_read_b64_tr_b16 a[42:43], v174 offset:26624
    v_mfma_f32_16x16x32_bf16 v[40:43], a[8:11], a[160:163], v[40:43]
    ds_read_b64_tr_b16 a[44:45], v175 offset:24576
    v_mfma_f32_16x16x32_bf16 v[56:59], a[8:11], a[164:167], v[56:59]
    ds_read_b64_tr_b16 a[46:47], v175 offset:26624
    v_mfma_f32_16x16x32_bf16 v[44:47], a[12:15], a[160:163], v[44:47]
    ds_read_b64_tr_b16 a[48:49], v172 offset:28672
    ds_read_b64_tr_b16 a[50:51], v172 offset:30720
    v_mfma_f32_16x16x32_bf16 v[60:63], a[12:15], a[164:167], v[60:63]
    ds_read_b64_tr_b16 a[52:53], v173 offset:28672
    v_mfma_f32_16x16x32_bf16 v[32:35], a[16:19], a[168:171], v[32:35]
    ds_read_b64_tr_b16 a[54:55], v173 offset:30720
    v_mfma_f32_16x16x32_bf16 v[48:51], a[16:19], a[172:175], v[48:51]
    ds_read_b64_tr_b16 a[56:57], v174 offset:28672
    ds_read_b64_tr_b16 a[58:59], v174 offset:30720
    v_mfma_f32_16x16x32_bf16 v[36:39], a[20:23], a[168:171], v[36:39]
    ds_read_b64_tr_b16 a[60:61], v175 offset:28672
    v_mfma_f32_16x16x32_bf16 v[52:55], a[20:23], a[172:175], v[52:55]
    ds_read_b64_tr_b16 a[62:63], v175 offset:30720
    v_mfma_f32_16x16x32_bf16 v[40:43], a[24:27], a[168:171], v[40:43]
    v_mfma_f32_16x16x32_bf16 v[56:59], a[24:27], a[172:175], v[56:59]
    v_mfma_f32_16x16x32_bf16 v[44:47], a[28:31], a[168:171], v[44:47]
    v_mfma_f32_16x16x32_bf16 v[60:63], a[28:31], a[172:175], v[60:63]
    s_waitcnt vmcnt(0) lgkmcnt(0)
    v_mfma_f32_16x16x32_bf16 v[32:35], a[32:35], a[176:179], v[32:35]
    v_mfma_f32_16x16x32_bf16 v[48:51], a[32:35], a[180:183], v[48:51]
    v_mfma_f32_16x16x32_bf16 v[36:39], a[36:39], a[176:179], v[36:39]
    v_mfma_f32_16x16x32_bf16 v[52:55], a[36:39], a[180:183], v[52:55]
    v_mfma_f32_16x16x32_bf16 v[40:43], a[40:43], a[176:179], v[40:43]
    v_mul_f32 v0, v0, v126
    v_mul_f32 v1, v1, v126
    v_mfma_f32_16x16x32_bf16 v[56:59], a[40:43], a[180:183], v[56:59]
    v_mul_f32 v2, v2, v126
    v_mul_f32 v3, v3, v126
    v_mfma_f32_16x16x32_bf16 v[44:47], a[44:47], a[176:179], v[44:47]
    v_mul_f32 v4, v4, v126
    v_mul_f32 v5, v5, v126
    v_mfma_f32_16x16x32_bf16 v[60:63], a[44:47], a[180:183], v[60:63]
    v_mul_f32 v6, v6, v126
    v_mul_f32 v7, v7, v126
    v_mfma_f32_16x16x32_bf16 v[32:35], a[48:51], a[184:187], v[32:35]
    v_mul_f32 v8, v8, v126
    v_mul_f32 v9, v9, v126
    v_mfma_f32_16x16x32_bf16 v[48:51], a[48:51], a[188:191], v[48:51]
    v_mul_f32 v10, v10, v126
    v_mul_f32 v11, v11, v126
    v_mfma_f32_16x16x32_bf16 v[36:39], a[52:55], a[184:187], v[36:39]
    v_mul_f32 v12, v12, v126
    v_mul_f32 v13, v13, v126
    v_mfma_f32_16x16x32_bf16 v[52:55], a[52:55], a[188:191], v[52:55]
    v_mul_f32 v14, v14, v126
    v_mul_f32 v15, v15, v126
    v_mfma_f32_16x16x32_bf16 v[40:43], a[56:59], a[184:187], v[40:43]
    v_mul_f32 v16, v16, v127
    v_mul_f32 v17, v17, v127
    v_mfma_f32_16x16x32_bf16 v[56:59], a[56:59], a[188:191], v[56:59]
    v_mul_f32 v18, v18, v127
    v_mul_f32 v19, v19, v127
    v_mfma_f32_16x16x32_bf16 v[44:47], a[60:63], a[184:187], v[44:47]
    v_mul_f32 v20, v20, v127
    v_mul_f32 v21, v21, v127
    v_mfma_f32_16x16x32_bf16 v[60:63], a[60:63], a[188:191], v[60:63]
    v_mul_f32 v22, v22, v127
    v_mul_f32 v23, v23, v127
    v_mul_f32 v24, v24, v127
    v_mul_f32 v25, v25, v127
    v_mul_f32 v26, v26, v127
    v_mul_f32 v27, v27, v127
    v_mul_f32 v28, v28, v127
    v_mul_f32 v29, v29, v127
    v_mul_f32 v30, v30, v127
    v_mul_f32 v31, v31, v127
    v_sub_f32 v126, 1.0, v126
    v_sub_f32 v127, 1.0, v127
    v_pk_fma_f32 v[0:1], v[32:33], v[126:127], v[0:1] op_sel:[0,0,0] op_sel_hi:[1,0,1]
    v_pk_fma_f32 v[2:3], v[34:35], v[126:127], v[2:3] op_sel:[0,0,0] op_sel_hi:[1,0,1]
    v_pk_fma_f32 v[4:5], v[36:37], v[126:127], v[4:5] op_sel:[0,0,0] op_sel_hi:[1,0,1]
    v_pk_fma_f32 v[6:7], v[38:39], v[126:127], v[6:7] op_sel:[0,0,0] op_sel_hi:[1,0,1]
    v_pk_fma_f32 v[8:9], v[40:41], v[126:127], v[8:9] op_sel:[0,0,0] op_sel_hi:[1,0,1]
    v_pk_fma_f32 v[10:11], v[42:43], v[126:127], v[10:11] op_sel:[0,0,0] op_sel_hi:[1,0,1]
    v_pk_fma_f32 v[12:13], v[44:45], v[126:127], v[12:13] op_sel:[0,0,0] op_sel_hi:[1,0,1]
    v_pk_fma_f32 v[14:15], v[46:47], v[126:127], v[14:15] op_sel:[0,0,0] op_sel_hi:[1,0,1]
    v_pk_fma_f32 v[16:17], v[48:49], v[126:127], v[16:17] op_sel:[0,1,0] op_sel_hi:[1,1,1]
    v_pk_fma_f32 v[18:19], v[50:51], v[126:127], v[18:19] op_sel:[0,1,0] op_sel_hi:[1,1,1]
    v_pk_fma_f32 v[20:21], v[52:53], v[126:127], v[20:21] op_sel:[0,1,0] op_sel_hi:[1,1,1]
    v_pk_fma_f32 v[22:23], v[54:55], v[126:127], v[22:23] op_sel:[0,1,0] op_sel_hi:[1,1,1]
    v_pk_fma_f32 v[24:25], v[56:57], v[126:127], v[24:25] op_sel:[0,1,0] op_sel_hi:[1,1,1]
    v_pk_fma_f32 v[26:27], v[58:59], v[126:127], v[26:27] op_sel:[0,1,0] op_sel_hi:[1,1,1]
    v_pk_fma_f32 v[28:29], v[60:61], v[126:127], v[28:29] op_sel:[0,1,0] op_sel_hi:[1,1,1]
    v_pk_fma_f32 v[30:31], v[62:63], v[126:127], v[30:31] op_sel:[0,1,0] op_sel_hi:[1,1,1]
    v_cvt_pk_bf16_f32 v64, v0, v1
    v_cvt_pk_bf16_f32 v65, v2, v3
    v_cvt_pk_bf16_f32 v66, v4, v5
    v_cvt_pk_bf16_f32 v67, v6, v7
    s_nop 0
    v_permlane16_swap_b32 v64, v66
    v_permlane16_swap_b32 v65, v67
    buffer_store_dwordx4 v[64:67], v160, s[64:67], s41 offen sc1
    v_cvt_pk_bf16_f32 v68, v8, v9
    v_cvt_pk_bf16_f32 v69, v10, v11
    v_cvt_pk_bf16_f32 v70, v12, v13
    v_cvt_pk_bf16_f32 v71, v14, v15
    s_nop 0
    v_permlane16_swap_b32 v68, v70
    v_permlane16_swap_b32 v69, v71
    buffer_store_dwordx4 v[68:71], v160, s[64:67], s41 offen offset:64 sc1
    v_cvt_pk_bf16_f32 v72, v16, v17
    v_cvt_pk_bf16_f32 v73, v18, v19
    v_cvt_pk_bf16_f32 v74, v20, v21
    v_cvt_pk_bf16_f32 v75, v22, v23
    s_nop 0
    v_permlane16_swap_b32 v72, v74
    v_permlane16_swap_b32 v73, v75
    buffer_store_dwordx4 v[72:75], v160, s[64:67], s41 offen offset:2048 sc1
    v_cvt_pk_bf16_f32 v76, v24, v25
    v_cvt_pk_bf16_f32 v77, v26, v27
    v_cvt_pk_bf16_f32 v78, v28, v29
    v_cvt_pk_bf16_f32 v79, v30, v31
    s_nop 0
    v_permlane16_swap_b32 v76, v78
    v_permlane16_swap_b32 v77, v79
    buffer_store_dwordx4 v[76:79], v160, s[64:67], s41 offen offset:2112 sc1
    s_endpgm
.section .rodata,"a"
.p2align 6
.amdhsa_kernel gated_mix__sliding_local_dilated__mixer_gmlp__prompt_kernel
  .amdhsa_next_free_vgpr 512
  .amdhsa_next_free_sgpr 102
  .amdhsa_accum_offset 256
  .amdhsa_group_segment_fixed_size 0
  .amdhsa_kernarg_size 96
  .amdhsa_user_sgpr_count 2
  .amdhsa_user_sgpr_kernarg_segment_ptr 1
  .amdhsa_system_sgpr_workgroup_id_x 1
  .amdhsa_float_denorm_mode_32 3
.end_amdhsa_kernel
```
